```python
import torch

def _softmax(x, axis=-1):
    return torch.softmax(x, dim=axis)
def _gelu(x):
    return torch.nn.functional.gelu(x, approximate="tanh")
def _silu(x):
    return torch.nn.functional.silu(x)
def _sigmoid(x):
    return torch.sigmoid(x)
def _layernorm(x, axis=-1, eps=1e-5):
    m = x.mean(dim=axis, keepdim=True)
    v = x.var(dim=axis, keepdim=True, unbiased=False)
    return (x - m) / torch.sqrt(v + eps)
def _scatter_add(tgt, idx, src, axis=0):
    return tgt.clone().index_add_(axis, idx, src)
def _segment_sum(src, seg, n):
    out = torch.zeros((n,) + src.shape[1:], dtype=src.dtype)
    return out.index_add_(0, seg, src)
def _pad(x, pw):
    flat = tuple(v for pair in reversed(pw) for v in pair)
    return torch.nn.functional.pad(x, flat)

kernel_name = 'standalone__mha_block_cached__near_ridge'

def setup_inputs():

    _w = (lambda a: (lambda t: t.to(torch.bfloat16) if t.is_floating_point() else t)(torch.as_tensor(a)))
    B, Sq, D = 16, 144, 448
    H, Sk, Dh = 16, 512, 256
    return {
        "x": _w((lambda *s: torch.randn(*s, dtype=torch.bfloat16) * 0.8)(B, Sq, D)),
        "k_cache": _w((lambda *s: torch.randn(*s, dtype=torch.bfloat16) * 0.8)(B, H, Sk, Dh)),
        "v_cache": _w((lambda *s: torch.randn(*s, dtype=torch.bfloat16) * 0.05)(B, H, Sk, Dh)),
        "wq": _w((lambda *s: torch.randn(*s, dtype=torch.bfloat16) * 0.8)(D, H * Dh) * (D ** -0.5)),
        "wo": _w((lambda *s: torch.randn(*s, dtype=torch.bfloat16) * 0.05)(H * Dh, D) * ((H * Dh) ** -0.5)),
    }

def reference(x, k_cache, v_cache, wq, wo):
    B, Sq, D = x.shape
    H, Dh = 16, 256
    q = (lambda x, *d: x.permute(*d))((x @ wq).reshape(B, Sq, H, Dh), 0, 2, 1, 3)
    scores = torch.einsum("bhqd,bhkd->bhqk", q, k_cache) * (Dh ** -0.5)
    p = _softmax(scores, axis=-1)
    o = torch.einsum("bhqk,bhkd->bhqd", p, v_cache)
    return (lambda x, *d: x.permute(*d))(o, 0, 2, 1, 3).reshape(B, Sq, H * Dh) @ wo
```

```asm
; @launch grid=(256,1,1) block=(256,1,1) lds=163840
.amdgcn_target "amdgcn-amd-amdhsa--gfx950"
.macro M d, a, b, c
v_mfma_f32_16x16x32_bf16 \d, \a, \b, \c
.endm
.macro T d, a, o
ds_read_b64_tr_b16 \d, \a offset:\o
.endm
.macro R d, a, o
ds_read_b128 \d, \a offset:\o
.endm
.macro WL n
s_waitcnt lgkmcnt(\n)
.endm
.macro CV d, a, b
v_cvt_pk_bf16_f32 \d, \a, \b
.endm
.text
.globl standalone__mha_block_cached__near_ridge_kernel
.p2align 8
.type standalone__mha_block_cached__near_ridge_kernel,@function
standalone__mha_block_cached__near_ridge_kernel:
s_cmp_ge_u32 s2, 256
s_cbranch_scc1 L_k1_exit
s_load_dwordx8 s[44:51], s[0:1], 0
s_load_dwordx2 s[52:53], s[0:1], 56
s_getpc_b64 s[76:77]
s_lshr_b32 s4, s2, 3
s_cmp_ge_u32 s4, 18
s_cbranch_scc1 L_nopref
s_lshl_b32 s4, s4, 12
v_lshlrev_b32 v2, 4, v0
v_add_u32 v2, s4, v2
global_load_dwordx4 v[4:7], v2, s[76:77]
L_nopref:
s_and_b32 s3, s2, 7
s_lshr_b32 s4, s2, 3
s_and_b32 s5, s3, 3
s_lshl_b32 s5, s5, 2
s_and_b32 s6, s4, 3
s_add_u32 s5, s5, s6
s_lshr_b32 s6, s3, 2
s_lshl_b32 s6, s6, 3
s_lshr_b32 s7, s4, 2
s_add_u32 s6, s6, s7
v_and_b32 v1, 63, v0
v_lshrrev_b32 v2, 6, v0
s_nop 0
v_readfirstlane_b32 s28, v2
s_mov_b32 s29, 0x3db8aa3b
s_waitcnt lgkmcnt(0)
s_mul_i32 s7, s6, 129024
s_add_u32 s8, s44, s7
s_addc_u32 s9, s45, 0
s_mov_b32 s10, 129024
s_mov_b32 s11, 0x20000
s_lshl_b32 s7, s6, 4
s_add_u32 s7, s7, s5
s_lshl_b32 s7, s7, 18
s_add_u32 s12, s46, s7
s_addc_u32 s13, s47, 0
s_mov_b32 s14, 262144
s_mov_b32 s15, 0x20000
s_add_u32 s16, s48, s7
s_addc_u32 s17, s49, 0
s_mov_b32 s18, 262144
s_mov_b32 s19, 0x20000
s_lshl_b32 s7, s5, 9
s_add_u32 s20, s50, s7
s_addc_u32 s21, s51, 0
s_mov_b32 s22, 3662336
s_mov_b32 s23, 0x20000
s_mov_b32 s24, s52
s_mov_b32 s25, s53
s_mov_b32 s26, 18874368
s_mov_b32 s27, 0x20000
s_lshl_b32 s7, s28, 1
s_add_u32 s42, s7, 0
s_mul_i32 s32, s42, 14336
s_mul_i32 s43, s6, 9
s_add_u32 s43, s43, s42
s_lshl_b32 s43, s43, 7
s_lshl_b32 s42, s5, 3
s_add_u32 s43, s43, s42
s_lshl_b32 s36, s43, 10
s_add_u32 s42, s7, 1
s_mul_i32 s33, s42, 14336
s_mul_i32 s43, s6, 9
s_add_u32 s43, s43, s42
s_lshl_b32 s43, s43, 7
s_lshl_b32 s42, s5, 3
s_add_u32 s43, s43, s42
s_lshl_b32 s37, s43, 10
s_mov_b32 s42, 8
s_mul_i32 s34, s42, 14336
s_mul_i32 s43, s6, 9
s_add_u32 s43, s43, s42
s_lshl_b32 s43, s43, 7
s_lshl_b32 s42, s5, 3
s_add_u32 s43, s43, s42
s_lshl_b32 s38, s43, 10
s_mul_i32 s78, s4, 3
s_mul_i32 s42, s78, 9363
s_lshr_b32 s42, s42, 16
s_mul_i32 s42, s42, 7
s_sub_u32 s78, s78, s42
s_lshl_b32 s78, s78, 1
s_mov_b32 s78, 0
s_xor_b32 s42, s28, 0
s_lshl_b32 s56, s42, 11
s_xor_b32 s42, s28, 1
s_lshl_b32 s57, s42, 11
s_xor_b32 s42, s28, 2
s_lshl_b32 s58, s42, 11
s_xor_b32 s42, s28, 3
s_lshl_b32 s59, s42, 11
s_cmp_eq_u32 s28, 0
s_cselect_b64 s[66:67], -1, 0
s_cmp_eq_u32 s28, 1
s_cselect_b64 s[68:69], -1, 0
s_cmp_eq_u32 s28, 2
s_cselect_b64 s[70:71], -1, 0
s_cmp_eq_u32 s28, 3
s_cselect_b64 s[72:73], -1, 0
v_lshlrev_b32 v15, 4, v1
s_lshl_b32 s42, s28, 1
s_lshl_b32 s55, s28, 10
v_lshrrev_b32 v50, 5, v1
v_add_u32 v50, s42, v50
v_and_b32 v51, 31, v1
v_lshlrev_b32 v52, 1, v50
v_xor_b32 v52, v51, v52
v_lshlrev_b32 v52, 4, v52
v_lshl_add_u32 v9, v50, 9, v52
s_and_b32 s42, s28, 1
s_lshl_b32 s42, s42, 1
s_lshr_b32 s43, s28, 1
s_lshl_b32 s43, s43, 3
s_add_u32 s42, s42, s43
s_lshl_b32 s54, s42, 9
v_lshrrev_b32 v50, 5, v1
v_add_u32 v50, s42, v50
v_and_b32 v52, 3, v50
v_bfe_u32 v53, v50, 3, 1
v_lshl_add_u32 v52, v53, 2, v52
v_lshlrev_b32 v52, 1, v52
v_xor_b32 v52, v51, v52
v_lshlrev_b32 v52, 4, v52
v_lshl_add_u32 v8, v50, 13, v52
s_and_b32 s42, s28, 1
s_lshl_b32 s42, s42, 2
v_lshrrev_b32 v50, 4, v1
v_or_b32 v50, s42, v50
v_and_b32 v51, 7, v1
v_xor_b32 v50, v50, v51
v_lshrrev_b32 v51, 3, v1
v_mul_u32_u24 v51, 896, v51
v_lshl_add_u32 v14, v50, 4, v51
v_and_b32 v50, 15, v1
v_lshrrev_b32 v51, 4, v1
v_bfe_u32 v52, v50, 1, 3
v_xor_b32 v51, v51, v52
v_lshlrev_b32 v51, 4, v51
v_lshl_add_u32 v51, v50, 7, v51
v_add_u32 v12, 131072, v51
v_xor_b32 v13, 64, v12
s_lshl_b32 s42, s28, 12
s_add_u32 s42, s42, 114688
v_add_u32 v10, s42, v51
v_xor_b32 v11, 64, v10
s_mul_i32 s89, s28, 7168
s_lshl_b32 s90, s28, 10
s_cmp_lt_u32 s28, 2
s_cselect_b32 s91, s90, 60000
v_lshlrev_b32 v224, 4, v1
v_add_u32 v224, 147456, v224
v_add_u32 v244, s56, v224
v_add_u32 v245, s57, v224
v_add_u32 v246, s58, v224
v_add_u32 v247, s59, v224
v_mov_b32 v220, 0x3f803f80
v_mov_b32 v221, 0x3f803f80
v_mov_b32 v222, 0x3f803f80
v_mov_b32 v223, 0x3f803f80
s_add_u32 s81, s78, 0
s_cmp_ge_u32 s81, 14
s_cselect_b32 s79, 14, 0
s_sub_u32 s81, s81, s79
s_lshl_b32 s81, s81, 6
s_add_u32 s81, s81, s89
s_add_u32 m0, s90, 114688
s_add_u32 s40, s81, 0
buffer_load_dwordx4 v14, s[8:11], s40 offen lds
s_add_u32 m0, s90, 118784
s_add_u32 s40, s81, 28672
buffer_load_dwordx4 v14, s[8:11], s40 offen lds
s_add_u32 m0, s90, 122880
s_add_u32 s40, s81, 57344
buffer_load_dwordx4 v14, s[8:11], s40 offen lds
s_add_u32 m0, s90, 126976
s_add_u32 s40, s81, 86016
buffer_load_dwordx4 v14, s[8:11], s40 offen lds
s_add_u32 m0, s91, 131072
s_add_u32 s40, s81, 114688
buffer_load_dwordx4 v14, s[8:11], s40 offen lds
s_add_u32 s80, s78, 0
s_cmp_ge_u32 s80, 14
s_cselect_b32 s79, 14, 0
s_sub_u32 s80, s80, s79
s_lshl_b32 s80, s80, 18
s_add_u32 m0, s54, 0
s_add_u32 s40, s80, 0
buffer_load_dwordx4 v8, s[20:23], s40 offen lds
s_add_u32 m0, s54, 2048
s_add_u32 s40, s80, 32768
buffer_load_dwordx4 v8, s[20:23], s40 offen lds
s_add_u32 m0, s54, 8192
s_add_u32 s40, s80, 131072
buffer_load_dwordx4 v8, s[20:23], s40 offen lds
s_add_u32 m0, s54, 10240
s_add_u32 s40, s80, 163840
buffer_load_dwordx4 v8, s[20:23], s40 offen lds
s_add_u32 s81, s78, 2
s_cmp_ge_u32 s81, 14
s_cselect_b32 s79, 14, 0
s_sub_u32 s81, s81, s79
s_lshl_b32 s81, s81, 6
s_add_u32 s81, s81, s89
s_add_u32 m0, s90, 133120
s_add_u32 s40, s81, 0
buffer_load_dwordx4 v14, s[8:11], s40 offen lds
s_add_u32 m0, s90, 137216
s_add_u32 s40, s81, 28672
buffer_load_dwordx4 v14, s[8:11], s40 offen lds
s_add_u32 m0, s90, 141312
s_add_u32 s40, s81, 57344
buffer_load_dwordx4 v14, s[8:11], s40 offen lds
s_add_u32 m0, s90, 145408
s_add_u32 s40, s81, 86016
buffer_load_dwordx4 v14, s[8:11], s40 offen lds
s_add_u32 m0, s91, 149504
s_add_u32 s40, s81, 114688
buffer_load_dwordx4 v14, s[8:11], s40 offen lds
s_add_u32 s80, s78, 1
s_cmp_ge_u32 s80, 14
s_cselect_b32 s79, 14, 0
s_sub_u32 s80, s80, s79
s_lshl_b32 s80, s80, 18
s_add_u32 m0, s54, 16384
s_add_u32 s40, s80, 0
buffer_load_dwordx4 v8, s[20:23], s40 offen lds
s_add_u32 m0, s54, 18432
s_add_u32 s40, s80, 32768
buffer_load_dwordx4 v8, s[20:23], s40 offen lds
s_add_u32 m0, s54, 24576
s_add_u32 s40, s80, 131072
buffer_load_dwordx4 v8, s[20:23], s40 offen lds
s_add_u32 m0, s54, 26624
s_add_u32 s40, s80, 163840
buffer_load_dwordx4 v8, s[20:23], s40 offen lds
s_add_u32 s80, s78, 2
s_cmp_ge_u32 s80, 14
s_cselect_b32 s79, 14, 0
s_sub_u32 s80, s80, s79
s_lshl_b32 s80, s80, 18
s_add_u32 m0, s54, 32768
s_add_u32 s40, s80, 0
buffer_load_dwordx4 v8, s[20:23], s40 offen lds
s_add_u32 m0, s54, 34816
s_add_u32 s40, s80, 32768
buffer_load_dwordx4 v8, s[20:23], s40 offen lds
s_add_u32 m0, s54, 40960
s_add_u32 s40, s80, 131072
buffer_load_dwordx4 v8, s[20:23], s40 offen lds
s_add_u32 m0, s54, 43008
s_add_u32 s40, s80, 163840
buffer_load_dwordx4 v8, s[20:23], s40 offen lds
s_add_u32 s80, s78, 3
s_cmp_ge_u32 s80, 14
s_cselect_b32 s79, 14, 0
s_sub_u32 s80, s80, s79
s_lshl_b32 s80, s80, 18
s_add_u32 m0, s54, 49152
s_add_u32 s40, s80, 0
buffer_load_dwordx4 v8, s[20:23], s40 offen lds
s_add_u32 m0, s54, 51200
s_add_u32 s40, s80, 32768
buffer_load_dwordx4 v8, s[20:23], s40 offen lds
s_add_u32 m0, s54, 57344
s_add_u32 s40, s80, 131072
buffer_load_dwordx4 v8, s[20:23], s40 offen lds
s_add_u32 m0, s54, 59392
s_add_u32 s40, s80, 163840
buffer_load_dwordx4 v8, s[20:23], s40 offen lds
s_add_u32 m0, s55, 65536
s_mov_b32 s40, 0
buffer_load_dwordx4 v9, s[12:15], s40 offen nt lds
s_add_u32 m0, s55, 69632
s_mov_b32 s40, 4096
buffer_load_dwordx4 v9, s[12:15], s40 offen nt lds
s_add_u32 m0, s55, 73728
s_mov_b32 s40, 8192
buffer_load_dwordx4 v9, s[12:15], s40 offen nt lds
s_add_u32 m0, s55, 77824
s_mov_b32 s40, 12288
buffer_load_dwordx4 v9, s[12:15], s40 offen nt lds
s_waitcnt vmcnt(21)
s_barrier
R a[144:147], v10, 0
R a[148:151], v10, 2048
R a[152:155], v12, 0
R a[156:159], v11, 0
R a[160:163], v11, 2048
R a[164:167], v13, 0
v_lshrrev_b32 v50, 4, v1
v_bfe_u32 v51, v1, 2, 2
v_and_b32 v52, 3, v1
v_lshl_add_u32 v53, v50, 3, v51
v_lshlrev_b32 v53, 9, v53
v_and_b32 v50, 1, v50
v_lshl_add_u32 v50, v50, 2, v51
v_lshl_add_u32 v53, v50, 5, v53
v_lshl_add_u32 v53, v52, 3, v53
s_lshl_b32 s42, s28, 7
v_xor_b32 v53, s42, v53
v_xor_b32 v16, 0, v53
v_xor_b32 v17, 32, v53
v_xor_b32 v18, 64, v53
v_xor_b32 v19, 96, v53
v_xor_b32 v20, 128, v53
v_xor_b32 v21, 160, v53
v_xor_b32 v22, 192, v53
v_xor_b32 v23, 224, v53
v_xor_b32 v24, 256, v53
v_xor_b32 v25, 288, v53
v_xor_b32 v26, 320, v53
v_xor_b32 v27, 352, v53
v_xor_b32 v28, 384, v53
v_xor_b32 v29, 416, v53
v_xor_b32 v30, 448, v53
v_xor_b32 v31, 480, v53
T a[192:193], v16, 0
T a[194:195], v16, 2048
s_add_u32 m0, s55, 81920
s_mov_b32 s40, 16384
buffer_load_dwordx4 v9, s[12:15], s40 offen nt lds
T a[196:197], v17, 0
T a[198:199], v17, 2048
s_add_u32 m0, s55, 86016
s_mov_b32 s40, 20480
buffer_load_dwordx4 v9, s[12:15], s40 offen nt lds
T a[200:201], v18, 0
T a[202:203], v18, 2048
s_add_u32 m0, s55, 90112
s_mov_b32 s40, 24576
buffer_load_dwordx4 v9, s[12:15], s40 offen nt lds
T a[204:205], v19, 0
T a[206:207], v19, 2048
s_add_u32 m0, s55, 94208
s_mov_b32 s40, 28672
buffer_load_dwordx4 v9, s[12:15], s40 offen nt lds
T a[208:209], v20, 0
T a[210:211], v20, 2048
T a[212:213], v21, 0
T a[214:215], v21, 2048
WL 15
WL 10
M v[64:67], a[192:195], a[144:147], 0
M v[128:131], a[192:195], a[148:151], 0
M v[192:195], a[192:195], a[152:155], 0
T a[216:217], v22, 0
T a[218:219], v22, 2048
WL 10
M v[68:71], a[196:199], a[144:147], 0
M v[132:135], a[196:199], a[148:151], 0
M v[196:199], a[196:199], a[152:155], 0
T a[220:221], v23, 0
T a[222:223], v23, 2048
WL 10
M v[72:75], a[200:203], a[144:147], 0
M v[136:139], a[200:203], a[148:151], 0
M v[200:203], a[200:203], a[152:155], 0
T a[224:225], v24, 0
T a[226:227], v24, 2048
WL 10
M v[76:79], a[204:207], a[144:147], 0
M v[140:143], a[204:207], a[148:151], 0
M v[204:207], a[204:207], a[152:155], 0
T a[228:229], v25, 0
T a[230:231], v25, 2048
WL 10
M v[80:83], a[208:211], a[144:147], 0
M v[144:147], a[208:211], a[148:151], 0
T a[232:233], v26, 0
T a[234:235], v26, 2048
WL 10
M v[84:87], a[212:215], a[144:147], 0
M v[148:151], a[212:215], a[148:151], 0
T a[236:237], v27, 0
T a[238:239], v27, 2048
WL 10
M v[88:91], a[216:219], a[144:147], 0
M v[152:155], a[216:219], a[148:151], 0
T a[240:241], v28, 0
T a[242:243], v28, 2048
WL 10
M v[92:95], a[220:223], a[144:147], 0
M v[156:159], a[220:223], a[148:151], 0
T a[244:245], v29, 0
T a[246:247], v29, 2048
WL 10
M v[96:99], a[224:227], a[144:147], 0
M v[160:163], a[224:227], a[148:151], 0
T a[248:249], v30, 0
T a[250:251], v30, 2048
WL 10
M v[100:103], a[228:231], a[144:147], 0
M v[164:167], a[228:231], a[148:151], 0
T a[252:253], v31, 0
T a[254:255], v31, 2048
WL 10
M v[104:107], a[232:235], a[144:147], 0
M v[168:171], a[232:235], a[148:151], 0
s_waitcnt vmcnt(16)
s_barrier
T a[192:193], v16, 16384
T a[194:195], v16, 18432
WL 10
M v[108:111], a[236:239], a[144:147], 0
M v[172:175], a[236:239], a[148:151], 0
s_add_u32 m0, s55, 98304
s_mov_b32 s40, 32768
buffer_load_dwordx4 v9, s[12:15], s40 offen nt lds
T a[196:197], v17, 16384
T a[198:199], v17, 18432
WL 10
M v[112:115], a[240:243], a[144:147], 0
M v[176:179], a[240:243], a[148:151], 0
s_add_u32 m0, s55, 102400
s_mov_b32 s40, 36864
buffer_load_dwordx4 v9, s[12:15], s40 offen nt lds
T a[200:201], v18, 16384
T a[202:203], v18, 18432
WL 10
M v[116:119], a[244:247], a[144:147], 0
M v[180:183], a[244:247], a[148:151], 0
s_add_u32 m0, s55, 106496
s_mov_b32 s40, 40960
buffer_load_dwordx4 v9, s[12:15], s40 offen nt lds
T a[204:205], v19, 16384
T a[206:207], v19, 18432
WL 10
M v[120:123], a[248:251], a[144:147], 0
M v[184:187], a[248:251], a[148:151], 0
s_add_u32 m0, s55, 110592
s_mov_b32 s40, 45056
buffer_load_dwordx4 v9, s[12:15], s40 offen nt lds
T a[208:209], v20, 16384
T a[210:211], v20, 18432
WL 10
M v[124:127], a[252:255], a[144:147], 0
M v[188:191], a[252:255], a[148:151], 0
T a[212:213], v21, 16384
T a[214:215], v21, 18432
WL 10
M v[64:67], a[192:195], a[156:159], v[64:67]
M v[128:131], a[192:195], a[160:163], v[128:131]
M v[192:195], a[192:195], a[164:167], v[192:195]
T a[216:217], v22, 16384
T a[218:219], v22, 18432
WL 10
M v[68:71], a[196:199], a[156:159], v[68:71]
M v[132:135], a[196:199], a[160:163], v[132:135]
M v[196:199], a[196:199], a[164:167], v[196:199]
T a[220:221], v23, 16384
T a[222:223], v23, 18432
WL 10
M v[72:75], a[200:203], a[156:159], v[72:75]
M v[136:139], a[200:203], a[160:163], v[136:139]
M v[200:203], a[200:203], a[164:167], v[200:203]
T a[224:225], v24, 16384
T a[226:227], v24, 18432
WL 10
M v[76:79], a[204:207], a[156:159], v[76:79]
M v[140:143], a[204:207], a[160:163], v[140:143]
M v[204:207], a[204:207], a[164:167], v[204:207]
T a[228:229], v25, 16384
T a[230:231], v25, 18432
WL 10
M v[80:83], a[208:211], a[156:159], v[80:83]
M v[144:147], a[208:211], a[160:163], v[144:147]
T a[232:233], v26, 16384
T a[234:235], v26, 18432
WL 10
M v[84:87], a[212:215], a[156:159], v[84:87]
M v[148:151], a[212:215], a[160:163], v[148:151]
T a[236:237], v27, 16384
T a[238:239], v27, 18432
WL 10
M v[88:91], a[216:219], a[156:159], v[88:91]
M v[152:155], a[216:219], a[160:163], v[152:155]
T a[240:241], v28, 16384
T a[242:243], v28, 18432
WL 10
M v[92:95], a[220:223], a[156:159], v[92:95]
M v[156:159], a[220:223], a[160:163], v[156:159]
T a[244:245], v29, 16384
T a[246:247], v29, 18432
WL 10
M v[96:99], a[224:227], a[156:159], v[96:99]
M v[160:163], a[224:227], a[160:163], v[160:163]
T a[248:249], v30, 16384
T a[250:251], v30, 18432
WL 10
M v[100:103], a[228:231], a[156:159], v[100:103]
M v[164:167], a[228:231], a[160:163], v[164:167]
T a[252:253], v31, 16384
T a[254:255], v31, 18432
WL 10
M v[104:107], a[232:235], a[156:159], v[104:107]
M v[168:171], a[232:235], a[160:163], v[168:171]
s_waitcnt vmcnt(16)
s_barrier
R a[168:171], v10, 18432
R a[172:175], v10, 20480
R a[176:179], v12, 18432
R a[180:183], v11, 18432
R a[184:187], v11, 20480
R a[188:191], v13, 18432
T a[192:193], v16, 32768
T a[194:195], v16, 34816
WL 15
M v[108:111], a[236:239], a[156:159], v[108:111]
M v[172:175], a[236:239], a[160:163], v[172:175]
s_add_u32 s81, s78, 4
s_cmp_ge_u32 s81, 14
s_cselect_b32 s79, 14, 0
s_sub_u32 s81, s81, s79
s_lshl_b32 s81, s81, 6
s_add_u32 s81, s81, s89
s_add_u32 m0, s90, 114688
s_add_u32 s40, s81, 0
buffer_load_dwordx4 v14, s[8:11], s40 offen lds
T a[196:197], v17, 32768
T a[198:199], v17, 34816
WL 15
M v[112:115], a[240:243], a[156:159], v[112:115]
M v[176:179], a[240:243], a[160:163], v[176:179]
s_add_u32 m0, s90, 118784
s_add_u32 s40, s81, 28672
buffer_load_dwordx4 v14, s[8:11], s40 offen lds
T a[200:201], v18, 32768
T a[202:203], v18, 34816
WL 15
M v[116:119], a[244:247], a[156:159], v[116:119]
M v[180:183], a[244:247], a[160:163], v[180:183]
s_add_u32 m0, s90, 122880
s_add_u32 s40, s81, 57344
buffer_load_dwordx4 v14, s[8:11], s40 offen lds
T a[204:205], v19, 32768
T a[206:207], v19, 34816
WL 15
M v[120:123], a[248:251], a[156:159], v[120:123]
M v[184:187], a[248:251], a[160:163], v[184:187]
s_add_u32 m0, s90, 126976
s_add_u32 s40, s81, 86016
buffer_load_dwordx4 v14, s[8:11], s40 offen lds
T a[208:209], v20, 32768
T a[210:211], v20, 34816
WL 15
M v[124:127], a[252:255], a[156:159], v[124:127]
M v[188:191], a[252:255], a[160:163], v[188:191]
s_add_u32 m0, s91, 131072
s_add_u32 s40, s81, 114688
buffer_load_dwordx4 v14, s[8:11], s40 offen lds
T a[212:213], v21, 32768
T a[214:215], v21, 34816
WL 15
WL 10
M v[64:67], a[192:195], a[168:171], v[64:67]
M v[128:131], a[192:195], a[172:175], v[128:131]
M v[192:195], a[192:195], a[176:179], v[192:195]
s_add_u32 s80, s78, 4
s_cmp_ge_u32 s80, 14
s_cselect_b32 s79, 14, 0
s_sub_u32 s80, s80, s79
s_lshl_b32 s80, s80, 18
s_add_u32 m0, s54, 0
s_add_u32 s40, s80, 0
buffer_load_dwordx4 v8, s[20:23], s40 offen lds
T a[216:217], v22, 32768
T a[218:219], v22, 34816
WL 10
M v[68:71], a[196:199], a[168:171], v[68:71]
M v[132:135], a[196:199], a[172:175], v[132:135]
M v[196:199], a[196:199], a[176:179], v[196:199]
s_add_u32 m0, s54, 2048
s_add_u32 s40, s80, 32768
buffer_load_dwordx4 v8, s[20:23], s40 offen lds
T a[220:221], v23, 32768
T a[222:223], v23, 34816
WL 10
M v[72:75], a[200:203], a[168:171], v[72:75]
M v[136:139], a[200:203], a[172:175], v[136:139]
M v[200:203], a[200:203], a[176:179], v[200:203]
s_add_u32 m0, s54, 8192
s_add_u32 s40, s80, 131072
buffer_load_dwordx4 v8, s[20:23], s40 offen lds
T a[224:225], v24, 32768
T a[226:227], v24, 34816
WL 10
M v[76:79], a[204:207], a[168:171], v[76:79]
M v[140:143], a[204:207], a[172:175], v[140:143]
M v[204:207], a[204:207], a[176:179], v[204:207]
s_add_u32 m0, s54, 10240
s_add_u32 s40, s80, 163840
buffer_load_dwordx4 v8, s[20:23], s40 offen lds
T a[228:229], v25, 32768
T a[230:231], v25, 34816
WL 10
M v[80:83], a[208:211], a[168:171], v[80:83]
M v[144:147], a[208:211], a[172:175], v[144:147]
T a[232:233], v26, 32768
T a[234:235], v26, 34816
WL 10
M v[84:87], a[212:215], a[168:171], v[84:87]
M v[148:151], a[212:215], a[172:175], v[148:151]
T a[236:237], v27, 32768
T a[238:239], v27, 34816
WL 10
M v[88:91], a[216:219], a[168:171], v[88:91]
M v[152:155], a[216:219], a[172:175], v[152:155]
T a[240:241], v28, 32768
T a[242:243], v28, 34816
WL 10
M v[92:95], a[220:223], a[168:171], v[92:95]
M v[156:159], a[220:223], a[172:175], v[156:159]
T a[244:245], v29, 32768
T a[246:247], v29, 34816
WL 10
M v[96:99], a[224:227], a[168:171], v[96:99]
M v[160:163], a[224:227], a[172:175], v[160:163]
T a[248:249], v30, 32768
T a[250:251], v30, 34816
WL 10
M v[100:103], a[228:231], a[168:171], v[100:103]
M v[164:167], a[228:231], a[172:175], v[164:167]
T a[252:253], v31, 32768
T a[254:255], v31, 34816
WL 10
M v[104:107], a[232:235], a[168:171], v[104:107]
M v[168:171], a[232:235], a[172:175], v[168:171]
s_waitcnt vmcnt(21)
s_barrier
T a[192:193], v16, 49152
T a[194:195], v16, 51200
WL 10
M v[108:111], a[236:239], a[168:171], v[108:111]
M v[172:175], a[236:239], a[172:175], v[172:175]
s_add_u32 s80, s78, 5
s_cmp_ge_u32 s80, 14
s_cselect_b32 s79, 14, 0
s_sub_u32 s80, s80, s79
s_lshl_b32 s80, s80, 18
s_add_u32 m0, s54, 16384
s_add_u32 s40, s80, 0
buffer_load_dwordx4 v8, s[20:23], s40 offen lds
T a[196:197], v17, 49152
T a[198:199], v17, 51200
WL 10
M v[112:115], a[240:243], a[168:171], v[112:115]
M v[176:179], a[240:243], a[172:175], v[176:179]
s_add_u32 m0, s54, 18432
s_add_u32 s40, s80, 32768
buffer_load_dwordx4 v8, s[20:23], s40 offen lds
T a[200:201], v18, 49152
T a[202:203], v18, 51200
WL 10
M v[116:119], a[244:247], a[168:171], v[116:119]
M v[180:183], a[244:247], a[172:175], v[180:183]
s_add_u32 m0, s54, 24576
s_add_u32 s40, s80, 131072
buffer_load_dwordx4 v8, s[20:23], s40 offen lds
T a[204:205], v19, 49152
T a[206:207], v19, 51200
WL 10
M v[120:123], a[248:251], a[168:171], v[120:123]
M v[184:187], a[248:251], a[172:175], v[184:187]
s_add_u32 m0, s54, 26624
s_add_u32 s40, s80, 163840
buffer_load_dwordx4 v8, s[20:23], s40 offen lds
T a[208:209], v20, 49152
T a[210:211], v20, 51200
WL 10
M v[124:127], a[252:255], a[168:171], v[124:127]
M v[188:191], a[252:255], a[172:175], v[188:191]
T a[212:213], v21, 49152
T a[214:215], v21, 51200
WL 10
M v[64:67], a[192:195], a[180:183], v[64:67]
M v[128:131], a[192:195], a[184:187], v[128:131]
M v[192:195], a[192:195], a[188:191], v[192:195]
T a[216:217], v22, 49152
T a[218:219], v22, 51200
WL 10
M v[68:71], a[196:199], a[180:183], v[68:71]
M v[132:135], a[196:199], a[184:187], v[132:135]
M v[196:199], a[196:199], a[188:191], v[196:199]
T a[220:221], v23, 49152
T a[222:223], v23, 51200
WL 10
M v[72:75], a[200:203], a[180:183], v[72:75]
M v[136:139], a[200:203], a[184:187], v[136:139]
M v[200:203], a[200:203], a[188:191], v[200:203]
T a[224:225], v24, 49152
T a[226:227], v24, 51200
WL 10
M v[76:79], a[204:207], a[180:183], v[76:79]
M v[140:143], a[204:207], a[184:187], v[140:143]
M v[204:207], a[204:207], a[188:191], v[204:207]
T a[228:229], v25, 49152
T a[230:231], v25, 51200
WL 10
M v[80:83], a[208:211], a[180:183], v[80:83]
M v[144:147], a[208:211], a[184:187], v[144:147]
T a[232:233], v26, 49152
T a[234:235], v26, 51200
WL 10
M v[84:87], a[212:215], a[180:183], v[84:87]
M v[148:151], a[212:215], a[184:187], v[148:151]
T a[236:237], v27, 49152
T a[238:239], v27, 51200
WL 10
M v[88:91], a[216:219], a[180:183], v[88:91]
M v[152:155], a[216:219], a[184:187], v[152:155]
T a[240:241], v28, 49152
T a[242:243], v28, 51200
WL 10
M v[92:95], a[220:223], a[180:183], v[92:95]
M v[156:159], a[220:223], a[184:187], v[156:159]
T a[244:245], v29, 49152
T a[246:247], v29, 51200
WL 10
M v[96:99], a[224:227], a[180:183], v[96:99]
M v[160:163], a[224:227], a[184:187], v[160:163]
T a[248:249], v30, 49152
T a[250:251], v30, 51200
WL 10
M v[100:103], a[228:231], a[180:183], v[100:103]
M v[164:167], a[228:231], a[184:187], v[164:167]
T a[252:253], v31, 49152
T a[254:255], v31, 51200
WL 10
M v[104:107], a[232:235], a[180:183], v[104:107]
M v[168:171], a[232:235], a[184:187], v[168:171]
s_waitcnt vmcnt(4)
s_barrier
R a[144:147], v10, 0
R a[148:151], v10, 2048
R a[152:155], v12, 0
R a[156:159], v11, 0
R a[160:163], v11, 2048
R a[164:167], v13, 0
T a[192:193], v16, 0
T a[194:195], v16, 2048
WL 15
M v[108:111], a[236:239], a[180:183], v[108:111]
M v[172:175], a[236:239], a[184:187], v[172:175]
s_add_u32 s81, s78, 6
s_cmp_ge_u32 s81, 14
s_cselect_b32 s79, 14, 0
s_sub_u32 s81, s81, s79
s_lshl_b32 s81, s81, 6
s_add_u32 s81, s81, s89
s_add_u32 m0, s90, 133120
s_add_u32 s40, s81, 0
buffer_load_dwordx4 v14, s[8:11], s40 offen lds
T a[196:197], v17, 0
T a[198:199], v17, 2048
WL 15
M v[112:115], a[240:243], a[180:183], v[112:115]
M v[176:179], a[240:243], a[184:187], v[176:179]
s_add_u32 m0, s90, 137216
s_add_u32 s40, s81, 28672
buffer_load_dwordx4 v14, s[8:11], s40 offen lds
T a[200:201], v18, 0
T a[202:203], v18, 2048
WL 15
M v[116:119], a[244:247], a[180:183], v[116:119]
M v[180:183], a[244:247], a[184:187], v[180:183]
s_add_u32 m0, s90, 141312
s_add_u32 s40, s81, 57344
buffer_load_dwordx4 v14, s[8:11], s40 offen lds
T a[204:205], v19, 0
T a[206:207], v19, 2048
WL 15
M v[120:123], a[248:251], a[180:183], v[120:123]
M v[184:187], a[248:251], a[184:187], v[184:187]
s_add_u32 m0, s90, 145408
s_add_u32 s40, s81, 86016
buffer_load_dwordx4 v14, s[8:11], s40 offen lds
T a[208:209], v20, 0
T a[210:211], v20, 2048
WL 15
M v[124:127], a[252:255], a[180:183], v[124:127]
M v[188:191], a[252:255], a[184:187], v[188:191]
s_add_u32 m0, s91, 149504
s_add_u32 s40, s81, 114688
buffer_load_dwordx4 v14, s[8:11], s40 offen lds
T a[212:213], v21, 0
T a[214:215], v21, 2048
WL 15
WL 10
M v[64:67], a[192:195], a[144:147], v[64:67]
M v[128:131], a[192:195], a[148:151], v[128:131]
M v[192:195], a[192:195], a[152:155], v[192:195]
s_add_u32 s80, s78, 6
s_cmp_ge_u32 s80, 14
s_cselect_b32 s79, 14, 0
s_sub_u32 s80, s80, s79
s_lshl_b32 s80, s80, 18
s_add_u32 m0, s54, 32768
s_add_u32 s40, s80, 0
buffer_load_dwordx4 v8, s[20:23], s40 offen lds
T a[216:217], v22, 0
T a[218:219], v22, 2048
WL 10
M v[68:71], a[196:199], a[144:147], v[68:71]
M v[132:135], a[196:199], a[148:151], v[132:135]
M v[196:199], a[196:199], a[152:155], v[196:199]
s_add_u32 m0, s54, 34816
s_add_u32 s40, s80, 32768
buffer_load_dwordx4 v8, s[20:23], s40 offen lds
T a[220:221], v23, 0
T a[222:223], v23, 2048
WL 10
M v[72:75], a[200:203], a[144:147], v[72:75]
M v[136:139], a[200:203], a[148:151], v[136:139]
M v[200:203], a[200:203], a[152:155], v[200:203]
s_add_u32 m0, s54, 40960
s_add_u32 s40, s80, 131072
buffer_load_dwordx4 v8, s[20:23], s40 offen lds
T a[224:225], v24, 0
T a[226:227], v24, 2048
WL 10
M v[76:79], a[204:207], a[144:147], v[76:79]
M v[140:143], a[204:207], a[148:151], v[140:143]
M v[204:207], a[204:207], a[152:155], v[204:207]
s_add_u32 m0, s54, 43008
s_add_u32 s40, s80, 163840
buffer_load_dwordx4 v8, s[20:23], s40 offen lds
T a[228:229], v25, 0
T a[230:231], v25, 2048
WL 10
M v[80:83], a[208:211], a[144:147], v[80:83]
M v[144:147], a[208:211], a[148:151], v[144:147]
T a[232:233], v26, 0
T a[234:235], v26, 2048
WL 10
M v[84:87], a[212:215], a[144:147], v[84:87]
M v[148:151], a[212:215], a[148:151], v[148:151]
T a[236:237], v27, 0
T a[238:239], v27, 2048
WL 10
M v[88:91], a[216:219], a[144:147], v[88:91]
M v[152:155], a[216:219], a[148:151], v[152:155]
T a[240:241], v28, 0
T a[242:243], v28, 2048
WL 10
M v[92:95], a[220:223], a[144:147], v[92:95]
M v[156:159], a[220:223], a[148:151], v[156:159]
T a[244:245], v29, 0
T a[246:247], v29, 2048
WL 10
M v[96:99], a[224:227], a[144:147], v[96:99]
M v[160:163], a[224:227], a[148:151], v[160:163]
T a[248:249], v30, 0
T a[250:251], v30, 2048
WL 10
M v[100:103], a[228:231], a[144:147], v[100:103]
M v[164:167], a[228:231], a[148:151], v[164:167]
T a[252:253], v31, 0
T a[254:255], v31, 2048
WL 10
M v[104:107], a[232:235], a[144:147], v[104:107]
M v[168:171], a[232:235], a[148:151], v[168:171]
s_waitcnt vmcnt(9)
s_barrier
T a[192:193], v16, 16384
T a[194:195], v16, 18432
WL 10
M v[108:111], a[236:239], a[144:147], v[108:111]
M v[172:175], a[236:239], a[148:151], v[172:175]
s_add_u32 s80, s78, 7
s_cmp_ge_u32 s80, 14
s_cselect_b32 s79, 14, 0
s_sub_u32 s80, s80, s79
s_lshl_b32 s80, s80, 18
s_add_u32 m0, s54, 49152
s_add_u32 s40, s80, 0
buffer_load_dwordx4 v8, s[20:23], s40 offen lds
T a[196:197], v17, 16384
T a[198:199], v17, 18432
WL 10
M v[112:115], a[240:243], a[144:147], v[112:115]
M v[176:179], a[240:243], a[148:151], v[176:179]
s_add_u32 m0, s54, 51200
s_add_u32 s40, s80, 32768
buffer_load_dwordx4 v8, s[20:23], s40 offen lds
T a[200:201], v18, 16384
T a[202:203], v18, 18432
WL 10
M v[116:119], a[244:247], a[144:147], v[116:119]
M v[180:183], a[244:247], a[148:151], v[180:183]
s_add_u32 m0, s54, 57344
s_add_u32 s40, s80, 131072
buffer_load_dwordx4 v8, s[20:23], s40 offen lds
T a[204:205], v19, 16384
T a[206:207], v19, 18432
WL 10
M v[120:123], a[248:251], a[144:147], v[120:123]
M v[184:187], a[248:251], a[148:151], v[184:187]
s_add_u32 m0, s54, 59392
s_add_u32 s40, s80, 163840
buffer_load_dwordx4 v8, s[20:23], s40 offen lds
T a[208:209], v20, 16384
T a[210:211], v20, 18432
WL 10
M v[124:127], a[252:255], a[144:147], v[124:127]
M v[188:191], a[252:255], a[148:151], v[188:191]
T a[212:213], v21, 16384
T a[214:215], v21, 18432
WL 10
M v[64:67], a[192:195], a[156:159], v[64:67]
M v[128:131], a[192:195], a[160:163], v[128:131]
M v[192:195], a[192:195], a[164:167], v[192:195]
T a[216:217], v22, 16384
T a[218:219], v22, 18432
WL 10
M v[68:71], a[196:199], a[156:159], v[68:71]
M v[132:135], a[196:199], a[160:163], v[132:135]
M v[196:199], a[196:199], a[164:167], v[196:199]
T a[220:221], v23, 16384
T a[222:223], v23, 18432
WL 10
M v[72:75], a[200:203], a[156:159], v[72:75]
M v[136:139], a[200:203], a[160:163], v[136:139]
M v[200:203], a[200:203], a[164:167], v[200:203]
T a[224:225], v24, 16384
T a[226:227], v24, 18432
WL 10
M v[76:79], a[204:207], a[156:159], v[76:79]
M v[140:143], a[204:207], a[160:163], v[140:143]
M v[204:207], a[204:207], a[164:167], v[204:207]
T a[228:229], v25, 16384
T a[230:231], v25, 18432
WL 10
M v[80:83], a[208:211], a[156:159], v[80:83]
M v[144:147], a[208:211], a[160:163], v[144:147]
T a[232:233], v26, 16384
T a[234:235], v26, 18432
WL 10
M v[84:87], a[212:215], a[156:159], v[84:87]
M v[148:151], a[212:215], a[160:163], v[148:151]
T a[236:237], v27, 16384
T a[238:239], v27, 18432
WL 10
M v[88:91], a[216:219], a[156:159], v[88:91]
M v[152:155], a[216:219], a[160:163], v[152:155]
T a[240:241], v28, 16384
T a[242:243], v28, 18432
WL 10
M v[92:95], a[220:223], a[156:159], v[92:95]
M v[156:159], a[220:223], a[160:163], v[156:159]
T a[244:245], v29, 16384
T a[246:247], v29, 18432
WL 10
M v[96:99], a[224:227], a[156:159], v[96:99]
M v[160:163], a[224:227], a[160:163], v[160:163]
T a[248:249], v30, 16384
T a[250:251], v30, 18432
WL 10
M v[100:103], a[228:231], a[156:159], v[100:103]
M v[164:167], a[228:231], a[160:163], v[164:167]
T a[252:253], v31, 16384
T a[254:255], v31, 18432
WL 10
M v[104:107], a[232:235], a[156:159], v[104:107]
M v[168:171], a[232:235], a[160:163], v[168:171]
s_waitcnt vmcnt(4)
s_barrier
R a[168:171], v10, 18432
R a[172:175], v10, 20480
R a[176:179], v12, 18432
R a[180:183], v11, 18432
R a[184:187], v11, 20480
R a[188:191], v13, 18432
T a[192:193], v16, 32768
T a[194:195], v16, 34816
WL 15
M v[108:111], a[236:239], a[156:159], v[108:111]
M v[172:175], a[236:239], a[160:163], v[172:175]
s_add_u32 s81, s78, 8
s_cmp_ge_u32 s81, 14
s_cselect_b32 s79, 14, 0
s_sub_u32 s81, s81, s79
s_lshl_b32 s81, s81, 6
s_add_u32 s81, s81, s89
s_add_u32 m0, s90, 114688
s_add_u32 s40, s81, 0
buffer_load_dwordx4 v14, s[8:11], s40 offen lds
T a[196:197], v17, 32768
T a[198:199], v17, 34816
WL 15
M v[112:115], a[240:243], a[156:159], v[112:115]
M v[176:179], a[240:243], a[160:163], v[176:179]
s_add_u32 m0, s90, 118784
s_add_u32 s40, s81, 28672
buffer_load_dwordx4 v14, s[8:11], s40 offen lds
T a[200:201], v18, 32768
T a[202:203], v18, 34816
WL 15
M v[116:119], a[244:247], a[156:159], v[116:119]
M v[180:183], a[244:247], a[160:163], v[180:183]
s_add_u32 m0, s90, 122880
s_add_u32 s40, s81, 57344
buffer_load_dwordx4 v14, s[8:11], s40 offen lds
T a[204:205], v19, 32768
T a[206:207], v19, 34816
WL 15
M v[120:123], a[248:251], a[156:159], v[120:123]
M v[184:187], a[248:251], a[160:163], v[184:187]
s_add_u32 m0, s90, 126976
s_add_u32 s40, s81, 86016
buffer_load_dwordx4 v14, s[8:11], s40 offen lds
T a[208:209], v20, 32768
T a[210:211], v20, 34816
WL 15
M v[124:127], a[252:255], a[156:159], v[124:127]
M v[188:191], a[252:255], a[160:163], v[188:191]
s_add_u32 m0, s91, 131072
s_add_u32 s40, s81, 114688
buffer_load_dwordx4 v14, s[8:11], s40 offen lds
T a[212:213], v21, 32768
T a[214:215], v21, 34816
WL 15
WL 10
M v[64:67], a[192:195], a[168:171], v[64:67]
M v[128:131], a[192:195], a[172:175], v[128:131]
M v[192:195], a[192:195], a[176:179], v[192:195]
s_add_u32 s80, s78, 8
s_cmp_ge_u32 s80, 14
s_cselect_b32 s79, 14, 0
s_sub_u32 s80, s80, s79
s_lshl_b32 s80, s80, 18
s_add_u32 m0, s54, 0
s_add_u32 s40, s80, 0
buffer_load_dwordx4 v8, s[20:23], s40 offen lds
T a[216:217], v22, 32768
T a[218:219], v22, 34816
WL 10
M v[68:71], a[196:199], a[168:171], v[68:71]
M v[132:135], a[196:199], a[172:175], v[132:135]
M v[196:199], a[196:199], a[176:179], v[196:199]
s_add_u32 m0, s54, 2048
s_add_u32 s40, s80, 32768
buffer_load_dwordx4 v8, s[20:23], s40 offen lds
T a[220:221], v23, 32768
T a[222:223], v23, 34816
WL 10
M v[72:75], a[200:203], a[168:171], v[72:75]
M v[136:139], a[200:203], a[172:175], v[136:139]
M v[200:203], a[200:203], a[176:179], v[200:203]
s_add_u32 m0, s54, 8192
s_add_u32 s40, s80, 131072
buffer_load_dwordx4 v8, s[20:23], s40 offen lds
T a[224:225], v24, 32768
T a[226:227], v24, 34816
WL 10
M v[76:79], a[204:207], a[168:171], v[76:79]
M v[140:143], a[204:207], a[172:175], v[140:143]
M v[204:207], a[204:207], a[176:179], v[204:207]
s_add_u32 m0, s54, 10240
s_add_u32 s40, s80, 163840
buffer_load_dwordx4 v8, s[20:23], s40 offen lds
T a[228:229], v25, 32768
T a[230:231], v25, 34816
WL 10
M v[80:83], a[208:211], a[168:171], v[80:83]
M v[144:147], a[208:211], a[172:175], v[144:147]
T a[232:233], v26, 32768
T a[234:235], v26, 34816
WL 10
M v[84:87], a[212:215], a[168:171], v[84:87]
M v[148:151], a[212:215], a[172:175], v[148:151]
T a[236:237], v27, 32768
T a[238:239], v27, 34816
WL 10
M v[88:91], a[216:219], a[168:171], v[88:91]
M v[152:155], a[216:219], a[172:175], v[152:155]
T a[240:241], v28, 32768
T a[242:243], v28, 34816
WL 10
M v[92:95], a[220:223], a[168:171], v[92:95]
M v[156:159], a[220:223], a[172:175], v[156:159]
T a[244:245], v29, 32768
T a[246:247], v29, 34816
WL 10
M v[96:99], a[224:227], a[168:171], v[96:99]
M v[160:163], a[224:227], a[172:175], v[160:163]
T a[248:249], v30, 32768
T a[250:251], v30, 34816
WL 10
M v[100:103], a[228:231], a[168:171], v[100:103]
M v[164:167], a[228:231], a[172:175], v[164:167]
T a[252:253], v31, 32768
T a[254:255], v31, 34816
WL 10
M v[104:107], a[232:235], a[168:171], v[104:107]
M v[168:171], a[232:235], a[172:175], v[168:171]
s_waitcnt vmcnt(9)
s_barrier
T a[192:193], v16, 49152
T a[194:195], v16, 51200
WL 10
M v[108:111], a[236:239], a[168:171], v[108:111]
M v[172:175], a[236:239], a[172:175], v[172:175]
s_add_u32 s80, s78, 9
s_cmp_ge_u32 s80, 14
s_cselect_b32 s79, 14, 0
s_sub_u32 s80, s80, s79
s_lshl_b32 s80, s80, 18
s_add_u32 m0, s54, 16384
s_add_u32 s40, s80, 0
buffer_load_dwordx4 v8, s[20:23], s40 offen lds
T a[196:197], v17, 49152
T a[198:199], v17, 51200
WL 10
M v[112:115], a[240:243], a[168:171], v[112:115]
M v[176:179], a[240:243], a[172:175], v[176:179]
s_add_u32 m0, s54, 18432
s_add_u32 s40, s80, 32768
buffer_load_dwordx4 v8, s[20:23], s40 offen lds
T a[200:201], v18, 49152
T a[202:203], v18, 51200
WL 10
M v[116:119], a[244:247], a[168:171], v[116:119]
M v[180:183], a[244:247], a[172:175], v[180:183]
s_add_u32 m0, s54, 24576
s_add_u32 s40, s80, 131072
buffer_load_dwordx4 v8, s[20:23], s40 offen lds
T a[204:205], v19, 49152
T a[206:207], v19, 51200
WL 10
M v[120:123], a[248:251], a[168:171], v[120:123]
M v[184:187], a[248:251], a[172:175], v[184:187]
s_add_u32 m0, s54, 26624
s_add_u32 s40, s80, 163840
buffer_load_dwordx4 v8, s[20:23], s40 offen lds
T a[208:209], v20, 49152
T a[210:211], v20, 51200
WL 10
M v[124:127], a[252:255], a[168:171], v[124:127]
M v[188:191], a[252:255], a[172:175], v[188:191]
T a[212:213], v21, 49152
T a[214:215], v21, 51200
WL 10
M v[64:67], a[192:195], a[180:183], v[64:67]
M v[128:131], a[192:195], a[184:187], v[128:131]
M v[192:195], a[192:195], a[188:191], v[192:195]
T a[216:217], v22, 49152
T a[218:219], v22, 51200
WL 10
M v[68:71], a[196:199], a[180:183], v[68:71]
M v[132:135], a[196:199], a[184:187], v[132:135]
M v[196:199], a[196:199], a[188:191], v[196:199]
T a[220:221], v23, 49152
T a[222:223], v23, 51200
WL 10
M v[72:75], a[200:203], a[180:183], v[72:75]
M v[136:139], a[200:203], a[184:187], v[136:139]
M v[200:203], a[200:203], a[188:191], v[200:203]
T a[224:225], v24, 49152
T a[226:227], v24, 51200
WL 10
M v[76:79], a[204:207], a[180:183], v[76:79]
M v[140:143], a[204:207], a[184:187], v[140:143]
M v[204:207], a[204:207], a[188:191], v[204:207]
T a[228:229], v25, 49152
T a[230:231], v25, 51200
WL 10
M v[80:83], a[208:211], a[180:183], v[80:83]
M v[144:147], a[208:211], a[184:187], v[144:147]
T a[232:233], v26, 49152
T a[234:235], v26, 51200
WL 10
M v[84:87], a[212:215], a[180:183], v[84:87]
M v[148:151], a[212:215], a[184:187], v[148:151]
T a[236:237], v27, 49152
T a[238:239], v27, 51200
WL 10
M v[88:91], a[216:219], a[180:183], v[88:91]
M v[152:155], a[216:219], a[184:187], v[152:155]
T a[240:241], v28, 49152
T a[242:243], v28, 51200
WL 10
M v[92:95], a[220:223], a[180:183], v[92:95]
M v[156:159], a[220:223], a[184:187], v[156:159]
T a[244:245], v29, 49152
T a[246:247], v29, 51200
WL 10
M v[96:99], a[224:227], a[180:183], v[96:99]
M v[160:163], a[224:227], a[184:187], v[160:163]
T a[248:249], v30, 49152
T a[250:251], v30, 51200
WL 10
M v[100:103], a[228:231], a[180:183], v[100:103]
M v[164:167], a[228:231], a[184:187], v[164:167]
T a[252:253], v31, 49152
T a[254:255], v31, 51200
WL 10
M v[104:107], a[232:235], a[180:183], v[104:107]
M v[168:171], a[232:235], a[184:187], v[168:171]
s_waitcnt vmcnt(4)
s_barrier
R a[144:147], v10, 0
R a[148:151], v10, 2048
R a[152:155], v12, 0
R a[156:159], v11, 0
R a[160:163], v11, 2048
R a[164:167], v13, 0
T a[192:193], v16, 0
T a[194:195], v16, 2048
WL 15
M v[108:111], a[236:239], a[180:183], v[108:111]
M v[172:175], a[236:239], a[184:187], v[172:175]
s_add_u32 s81, s78, 10
s_cmp_ge_u32 s81, 14
s_cselect_b32 s79, 14, 0
s_sub_u32 s81, s81, s79
s_lshl_b32 s81, s81, 6
s_add_u32 s81, s81, s89
s_add_u32 m0, s90, 133120
s_add_u32 s40, s81, 0
buffer_load_dwordx4 v14, s[8:11], s40 offen lds
T a[196:197], v17, 0
T a[198:199], v17, 2048
WL 15
M v[112:115], a[240:243], a[180:183], v[112:115]
M v[176:179], a[240:243], a[184:187], v[176:179]
s_add_u32 m0, s90, 137216
s_add_u32 s40, s81, 28672
buffer_load_dwordx4 v14, s[8:11], s40 offen lds
T a[200:201], v18, 0
T a[202:203], v18, 2048
WL 15
M v[116:119], a[244:247], a[180:183], v[116:119]
M v[180:183], a[244:247], a[184:187], v[180:183]
s_add_u32 m0, s90, 141312
s_add_u32 s40, s81, 57344
buffer_load_dwordx4 v14, s[8:11], s40 offen lds
T a[204:205], v19, 0
T a[206:207], v19, 2048
WL 15
M v[120:123], a[248:251], a[180:183], v[120:123]
M v[184:187], a[248:251], a[184:187], v[184:187]
s_add_u32 m0, s90, 145408
s_add_u32 s40, s81, 86016
buffer_load_dwordx4 v14, s[8:11], s40 offen lds
T a[208:209], v20, 0
T a[210:211], v20, 2048
WL 15
M v[124:127], a[252:255], a[180:183], v[124:127]
M v[188:191], a[252:255], a[184:187], v[188:191]
s_add_u32 m0, s91, 149504
s_add_u32 s40, s81, 114688
buffer_load_dwordx4 v14, s[8:11], s40 offen lds
T a[212:213], v21, 0
T a[214:215], v21, 2048
WL 15
WL 10
M v[64:67], a[192:195], a[144:147], v[64:67]
M v[128:131], a[192:195], a[148:151], v[128:131]
M v[192:195], a[192:195], a[152:155], v[192:195]
s_add_u32 s80, s78, 10
s_cmp_ge_u32 s80, 14
s_cselect_b32 s79, 14, 0
s_sub_u32 s80, s80, s79
s_lshl_b32 s80, s80, 18
s_add_u32 m0, s54, 32768
s_add_u32 s40, s80, 0
buffer_load_dwordx4 v8, s[20:23], s40 offen lds
T a[216:217], v22, 0
T a[218:219], v22, 2048
WL 10
M v[68:71], a[196:199], a[144:147], v[68:71]
M v[132:135], a[196:199], a[148:151], v[132:135]
M v[196:199], a[196:199], a[152:155], v[196:199]
s_add_u32 m0, s54, 34816
s_add_u32 s40, s80, 32768
buffer_load_dwordx4 v8, s[20:23], s40 offen lds
T a[220:221], v23, 0
T a[222:223], v23, 2048
WL 10
M v[72:75], a[200:203], a[144:147], v[72:75]
M v[136:139], a[200:203], a[148:151], v[136:139]
M v[200:203], a[200:203], a[152:155], v[200:203]
s_add_u32 m0, s54, 40960
s_add_u32 s40, s80, 131072
buffer_load_dwordx4 v8, s[20:23], s40 offen lds
T a[224:225], v24, 0
T a[226:227], v24, 2048
WL 10
M v[76:79], a[204:207], a[144:147], v[76:79]
M v[140:143], a[204:207], a[148:151], v[140:143]
M v[204:207], a[204:207], a[152:155], v[204:207]
s_add_u32 m0, s54, 43008
s_add_u32 s40, s80, 163840
buffer_load_dwordx4 v8, s[20:23], s40 offen lds
T a[228:229], v25, 0
T a[230:231], v25, 2048
WL 10
M v[80:83], a[208:211], a[144:147], v[80:83]
M v[144:147], a[208:211], a[148:151], v[144:147]
T a[232:233], v26, 0
T a[234:235], v26, 2048
WL 10
M v[84:87], a[212:215], a[144:147], v[84:87]
M v[148:151], a[212:215], a[148:151], v[148:151]
T a[236:237], v27, 0
T a[238:239], v27, 2048
WL 10
M v[88:91], a[216:219], a[144:147], v[88:91]
M v[152:155], a[216:219], a[148:151], v[152:155]
T a[240:241], v28, 0
T a[242:243], v28, 2048
WL 10
M v[92:95], a[220:223], a[144:147], v[92:95]
M v[156:159], a[220:223], a[148:151], v[156:159]
T a[244:245], v29, 0
T a[246:247], v29, 2048
WL 10
M v[96:99], a[224:227], a[144:147], v[96:99]
M v[160:163], a[224:227], a[148:151], v[160:163]
T a[248:249], v30, 0
T a[250:251], v30, 2048
WL 10
M v[100:103], a[228:231], a[144:147], v[100:103]
M v[164:167], a[228:231], a[148:151], v[164:167]
T a[252:253], v31, 0
T a[254:255], v31, 2048
WL 10
M v[104:107], a[232:235], a[144:147], v[104:107]
M v[168:171], a[232:235], a[148:151], v[168:171]
s_waitcnt vmcnt(9)
s_barrier
T a[192:193], v16, 16384
T a[194:195], v16, 18432
WL 10
M v[108:111], a[236:239], a[144:147], v[108:111]
M v[172:175], a[236:239], a[148:151], v[172:175]
s_add_u32 s80, s78, 11
s_cmp_ge_u32 s80, 14
s_cselect_b32 s79, 14, 0
s_sub_u32 s80, s80, s79
s_lshl_b32 s80, s80, 18
s_add_u32 m0, s54, 49152
s_add_u32 s40, s80, 0
buffer_load_dwordx4 v8, s[20:23], s40 offen lds
T a[196:197], v17, 16384
T a[198:199], v17, 18432
WL 10
M v[112:115], a[240:243], a[144:147], v[112:115]
M v[176:179], a[240:243], a[148:151], v[176:179]
s_add_u32 m0, s54, 51200
s_add_u32 s40, s80, 32768
buffer_load_dwordx4 v8, s[20:23], s40 offen lds
T a[200:201], v18, 16384
T a[202:203], v18, 18432
WL 10
M v[116:119], a[244:247], a[144:147], v[116:119]
M v[180:183], a[244:247], a[148:151], v[180:183]
s_add_u32 m0, s54, 57344
s_add_u32 s40, s80, 131072
buffer_load_dwordx4 v8, s[20:23], s40 offen lds
T a[204:205], v19, 16384
T a[206:207], v19, 18432
WL 10
M v[120:123], a[248:251], a[144:147], v[120:123]
M v[184:187], a[248:251], a[148:151], v[184:187]
s_add_u32 m0, s54, 59392
s_add_u32 s40, s80, 163840
buffer_load_dwordx4 v8, s[20:23], s40 offen lds
T a[208:209], v20, 16384
T a[210:211], v20, 18432
WL 10
M v[124:127], a[252:255], a[144:147], v[124:127]
M v[188:191], a[252:255], a[148:151], v[188:191]
T a[212:213], v21, 16384
T a[214:215], v21, 18432
WL 10
M v[64:67], a[192:195], a[156:159], v[64:67]
M v[128:131], a[192:195], a[160:163], v[128:131]
M v[192:195], a[192:195], a[164:167], v[192:195]
T a[216:217], v22, 16384
T a[218:219], v22, 18432
WL 10
M v[68:71], a[196:199], a[156:159], v[68:71]
M v[132:135], a[196:199], a[160:163], v[132:135]
M v[196:199], a[196:199], a[164:167], v[196:199]
T a[220:221], v23, 16384
T a[222:223], v23, 18432
WL 10
M v[72:75], a[200:203], a[156:159], v[72:75]
M v[136:139], a[200:203], a[160:163], v[136:139]
M v[200:203], a[200:203], a[164:167], v[200:203]
T a[224:225], v24, 16384
T a[226:227], v24, 18432
WL 10
M v[76:79], a[204:207], a[156:159], v[76:79]
M v[140:143], a[204:207], a[160:163], v[140:143]
M v[204:207], a[204:207], a[164:167], v[204:207]
T a[228:229], v25, 16384
T a[230:231], v25, 18432
WL 10
M v[80:83], a[208:211], a[156:159], v[80:83]
M v[144:147], a[208:211], a[160:163], v[144:147]
T a[232:233], v26, 16384
T a[234:235], v26, 18432
WL 10
M v[84:87], a[212:215], a[156:159], v[84:87]
M v[148:151], a[212:215], a[160:163], v[148:151]
T a[236:237], v27, 16384
T a[238:239], v27, 18432
WL 10
M v[88:91], a[216:219], a[156:159], v[88:91]
M v[152:155], a[216:219], a[160:163], v[152:155]
T a[240:241], v28, 16384
T a[242:243], v28, 18432
WL 10
M v[92:95], a[220:223], a[156:159], v[92:95]
M v[156:159], a[220:223], a[160:163], v[156:159]
T a[244:245], v29, 16384
T a[246:247], v29, 18432
WL 10
M v[96:99], a[224:227], a[156:159], v[96:99]
M v[160:163], a[224:227], a[160:163], v[160:163]
T a[248:249], v30, 16384
T a[250:251], v30, 18432
WL 10
M v[100:103], a[228:231], a[156:159], v[100:103]
M v[164:167], a[228:231], a[160:163], v[164:167]
T a[252:253], v31, 16384
T a[254:255], v31, 18432
WL 10
M v[104:107], a[232:235], a[156:159], v[104:107]
M v[168:171], a[232:235], a[160:163], v[168:171]
s_waitcnt vmcnt(4)
s_barrier
R a[168:171], v10, 18432
R a[172:175], v10, 20480
R a[176:179], v12, 18432
R a[180:183], v11, 18432
R a[184:187], v11, 20480
R a[188:191], v13, 18432
T a[192:193], v16, 32768
T a[194:195], v16, 34816
WL 15
M v[108:111], a[236:239], a[156:159], v[108:111]
M v[172:175], a[236:239], a[160:163], v[172:175]
s_add_u32 s81, s78, 12
s_cmp_ge_u32 s81, 14
s_cselect_b32 s79, 14, 0
s_sub_u32 s81, s81, s79
s_lshl_b32 s81, s81, 6
s_add_u32 s81, s81, s89
s_add_u32 m0, s90, 114688
s_add_u32 s40, s81, 0
buffer_load_dwordx4 v14, s[8:11], s40 offen lds
T a[196:197], v17, 32768
T a[198:199], v17, 34816
WL 15
M v[112:115], a[240:243], a[156:159], v[112:115]
M v[176:179], a[240:243], a[160:163], v[176:179]
s_add_u32 m0, s90, 118784
s_add_u32 s40, s81, 28672
buffer_load_dwordx4 v14, s[8:11], s40 offen lds
T a[200:201], v18, 32768
T a[202:203], v18, 34816
WL 15
M v[116:119], a[244:247], a[156:159], v[116:119]
M v[180:183], a[244:247], a[160:163], v[180:183]
s_add_u32 m0, s90, 122880
s_add_u32 s40, s81, 57344
buffer_load_dwordx4 v14, s[8:11], s40 offen lds
T a[204:205], v19, 32768
T a[206:207], v19, 34816
WL 15
M v[120:123], a[248:251], a[156:159], v[120:123]
M v[184:187], a[248:251], a[160:163], v[184:187]
s_add_u32 m0, s90, 126976
s_add_u32 s40, s81, 86016
buffer_load_dwordx4 v14, s[8:11], s40 offen lds
T a[208:209], v20, 32768
T a[210:211], v20, 34816
WL 15
M v[124:127], a[252:255], a[156:159], v[124:127]
M v[188:191], a[252:255], a[160:163], v[188:191]
s_add_u32 m0, s91, 131072
s_add_u32 s40, s81, 114688
buffer_load_dwordx4 v14, s[8:11], s40 offen lds
T a[212:213], v21, 32768
T a[214:215], v21, 34816
WL 15
WL 10
M v[64:67], a[192:195], a[168:171], v[64:67]
M v[128:131], a[192:195], a[172:175], v[128:131]
M v[192:195], a[192:195], a[176:179], v[192:195]
s_add_u32 s80, s78, 12
s_cmp_ge_u32 s80, 14
s_cselect_b32 s79, 14, 0
s_sub_u32 s80, s80, s79
s_lshl_b32 s80, s80, 18
s_add_u32 m0, s54, 0
s_add_u32 s40, s80, 0
buffer_load_dwordx4 v8, s[20:23], s40 offen lds
T a[216:217], v22, 32768
T a[218:219], v22, 34816
WL 10
M v[68:71], a[196:199], a[168:171], v[68:71]
M v[132:135], a[196:199], a[172:175], v[132:135]
M v[196:199], a[196:199], a[176:179], v[196:199]
s_add_u32 m0, s54, 2048
s_add_u32 s40, s80, 32768
buffer_load_dwordx4 v8, s[20:23], s40 offen lds
T a[220:221], v23, 32768
T a[222:223], v23, 34816
WL 10
M v[72:75], a[200:203], a[168:171], v[72:75]
M v[136:139], a[200:203], a[172:175], v[136:139]
M v[200:203], a[200:203], a[176:179], v[200:203]
s_add_u32 m0, s54, 8192
s_add_u32 s40, s80, 131072
buffer_load_dwordx4 v8, s[20:23], s40 offen lds
T a[224:225], v24, 32768
T a[226:227], v24, 34816
WL 10
M v[76:79], a[204:207], a[168:171], v[76:79]
M v[140:143], a[204:207], a[172:175], v[140:143]
M v[204:207], a[204:207], a[176:179], v[204:207]
s_add_u32 m0, s54, 10240
s_add_u32 s40, s80, 163840
buffer_load_dwordx4 v8, s[20:23], s40 offen lds
T a[228:229], v25, 32768
T a[230:231], v25, 34816
WL 10
M v[80:83], a[208:211], a[168:171], v[80:83]
M v[144:147], a[208:211], a[172:175], v[144:147]
T a[232:233], v26, 32768
T a[234:235], v26, 34816
WL 10
M v[84:87], a[212:215], a[168:171], v[84:87]
M v[148:151], a[212:215], a[172:175], v[148:151]
T a[236:237], v27, 32768
T a[238:239], v27, 34816
WL 10
M v[88:91], a[216:219], a[168:171], v[88:91]
M v[152:155], a[216:219], a[172:175], v[152:155]
T a[240:241], v28, 32768
T a[242:243], v28, 34816
WL 10
M v[92:95], a[220:223], a[168:171], v[92:95]
M v[156:159], a[220:223], a[172:175], v[156:159]
T a[244:245], v29, 32768
T a[246:247], v29, 34816
WL 10
M v[96:99], a[224:227], a[168:171], v[96:99]
M v[160:163], a[224:227], a[172:175], v[160:163]
T a[248:249], v30, 32768
T a[250:251], v30, 34816
WL 10
M v[100:103], a[228:231], a[168:171], v[100:103]
M v[164:167], a[228:231], a[172:175], v[164:167]
T a[252:253], v31, 32768
T a[254:255], v31, 34816
WL 10
M v[104:107], a[232:235], a[168:171], v[104:107]
M v[168:171], a[232:235], a[172:175], v[168:171]
s_waitcnt vmcnt(9)
s_barrier
T a[192:193], v16, 49152
T a[194:195], v16, 51200
WL 10
M v[108:111], a[236:239], a[168:171], v[108:111]
M v[172:175], a[236:239], a[172:175], v[172:175]
s_add_u32 s80, s78, 13
s_cmp_ge_u32 s80, 14
s_cselect_b32 s79, 14, 0
s_sub_u32 s80, s80, s79
s_lshl_b32 s80, s80, 18
s_add_u32 m0, s54, 16384
s_add_u32 s40, s80, 0
buffer_load_dwordx4 v8, s[20:23], s40 offen lds
T a[196:197], v17, 49152
T a[198:199], v17, 51200
WL 10
M v[112:115], a[240:243], a[168:171], v[112:115]
M v[176:179], a[240:243], a[172:175], v[176:179]
s_add_u32 m0, s54, 18432
s_add_u32 s40, s80, 32768
buffer_load_dwordx4 v8, s[20:23], s40 offen lds
T a[200:201], v18, 49152
T a[202:203], v18, 51200
WL 10
M v[116:119], a[244:247], a[168:171], v[116:119]
M v[180:183], a[244:247], a[172:175], v[180:183]
s_add_u32 m0, s54, 24576
s_add_u32 s40, s80, 131072
buffer_load_dwordx4 v8, s[20:23], s40 offen lds
T a[204:205], v19, 49152
T a[206:207], v19, 51200
WL 10
M v[120:123], a[248:251], a[168:171], v[120:123]
M v[184:187], a[248:251], a[172:175], v[184:187]
s_add_u32 m0, s54, 26624
s_add_u32 s40, s80, 163840
buffer_load_dwordx4 v8, s[20:23], s40 offen lds
T a[208:209], v20, 49152
T a[210:211], v20, 51200
WL 10
M v[124:127], a[252:255], a[168:171], v[124:127]
M v[188:191], a[252:255], a[172:175], v[188:191]
T a[212:213], v21, 49152
T a[214:215], v21, 51200
WL 10
M v[64:67], a[192:195], a[180:183], v[64:67]
M v[128:131], a[192:195], a[184:187], v[128:131]
M v[192:195], a[192:195], a[188:191], v[192:195]
T a[216:217], v22, 49152
T a[218:219], v22, 51200
WL 10
M v[68:71], a[196:199], a[180:183], v[68:71]
M v[132:135], a[196:199], a[184:187], v[132:135]
M v[196:199], a[196:199], a[188:191], v[196:199]
T a[220:221], v23, 49152
T a[222:223], v23, 51200
WL 10
M v[72:75], a[200:203], a[180:183], v[72:75]
M v[136:139], a[200:203], a[184:187], v[136:139]
M v[200:203], a[200:203], a[188:191], v[200:203]
T a[224:225], v24, 49152
T a[226:227], v24, 51200
WL 10
M v[76:79], a[204:207], a[180:183], v[76:79]
M v[140:143], a[204:207], a[184:187], v[140:143]
M v[204:207], a[204:207], a[188:191], v[204:207]
T a[228:229], v25, 49152
T a[230:231], v25, 51200
WL 10
M v[80:83], a[208:211], a[180:183], v[80:83]
M v[144:147], a[208:211], a[184:187], v[144:147]
T a[232:233], v26, 49152
T a[234:235], v26, 51200
WL 10
M v[84:87], a[212:215], a[180:183], v[84:87]
M v[148:151], a[212:215], a[184:187], v[148:151]
T a[236:237], v27, 49152
T a[238:239], v27, 51200
WL 10
M v[88:91], a[216:219], a[180:183], v[88:91]
M v[152:155], a[216:219], a[184:187], v[152:155]
T a[240:241], v28, 49152
T a[242:243], v28, 51200
WL 10
M v[92:95], a[220:223], a[180:183], v[92:95]
M v[156:159], a[220:223], a[184:187], v[156:159]
T a[244:245], v29, 49152
T a[246:247], v29, 51200
WL 10
M v[96:99], a[224:227], a[180:183], v[96:99]
M v[160:163], a[224:227], a[184:187], v[160:163]
T a[248:249], v30, 49152
T a[250:251], v30, 51200
WL 10
M v[100:103], a[228:231], a[180:183], v[100:103]
M v[164:167], a[228:231], a[184:187], v[164:167]
T a[252:253], v31, 49152
T a[254:255], v31, 51200
WL 10
M v[104:107], a[232:235], a[180:183], v[104:107]
M v[168:171], a[232:235], a[184:187], v[168:171]
s_waitcnt vmcnt(4)
s_barrier
R a[144:147], v10, 0
R a[148:151], v10, 2048
R a[152:155], v12, 0
R a[156:159], v11, 0
R a[160:163], v11, 2048
R a[164:167], v13, 0
T a[192:193], v16, 0
T a[194:195], v16, 2048
WL 15
M v[108:111], a[236:239], a[180:183], v[108:111]
M v[172:175], a[236:239], a[184:187], v[172:175]
s_add_u32 m0, s55, 32768
s_mov_b32 s40, 49152
buffer_load_dwordx4 v9, s[12:15], s40 offen nt lds
T a[196:197], v17, 0
T a[198:199], v17, 2048
WL 15
M v[112:115], a[240:243], a[180:183], v[112:115]
M v[176:179], a[240:243], a[184:187], v[176:179]
s_add_u32 m0, s55, 36864
s_mov_b32 s40, 53248
buffer_load_dwordx4 v9, s[12:15], s40 offen nt lds
T a[200:201], v18, 0
T a[202:203], v18, 2048
WL 15
M v[116:119], a[244:247], a[180:183], v[116:119]
M v[180:183], a[244:247], a[184:187], v[180:183]
s_add_u32 m0, s55, 40960
s_mov_b32 s40, 57344
buffer_load_dwordx4 v9, s[12:15], s40 offen nt lds
T a[204:205], v19, 0
T a[206:207], v19, 2048
WL 15
M v[120:123], a[248:251], a[180:183], v[120:123]
M v[184:187], a[248:251], a[184:187], v[184:187]
s_add_u32 m0, s55, 45056
s_mov_b32 s40, 61440
buffer_load_dwordx4 v9, s[12:15], s40 offen nt lds
T a[208:209], v20, 0
T a[210:211], v20, 2048
WL 15
M v[124:127], a[252:255], a[180:183], v[124:127]
M v[188:191], a[252:255], a[184:187], v[188:191]
T a[212:213], v21, 0
T a[214:215], v21, 2048
WL 15
WL 10
M v[64:67], a[192:195], a[144:147], v[64:67]
M v[128:131], a[192:195], a[148:151], v[128:131]
M v[192:195], a[192:195], a[152:155], v[192:195]
T a[216:217], v22, 0
T a[218:219], v22, 2048
WL 10
M v[68:71], a[196:199], a[144:147], v[68:71]
M v[132:135], a[196:199], a[148:151], v[132:135]
M v[196:199], a[196:199], a[152:155], v[196:199]
T a[220:221], v23, 0
T a[222:223], v23, 2048
WL 10
M v[72:75], a[200:203], a[144:147], v[72:75]
M v[136:139], a[200:203], a[148:151], v[136:139]
M v[200:203], a[200:203], a[152:155], v[200:203]
T a[224:225], v24, 0
T a[226:227], v24, 2048
WL 10
M v[76:79], a[204:207], a[144:147], v[76:79]
M v[140:143], a[204:207], a[148:151], v[140:143]
M v[204:207], a[204:207], a[152:155], v[204:207]
T a[228:229], v25, 0
T a[230:231], v25, 2048
WL 10
M v[80:83], a[208:211], a[144:147], v[80:83]
M v[144:147], a[208:211], a[148:151], v[144:147]
T a[232:233], v26, 0
T a[234:235], v26, 2048
WL 10
M v[84:87], a[212:215], a[144:147], v[84:87]
M v[148:151], a[212:215], a[148:151], v[148:151]
T a[236:237], v27, 0
T a[238:239], v27, 2048
WL 10
M v[88:91], a[216:219], a[144:147], v[88:91]
M v[152:155], a[216:219], a[148:151], v[152:155]
T a[240:241], v28, 0
T a[242:243], v28, 2048
WL 10
M v[92:95], a[220:223], a[144:147], v[92:95]
M v[156:159], a[220:223], a[148:151], v[156:159]
T a[244:245], v29, 0
T a[246:247], v29, 2048
WL 10
M v[96:99], a[224:227], a[144:147], v[96:99]
M v[160:163], a[224:227], a[148:151], v[160:163]
T a[248:249], v30, 0
T a[250:251], v30, 2048
WL 10
M v[100:103], a[228:231], a[144:147], v[100:103]
M v[164:167], a[228:231], a[148:151], v[164:167]
T a[252:253], v31, 0
T a[254:255], v31, 2048
WL 10
M v[104:107], a[232:235], a[144:147], v[104:107]
M v[168:171], a[232:235], a[148:151], v[168:171]
s_waitcnt vmcnt(4)
s_barrier
T a[192:193], v16, 16384
T a[194:195], v16, 18432
WL 10
M v[108:111], a[236:239], a[144:147], v[108:111]
M v[172:175], a[236:239], a[148:151], v[172:175]
s_add_u32 m0, s55, 49152
s_mov_b32 s40, 65536
buffer_load_dwordx4 v9, s[12:15], s40 offen nt lds
T a[196:197], v17, 16384
T a[198:199], v17, 18432
WL 10
M v[112:115], a[240:243], a[144:147], v[112:115]
M v[176:179], a[240:243], a[148:151], v[176:179]
s_add_u32 m0, s55, 53248
s_mov_b32 s40, 69632
buffer_load_dwordx4 v9, s[12:15], s40 offen nt lds
T a[200:201], v18, 16384
T a[202:203], v18, 18432
WL 10
M v[116:119], a[244:247], a[144:147], v[116:119]
M v[180:183], a[244:247], a[148:151], v[180:183]
s_add_u32 m0, s55, 57344
s_mov_b32 s40, 73728
buffer_load_dwordx4 v9, s[12:15], s40 offen nt lds
T a[204:205], v19, 16384
T a[206:207], v19, 18432
WL 10
M v[120:123], a[248:251], a[144:147], v[120:123]
M v[184:187], a[248:251], a[148:151], v[184:187]
s_add_u32 m0, s55, 61440
s_mov_b32 s40, 77824
buffer_load_dwordx4 v9, s[12:15], s40 offen nt lds
T a[208:209], v20, 16384
T a[210:211], v20, 18432
WL 10
M v[124:127], a[252:255], a[144:147], v[124:127]
M v[188:191], a[252:255], a[148:151], v[188:191]
T a[212:213], v21, 16384
T a[214:215], v21, 18432
WL 10
M v[64:67], a[192:195], a[156:159], v[64:67]
M v[128:131], a[192:195], a[160:163], v[128:131]
M v[192:195], a[192:195], a[164:167], v[192:195]
T a[216:217], v22, 16384
T a[218:219], v22, 18432
WL 10
M v[68:71], a[196:199], a[156:159], v[68:71]
M v[132:135], a[196:199], a[160:163], v[132:135]
M v[196:199], a[196:199], a[164:167], v[196:199]
T a[220:221], v23, 16384
T a[222:223], v23, 18432
WL 10
M v[72:75], a[200:203], a[156:159], v[72:75]
M v[136:139], a[200:203], a[160:163], v[136:139]
M v[200:203], a[200:203], a[164:167], v[200:203]
T a[224:225], v24, 16384
T a[226:227], v24, 18432
WL 10
M v[76:79], a[204:207], a[156:159], v[76:79]
CV v50, v64, v65
CV v51, v66, v67
CV v52, v68, v69
M v[140:143], a[204:207], a[160:163], v[140:143]
CV v53, v70, v71
CV v54, v128, v129
CV v55, v130, v131
M v[204:207], a[204:207], a[164:167], v[204:207]
CV v56, v132, v133
CV v57, v134, v135
CV v58, v192, v193
T a[228:229], v25, 16384
T a[230:231], v25, 18432
WL 10
M v[80:83], a[208:211], a[156:159], v[80:83]
CV v59, v194, v195
CV v60, v196, v197
CV v61, v198, v199
M v[144:147], a[208:211], a[160:163], v[144:147]
s_nop 1
v_permlane32_swap_b32 v50, v52
v_permlane32_swap_b32 v51, v53
T a[232:233], v26, 16384
T a[234:235], v26, 18432
WL 10
M v[84:87], a[212:215], a[156:159], v[84:87]
v_permlane32_swap_b32 v54, v56
v_permlane32_swap_b32 v55, v57
v_permlane32_swap_b32 v58, v60
M v[148:151], a[212:215], a[160:163], v[148:151]
v_permlane32_swap_b32 v59, v61
s_nop 1
v_permlane16_swap_b32 v50, v52
T a[236:237], v27, 16384
T a[238:239], v27, 18432
WL 10
M v[88:91], a[216:219], a[156:159], v[88:91]
v_permlane16_swap_b32 v51, v53
v_permlane16_swap_b32 v54, v56
v_permlane16_swap_b32 v55, v57
M v[152:155], a[216:219], a[160:163], v[152:155]
v_permlane16_swap_b32 v58, v60
v_permlane16_swap_b32 v59, v61
s_nop 0
T a[240:241], v28, 16384
T a[242:243], v28, 18432
WL 10
M v[92:95], a[220:223], a[156:159], v[92:95]
v_accvgpr_write_b32 a0, v50
v_accvgpr_write_b32 a1, v51
v_accvgpr_write_b32 a2, v52
M v[156:159], a[220:223], a[160:163], v[156:159]
v_accvgpr_write_b32 a3, v53
v_accvgpr_write_b32 a56, v54
v_accvgpr_write_b32 a57, v55
T a[244:245], v29, 16384
T a[246:247], v29, 18432
WL 10
M v[96:99], a[224:227], a[156:159], v[96:99]
v_accvgpr_write_b32 a58, v56
v_accvgpr_write_b32 a59, v57
ds_write_b128 v244, v[58:61] offset:0
M v[160:163], a[224:227], a[160:163], v[160:163]
CV v50, v72, v73
CV v51, v74, v75
CV v52, v76, v77
T a[248:249], v30, 16384
T a[250:251], v30, 18432
WL 11
M v[100:103], a[228:231], a[156:159], v[100:103]
CV v53, v78, v79
CV v54, v136, v137
CV v55, v138, v139
M v[164:167], a[228:231], a[160:163], v[164:167]
CV v56, v140, v141
CV v57, v142, v143
CV v58, v200, v201
T a[252:253], v31, 16384
T a[254:255], v31, 18432
WL 11
M v[104:107], a[232:235], a[156:159], v[104:107]
CV v59, v202, v203
CV v60, v204, v205
CV v61, v206, v207
M v[168:171], a[232:235], a[160:163], v[168:171]
s_nop 1
v_permlane32_swap_b32 v50, v52
v_permlane32_swap_b32 v51, v53
s_barrier
v_permlane32_swap_b32 v54, v56
v_permlane32_swap_b32 v55, v57
v_permlane32_swap_b32 v58, v60
v_permlane32_swap_b32 v59, v61
s_nop 1
v_permlane16_swap_b32 v50, v52
v_permlane16_swap_b32 v51, v53
v_permlane16_swap_b32 v54, v56
v_permlane16_swap_b32 v55, v57
v_permlane16_swap_b32 v58, v60
v_permlane16_swap_b32 v59, v61
s_nop 0
v_accvgpr_write_b32 a4, v50
v_accvgpr_write_b32 a5, v51
v_accvgpr_write_b32 a6, v52
v_accvgpr_write_b32 a7, v53
v_accvgpr_write_b32 a60, v54
v_accvgpr_write_b32 a61, v55
v_accvgpr_write_b32 a62, v56
v_accvgpr_write_b32 a63, v57
ds_write_b128 v244, v[58:61] offset:1024
CV v50, v80, v81
CV v51, v82, v83
CV v52, v84, v85
CV v53, v86, v87
CV v54, v144, v145
CV v55, v146, v147
CV v56, v148, v149
CV v57, v150, v151
s_nop 1
v_permlane32_swap_b32 v50, v52
v_permlane32_swap_b32 v51, v53
v_permlane32_swap_b32 v54, v56
v_permlane32_swap_b32 v55, v57
s_nop 1
v_permlane16_swap_b32 v50, v52
v_permlane16_swap_b32 v51, v53
v_permlane16_swap_b32 v54, v56
v_permlane16_swap_b32 v55, v57
s_nop 0
v_accvgpr_write_b32 a8, v50
v_accvgpr_write_b32 a9, v51
v_accvgpr_write_b32 a10, v52
v_accvgpr_write_b32 a11, v53
v_accvgpr_write_b32 a64, v54
v_accvgpr_write_b32 a65, v55
v_accvgpr_write_b32 a66, v56
v_accvgpr_write_b32 a67, v57
CV v50, v88, v89
CV v51, v90, v91
CV v52, v92, v93
CV v53, v94, v95
CV v54, v152, v153
CV v55, v154, v155
CV v56, v156, v157
CV v57, v158, v159
s_nop 1
v_permlane32_swap_b32 v50, v52
v_permlane32_swap_b32 v51, v53
v_permlane32_swap_b32 v54, v56
v_permlane32_swap_b32 v55, v57
s_nop 1
v_permlane16_swap_b32 v50, v52
v_permlane16_swap_b32 v51, v53
v_permlane16_swap_b32 v54, v56
v_permlane16_swap_b32 v55, v57
s_nop 0
v_accvgpr_write_b32 a12, v50
v_accvgpr_write_b32 a13, v51
v_accvgpr_write_b32 a14, v52
v_accvgpr_write_b32 a15, v53
v_accvgpr_write_b32 a68, v54
v_accvgpr_write_b32 a69, v55
v_accvgpr_write_b32 a70, v56
v_accvgpr_write_b32 a71, v57
CV v50, v96, v97
CV v51, v98, v99
CV v52, v100, v101
CV v53, v102, v103
CV v54, v160, v161
CV v55, v162, v163
CV v56, v164, v165
CV v57, v166, v167
s_nop 1
v_permlane32_swap_b32 v50, v52
v_permlane32_swap_b32 v51, v53
v_permlane32_swap_b32 v54, v56
v_permlane32_swap_b32 v55, v57
s_nop 1
v_permlane16_swap_b32 v50, v52
v_permlane16_swap_b32 v51, v53
v_permlane16_swap_b32 v54, v56
v_permlane16_swap_b32 v55, v57
s_nop 0
v_accvgpr_write_b32 a16, v50
v_accvgpr_write_b32 a17, v51
v_accvgpr_write_b32 a18, v52
v_accvgpr_write_b32 a19, v53
v_accvgpr_write_b32 a72, v54
v_accvgpr_write_b32 a73, v55
v_accvgpr_write_b32 a74, v56
v_accvgpr_write_b32 a75, v57
v_lshrrev_b32 v50, 4, v1
v_bfe_u32 v51, v1, 2, 2
v_and_b32 v52, 3, v1
v_and_b32 v51, 15, v1
v_lshlrev_b32 v53, 9, v51
v_and_b32 v51, 7, v51
v_lshlrev_b32 v51, 1, v51
v_xor_b32 v51, v50, v51
v_lshl_add_u32 v53, v51, 4, v53
s_lshl_b32 s42, s28, 7
v_xor_b32 v53, s42, v53
v_xor_b32 v16, 0, v53
v_xor_b32 v17, 64, v53
v_xor_b32 v18, 128, v53
v_xor_b32 v19, 192, v53
v_xor_b32 v20, 256, v53
v_xor_b32 v21, 320, v53
v_xor_b32 v22, 384, v53
v_xor_b32 v23, 448, v53
v_add_u32 v16, 65536, v16
v_add_u32 v17, 65536, v17
v_add_u32 v18, 65536, v18
v_add_u32 v19, 65536, v19
v_add_u32 v20, 65536, v20
v_add_u32 v21, 65536, v21
v_add_u32 v22, 65536, v22
v_add_u32 v23, 65536, v23
R a[192:195], v16, 0
WL 11
M v[108:111], a[236:239], a[156:159], v[108:111]
M v[172:175], a[236:239], a[160:163], v[172:175]
s_add_u32 m0, s55, 0
s_mov_b32 s40, 81920
buffer_load_dwordx4 v9, s[12:15], s40 offen nt lds
R a[196:199], v17, 0
WL 10
M v[112:115], a[240:243], a[156:159], v[112:115]
M v[176:179], a[240:243], a[160:163], v[176:179]
s_add_u32 m0, s55, 4096
s_mov_b32 s40, 86016
buffer_load_dwordx4 v9, s[12:15], s40 offen nt lds
R a[200:203], v18, 0
WL 9
M v[116:119], a[244:247], a[156:159], v[116:119]
CV v50, v104, v105
CV v51, v106, v107
CV v52, v108, v109
M v[180:183], a[244:247], a[160:163], v[180:183]
CV v53, v110, v111
CV v54, v168, v169
CV v55, v170, v171
s_add_u32 m0, s55, 8192
s_mov_b32 s40, 90112
buffer_load_dwordx4 v9, s[12:15], s40 offen nt lds
R a[204:207], v19, 0
WL 7
M v[120:123], a[248:251], a[156:159], v[120:123]
CV v56, v172, v173
CV v57, v174, v175
s_nop 1
M v[184:187], a[248:251], a[160:163], v[184:187]
v_permlane32_swap_b32 v50, v52
v_permlane32_swap_b32 v51, v53
v_permlane32_swap_b32 v54, v56
s_add_u32 m0, s55, 12288
s_mov_b32 s40, 94208
buffer_load_dwordx4 v9, s[12:15], s40 offen nt lds
R a[208:211], v20, 0
WL 6
M v[124:127], a[252:255], a[156:159], v[124:127]
v_permlane32_swap_b32 v55, v57
s_nop 1
v_permlane16_swap_b32 v50, v52
M v[188:191], a[252:255], a[160:163], v[188:191]
v_permlane16_swap_b32 v51, v53
v_permlane16_swap_b32 v54, v56
v_permlane16_swap_b32 v55, v57
s_add_u32 m0, s55, 114688
s_mov_b32 s40, 98304
buffer_load_dwordx4 v9, s[12:15], s40 offen nt lds
s_nop 0
v_accvgpr_write_b32 a20, v50
v_accvgpr_write_b32 a21, v51
v_accvgpr_write_b32 a22, v52
v_accvgpr_write_b32 a23, v53
v_accvgpr_write_b32 a76, v54
v_accvgpr_write_b32 a77, v55
v_accvgpr_write_b32 a78, v56
v_accvgpr_write_b32 a79, v57
CV v50, v112, v113
CV v51, v114, v115
CV v52, v116, v117
CV v53, v118, v119
CV v54, v176, v177
CV v55, v178, v179
CV v56, v180, v181
CV v57, v182, v183
s_nop 1
v_permlane32_swap_b32 v50, v52
v_permlane32_swap_b32 v51, v53
v_permlane32_swap_b32 v54, v56
v_permlane32_swap_b32 v55, v57
s_nop 1
v_permlane16_swap_b32 v50, v52
v_permlane16_swap_b32 v51, v53
v_permlane16_swap_b32 v54, v56
v_permlane16_swap_b32 v55, v57
s_nop 0
v_accvgpr_write_b32 a24, v50
v_accvgpr_write_b32 a25, v51
v_accvgpr_write_b32 a26, v52
v_accvgpr_write_b32 a27, v53
v_accvgpr_write_b32 a80, v54
v_accvgpr_write_b32 a81, v55
v_accvgpr_write_b32 a82, v56
v_accvgpr_write_b32 a83, v57
CV v50, v120, v121
CV v51, v122, v123
CV v52, v124, v125
CV v53, v126, v127
CV v54, v184, v185
CV v55, v186, v187
CV v56, v188, v189
CV v57, v190, v191
s_nop 1
v_permlane32_swap_b32 v50, v52
v_permlane32_swap_b32 v51, v53
v_permlane32_swap_b32 v54, v56
v_permlane32_swap_b32 v55, v57
s_nop 1
v_permlane16_swap_b32 v50, v52
v_permlane16_swap_b32 v51, v53
v_permlane16_swap_b32 v54, v56
v_permlane16_swap_b32 v55, v57
s_nop 0
v_accvgpr_write_b32 a28, v50
v_accvgpr_write_b32 a29, v51
v_accvgpr_write_b32 a30, v52
v_accvgpr_write_b32 a31, v53
v_accvgpr_write_b32 a84, v54
v_accvgpr_write_b32 a85, v55
v_accvgpr_write_b32 a86, v56
v_accvgpr_write_b32 a87, v57
v_mov_b32 v225, 0xff800000
WL 5
s_barrier
R a[112:115], v244, 0
R a[116:119], v244, 1024
R a[120:123], v245, 0
R a[124:127], v245, 1024
R a[128:131], v246, 0
R a[132:135], v246, 1024
R a[136:139], v247, 0
R a[140:143], v247, 1024
s_nop 1
WL 0
R a[212:215], v21, 0
M v[32:35], a[192:195], a[0:3], 0
M v[36:39], a[192:195], a[56:59], 0
M v[208:211], a[192:195], a[112:115], 0
s_add_u32 m0, s55, 118784
s_mov_b32 s40, 102400
buffer_load_dwordx4 v9, s[12:15], s40 offen nt lds
R a[216:219], v22, 0
M v[32:35], a[196:199], a[4:7], v[32:35]
M v[36:39], a[196:199], a[60:63], v[36:39]
M v[208:211], a[196:199], a[116:119], v[208:211]
s_add_u32 m0, s55, 122880
s_mov_b32 s40, 106496
buffer_load_dwordx4 v9, s[12:15], s40 offen nt lds
R a[220:223], v23, 0
M v[32:35], a[200:203], a[8:11], v[32:35]
M v[36:39], a[200:203], a[64:67], v[36:39]
M v[208:211], a[200:203], a[120:123], v[208:211]
s_add_u32 m0, s55, 126976
s_mov_b32 s40, 110592
buffer_load_dwordx4 v9, s[12:15], s40 offen nt lds
R a[224:227], v16, 8192
M v[32:35], a[204:207], a[12:15], v[32:35]
M v[36:39], a[204:207], a[68:71], v[36:39]
M v[208:211], a[204:207], a[124:127], v[208:211]
s_add_u32 m0, s55, 131072
s_mov_b32 s40, 114688
buffer_load_dwordx4 v9, s[12:15], s40 offen nt lds
R a[228:231], v17, 8192
M v[32:35], a[208:211], a[16:19], v[32:35]
M v[36:39], a[208:211], a[72:75], v[36:39]
M v[208:211], a[208:211], a[128:131], v[208:211]
s_add_u32 m0, s55, 135168
s_mov_b32 s40, 118784
buffer_load_dwordx4 v9, s[12:15], s40 offen nt lds
R a[232:235], v18, 8192
WL 5
M v[32:35], a[212:215], a[20:23], v[32:35]
M v[36:39], a[212:215], a[76:79], v[36:39]
M v[208:211], a[212:215], a[132:135], v[208:211]
s_add_u32 m0, s55, 139264
s_mov_b32 s40, 122880
buffer_load_dwordx4 v9, s[12:15], s40 offen nt lds
R a[236:239], v19, 8192
WL 5
M v[32:35], a[216:219], a[24:27], v[32:35]
M v[36:39], a[216:219], a[80:83], v[36:39]
M v[208:211], a[216:219], a[136:139], v[208:211]
s_add_u32 m0, s55, 143360
s_mov_b32 s40, 126976
buffer_load_dwordx4 v9, s[12:15], s40 offen nt lds
R a[240:243], v20, 8192
WL 5
M v[32:35], a[220:223], a[28:31], v[32:35]
M v[36:39], a[220:223], a[84:87], v[36:39]
M v[208:211], a[220:223], a[140:143], v[208:211]
R a[244:247], v21, 8192
WL 5
M v[40:43], a[224:227], a[0:3], 0
M v[44:47], a[224:227], a[56:59], 0
s_nop 8
v_max_f32 v2, v32, v33
CV v64, v32, v33
v_max3_f32 v2, v34, v35, v2
CV v65, v34, v35
v_max_f32 v3, v36, v37
CV v128, v36, v37
v_max3_f32 v3, v38, v39, v3
CV v129, v38, v39
s_mov_b64 vcc, s[66:67]
s_cbranch_vccz Ls8_1
v_max3_f32 v225, v208, v209, v225
CV v192, v208, v209
v_max3_f32 v225, v210, v211, v225
CV v193, v210, v211
Ls8_1:
M v[208:211], a[224:227], a[112:115], 0
R a[248:251], v22, 8192
WL 5
M v[40:43], a[228:231], a[4:7], v[40:43]
M v[44:47], a[228:231], a[60:63], v[44:47]
M v[208:211], a[228:231], a[116:119], v[208:211]
R a[252:255], v23, 8192
WL 5
M v[40:43], a[232:235], a[8:11], v[40:43]
M v[44:47], a[232:235], a[64:67], v[44:47]
M v[208:211], a[232:235], a[120:123], v[208:211]
s_barrier
R a[192:195], v16, 16384
WL 5
M v[40:43], a[236:239], a[12:15], v[40:43]
M v[44:47], a[236:239], a[68:71], v[44:47]
M v[208:211], a[236:239], a[124:127], v[208:211]
s_add_u32 m0, s55, 16384
s_mov_b32 s40, 131072
buffer_load_dwordx4 v9, s[12:15], s40 offen nt lds
R a[196:199], v17, 16384
WL 5
M v[40:43], a[240:243], a[16:19], v[40:43]
M v[44:47], a[240:243], a[72:75], v[44:47]
M v[208:211], a[240:243], a[128:131], v[208:211]
s_add_u32 m0, s55, 20480
s_mov_b32 s40, 135168
buffer_load_dwordx4 v9, s[12:15], s40 offen nt lds
R a[200:203], v18, 16384
WL 5
M v[40:43], a[244:247], a[20:23], v[40:43]
M v[44:47], a[244:247], a[76:79], v[44:47]
M v[208:211], a[244:247], a[132:135], v[208:211]
s_add_u32 m0, s55, 24576
s_mov_b32 s40, 139264
buffer_load_dwordx4 v9, s[12:15], s40 offen nt lds
R a[204:207], v19, 16384
WL 5
M v[40:43], a[248:251], a[24:27], v[40:43]
M v[44:47], a[248:251], a[80:83], v[44:47]
M v[208:211], a[248:251], a[136:139], v[208:211]
s_add_u32 m0, s55, 28672
s_mov_b32 s40, 143360
buffer_load_dwordx4 v9, s[12:15], s40 offen nt lds
R a[208:211], v20, 16384
WL 5
M v[40:43], a[252:255], a[28:31], v[40:43]
M v[44:47], a[252:255], a[84:87], v[44:47]
M v[208:211], a[252:255], a[140:143], v[208:211]
R a[212:215], v21, 16384
WL 5
M v[32:35], a[192:195], a[0:3], 0
M v[36:39], a[192:195], a[56:59], 0
s_nop 8
v_max3_f32 v2, v40, v41, v2
CV v66, v40, v41
v_max3_f32 v2, v42, v43, v2
CV v67, v42, v43
v_max3_f32 v3, v44, v45, v3
CV v130, v44, v45
v_max3_f32 v3, v46, v47, v3
CV v131, v46, v47
s_mov_b64 vcc, s[68:69]
s_cbranch_vccz Ls8_2
v_max3_f32 v225, v208, v209, v225
CV v192, v208, v209
v_max3_f32 v225, v210, v211, v225
CV v193, v210, v211
Ls8_2:
M v[208:211], a[192:195], a[112:115], 0
R a[216:219], v22, 16384
WL 5
M v[32:35], a[196:199], a[4:7], v[32:35]
M v[36:39], a[196:199], a[60:63], v[36:39]
M v[208:211], a[196:199], a[116:119], v[208:211]
R a[220:223], v23, 16384
WL 5
M v[32:35], a[200:203], a[8:11], v[32:35]
M v[36:39], a[200:203], a[64:67], v[36:39]
M v[208:211], a[200:203], a[120:123], v[208:211]
R a[224:227], v16, 24576
WL 5
M v[32:35], a[204:207], a[12:15], v[32:35]
M v[36:39], a[204:207], a[68:71], v[36:39]
M v[208:211], a[204:207], a[124:127], v[208:211]
R a[228:231], v17, 24576
WL 5
M v[32:35], a[208:211], a[16:19], v[32:35]
M v[36:39], a[208:211], a[72:75], v[36:39]
M v[208:211], a[208:211], a[128:131], v[208:211]
R a[232:235], v18, 24576
WL 5
M v[32:35], a[212:215], a[20:23], v[32:35]
M v[36:39], a[212:215], a[76:79], v[36:39]
M v[208:211], a[212:215], a[132:135], v[208:211]
R a[236:239], v19, 24576
WL 5
M v[32:35], a[216:219], a[24:27], v[32:35]
M v[36:39], a[216:219], a[80:83], v[36:39]
M v[208:211], a[216:219], a[136:139], v[208:211]
R a[240:243], v20, 24576
WL 5
M v[32:35], a[220:223], a[28:31], v[32:35]
M v[36:39], a[220:223], a[84:87], v[36:39]
M v[208:211], a[220:223], a[140:143], v[208:211]
R a[244:247], v21, 24576
WL 5
M v[40:43], a[224:227], a[0:3], 0
M v[44:47], a[224:227], a[56:59], 0
s_nop 8
v_max3_f32 v2, v32, v33, v2
CV v68, v32, v33
v_max3_f32 v2, v34, v35, v2
CV v69, v34, v35
v_max3_f32 v3, v36, v37, v3
CV v132, v36, v37
v_max3_f32 v3, v38, v39, v3
CV v133, v38, v39
s_mov_b64 vcc, s[70:71]
s_cbranch_vccz Ls8_3
v_max3_f32 v225, v208, v209, v225
CV v192, v208, v209
v_max3_f32 v225, v210, v211, v225
CV v193, v210, v211
Ls8_3:
M v[208:211], a[224:227], a[112:115], 0
R a[248:251], v22, 24576
WL 5
M v[40:43], a[228:231], a[4:7], v[40:43]
M v[44:47], a[228:231], a[60:63], v[44:47]
M v[208:211], a[228:231], a[116:119], v[208:211]
R a[252:255], v23, 24576
WL 5
M v[40:43], a[232:235], a[8:11], v[40:43]
M v[44:47], a[232:235], a[64:67], v[44:47]
M v[208:211], a[232:235], a[120:123], v[208:211]
s_barrier
R a[192:195], v16, 32768
WL 5
M v[40:43], a[236:239], a[12:15], v[40:43]
M v[44:47], a[236:239], a[68:71], v[44:47]
M v[208:211], a[236:239], a[124:127], v[208:211]
s_add_u32 m0, s55, 65536
s_mov_b32 s40, 147456
buffer_load_dwordx4 v9, s[12:15], s40 offen nt lds
R a[196:199], v17, 32768
WL 5
M v[40:43], a[240:243], a[16:19], v[40:43]
M v[44:47], a[240:243], a[72:75], v[44:47]
M v[208:211], a[240:243], a[128:131], v[208:211]
s_add_u32 m0, s55, 69632
s_mov_b32 s40, 151552
buffer_load_dwordx4 v9, s[12:15], s40 offen nt lds
R a[200:203], v18, 32768
WL 5
M v[40:43], a[244:247], a[20:23], v[40:43]
M v[44:47], a[244:247], a[76:79], v[44:47]
M v[208:211], a[244:247], a[132:135], v[208:211]
s_add_u32 m0, s55, 73728
s_mov_b32 s40, 155648
buffer_load_dwordx4 v9, s[12:15], s40 offen nt lds
R a[204:207], v19, 32768
WL 5
M v[40:43], a[248:251], a[24:27], v[40:43]
M v[44:47], a[248:251], a[80:83], v[44:47]
M v[208:211], a[248:251], a[136:139], v[208:211]
s_add_u32 m0, s55, 77824
s_mov_b32 s40, 159744
buffer_load_dwordx4 v9, s[12:15], s40 offen nt lds
R a[208:211], v20, 32768
WL 5
M v[40:43], a[252:255], a[28:31], v[40:43]
M v[44:47], a[252:255], a[84:87], v[44:47]
M v[208:211], a[252:255], a[140:143], v[208:211]
R a[212:215], v21, 32768
WL 5
M v[32:35], a[192:195], a[0:3], 0
M v[36:39], a[192:195], a[56:59], 0
s_nop 8
v_max3_f32 v2, v40, v41, v2
CV v70, v40, v41
v_max3_f32 v2, v42, v43, v2
CV v71, v42, v43
v_max3_f32 v3, v44, v45, v3
CV v134, v44, v45
v_max3_f32 v3, v46, v47, v3
CV v135, v46, v47
s_mov_b64 vcc, s[72:73]
s_cbranch_vccz Ls8_4
v_max3_f32 v225, v208, v209, v225
CV v192, v208, v209
v_max3_f32 v225, v210, v211, v225
CV v193, v210, v211
Ls8_4:
M v[208:211], a[192:195], a[112:115], 0
R a[216:219], v22, 32768
WL 5
M v[32:35], a[196:199], a[4:7], v[32:35]
M v[36:39], a[196:199], a[60:63], v[36:39]
M v[208:211], a[196:199], a[116:119], v[208:211]
R a[220:223], v23, 32768
WL 5
M v[32:35], a[200:203], a[8:11], v[32:35]
M v[36:39], a[200:203], a[64:67], v[36:39]
M v[208:211], a[200:203], a[120:123], v[208:211]
R a[224:227], v16, 40960
WL 5
M v[32:35], a[204:207], a[12:15], v[32:35]
M v[36:39], a[204:207], a[68:71], v[36:39]
M v[208:211], a[204:207], a[124:127], v[208:211]
R a[228:231], v17, 40960
WL 5
M v[32:35], a[208:211], a[16:19], v[32:35]
M v[36:39], a[208:211], a[72:75], v[36:39]
M v[208:211], a[208:211], a[128:131], v[208:211]
R a[232:235], v18, 40960
WL 5
M v[32:35], a[212:215], a[20:23], v[32:35]
M v[36:39], a[212:215], a[76:79], v[36:39]
M v[208:211], a[212:215], a[132:135], v[208:211]
R a[236:239], v19, 40960
WL 5
M v[32:35], a[216:219], a[24:27], v[32:35]
M v[36:39], a[216:219], a[80:83], v[36:39]
M v[208:211], a[216:219], a[136:139], v[208:211]
R a[240:243], v20, 40960
WL 5
M v[32:35], a[220:223], a[28:31], v[32:35]
M v[36:39], a[220:223], a[84:87], v[36:39]
M v[208:211], a[220:223], a[140:143], v[208:211]
R a[244:247], v21, 40960
WL 5
M v[40:43], a[224:227], a[0:3], 0
M v[44:47], a[224:227], a[56:59], 0
s_nop 8
v_max3_f32 v2, v32, v33, v2
CV v72, v32, v33
v_max3_f32 v2, v34, v35, v2
CV v73, v34, v35
v_max3_f32 v3, v36, v37, v3
CV v136, v36, v37
v_max3_f32 v3, v38, v39, v3
CV v137, v38, v39
s_mov_b64 vcc, s[66:67]
s_cbranch_vccz Ls8_5
v_max3_f32 v225, v208, v209, v225
CV v194, v208, v209
v_max3_f32 v225, v210, v211, v225
CV v195, v210, v211
Ls8_5:
M v[208:211], a[224:227], a[112:115], 0
R a[248:251], v22, 40960
WL 5
M v[40:43], a[228:231], a[4:7], v[40:43]
M v[44:47], a[228:231], a[60:63], v[44:47]
M v[208:211], a[228:231], a[116:119], v[208:211]
R a[252:255], v23, 40960
WL 5
M v[40:43], a[232:235], a[8:11], v[40:43]
M v[44:47], a[232:235], a[64:67], v[44:47]
M v[208:211], a[232:235], a[120:123], v[208:211]
s_waitcnt vmcnt(24)
s_barrier
v_add_u32 v16, 4294901760, v16
v_add_u32 v17, 4294901760, v17
v_add_u32 v18, 4294901760, v18
v_add_u32 v19, 4294901760, v19
v_add_u32 v20, 4294901760, v20
v_add_u32 v21, 4294901760, v21
v_add_u32 v22, 4294901760, v22
v_add_u32 v23, 4294901760, v23
R a[192:195], v16, 32768
WL 5
M v[40:43], a[236:239], a[12:15], v[40:43]
M v[44:47], a[236:239], a[68:71], v[44:47]
M v[208:211], a[236:239], a[124:127], v[208:211]
s_add_u32 m0, s55, 81920
s_mov_b32 s40, 163840
buffer_load_dwordx4 v9, s[12:15], s40 offen nt lds
R a[196:199], v17, 32768
WL 5
M v[40:43], a[240:243], a[16:19], v[40:43]
M v[44:47], a[240:243], a[72:75], v[44:47]
M v[208:211], a[240:243], a[128:131], v[208:211]
s_add_u32 m0, s55, 86016
s_mov_b32 s40, 167936
buffer_load_dwordx4 v9, s[12:15], s40 offen nt lds
R a[200:203], v18, 32768
WL 5
M v[40:43], a[244:247], a[20:23], v[40:43]
M v[44:47], a[244:247], a[76:79], v[44:47]
M v[208:211], a[244:247], a[132:135], v[208:211]
s_add_u32 m0, s55, 90112
s_mov_b32 s40, 172032
buffer_load_dwordx4 v9, s[12:15], s40 offen nt lds
R a[204:207], v19, 32768
WL 5
M v[40:43], a[248:251], a[24:27], v[40:43]
M v[44:47], a[248:251], a[80:83], v[44:47]
M v[208:211], a[248:251], a[136:139], v[208:211]
s_add_u32 m0, s55, 94208
s_mov_b32 s40, 176128
buffer_load_dwordx4 v9, s[12:15], s40 offen nt lds
R a[208:211], v20, 32768
WL 5
M v[40:43], a[252:255], a[28:31], v[40:43]
M v[44:47], a[252:255], a[84:87], v[44:47]
M v[208:211], a[252:255], a[140:143], v[208:211]
R a[212:215], v21, 32768
WL 5
M v[32:35], a[192:195], a[0:3], 0
M v[36:39], a[192:195], a[56:59], 0
s_nop 8
v_max3_f32 v2, v40, v41, v2
CV v74, v40, v41
v_max3_f32 v2, v42, v43, v2
CV v75, v42, v43
v_max3_f32 v3, v44, v45, v3
CV v138, v44, v45
v_max3_f32 v3, v46, v47, v3
CV v139, v46, v47
s_mov_b64 vcc, s[68:69]
s_cbranch_vccz Ls8_6
v_max3_f32 v225, v208, v209, v225
CV v194, v208, v209
v_max3_f32 v225, v210, v211, v225
CV v195, v210, v211
Ls8_6:
M v[208:211], a[192:195], a[112:115], 0
R a[216:219], v22, 32768
WL 5
M v[32:35], a[196:199], a[4:7], v[32:35]
M v[36:39], a[196:199], a[60:63], v[36:39]
M v[208:211], a[196:199], a[116:119], v[208:211]
R a[220:223], v23, 32768
WL 5
M v[32:35], a[200:203], a[8:11], v[32:35]
M v[36:39], a[200:203], a[64:67], v[36:39]
M v[208:211], a[200:203], a[120:123], v[208:211]
R a[224:227], v16, 40960
WL 5
M v[32:35], a[204:207], a[12:15], v[32:35]
M v[36:39], a[204:207], a[68:71], v[36:39]
M v[208:211], a[204:207], a[124:127], v[208:211]
R a[228:231], v17, 40960
WL 5
M v[32:35], a[208:211], a[16:19], v[32:35]
M v[36:39], a[208:211], a[72:75], v[36:39]
M v[208:211], a[208:211], a[128:131], v[208:211]
R a[232:235], v18, 40960
WL 5
M v[32:35], a[212:215], a[20:23], v[32:35]
M v[36:39], a[212:215], a[76:79], v[36:39]
M v[208:211], a[212:215], a[132:135], v[208:211]
R a[236:239], v19, 40960
WL 5
M v[32:35], a[216:219], a[24:27], v[32:35]
M v[36:39], a[216:219], a[80:83], v[36:39]
M v[208:211], a[216:219], a[136:139], v[208:211]
R a[240:243], v20, 40960
WL 5
M v[32:35], a[220:223], a[28:31], v[32:35]
M v[36:39], a[220:223], a[84:87], v[36:39]
M v[208:211], a[220:223], a[140:143], v[208:211]
R a[244:247], v21, 40960
WL 5
M v[40:43], a[224:227], a[0:3], 0
M v[44:47], a[224:227], a[56:59], 0
s_nop 8
v_max3_f32 v2, v32, v33, v2
CV v76, v32, v33
v_max3_f32 v2, v34, v35, v2
CV v77, v34, v35
v_max3_f32 v3, v36, v37, v3
CV v140, v36, v37
v_max3_f32 v3, v38, v39, v3
CV v141, v38, v39
s_mov_b64 vcc, s[70:71]
s_cbranch_vccz Ls8_7
v_max3_f32 v225, v208, v209, v225
CV v194, v208, v209
v_max3_f32 v225, v210, v211, v225
CV v195, v210, v211
Ls8_7:
M v[208:211], a[224:227], a[112:115], 0
R a[248:251], v22, 40960
WL 5
M v[40:43], a[228:231], a[4:7], v[40:43]
M v[44:47], a[228:231], a[60:63], v[44:47]
M v[208:211], a[228:231], a[116:119], v[208:211]
R a[252:255], v23, 40960
WL 5
M v[40:43], a[232:235], a[8:11], v[40:43]
M v[44:47], a[232:235], a[64:67], v[44:47]
M v[208:211], a[232:235], a[120:123], v[208:211]
s_waitcnt vmcnt(24)
s_barrier
R a[192:195], v16, 49152
WL 5
M v[40:43], a[236:239], a[12:15], v[40:43]
M v[44:47], a[236:239], a[68:71], v[44:47]
M v[208:211], a[236:239], a[124:127], v[208:211]
s_add_u32 m0, s55, 98304
s_mov_b32 s40, 180224
buffer_load_dwordx4 v9, s[12:15], s40 offen nt lds
R a[196:199], v17, 49152
WL 5
M v[40:43], a[240:243], a[16:19], v[40:43]
M v[44:47], a[240:243], a[72:75], v[44:47]
M v[208:211], a[240:243], a[128:131], v[208:211]
s_add_u32 m0, s55, 102400
s_mov_b32 s40, 184320
buffer_load_dwordx4 v9, s[12:15], s40 offen nt lds
R a[200:203], v18, 49152
WL 5
M v[40:43], a[244:247], a[20:23], v[40:43]
M v[44:47], a[244:247], a[76:79], v[44:47]
M v[208:211], a[244:247], a[132:135], v[208:211]
s_add_u32 m0, s55, 106496
s_mov_b32 s40, 188416
buffer_load_dwordx4 v9, s[12:15], s40 offen nt lds
R a[204:207], v19, 49152
WL 5
M v[40:43], a[248:251], a[24:27], v[40:43]
M v[44:47], a[248:251], a[80:83], v[44:47]
M v[208:211], a[248:251], a[136:139], v[208:211]
s_add_u32 m0, s55, 110592
s_mov_b32 s40, 192512
buffer_load_dwordx4 v9, s[12:15], s40 offen nt lds
R a[208:211], v20, 49152
WL 5
M v[40:43], a[252:255], a[28:31], v[40:43]
M v[44:47], a[252:255], a[84:87], v[44:47]
M v[208:211], a[252:255], a[140:143], v[208:211]
R a[212:215], v21, 49152
WL 5
M v[32:35], a[192:195], a[0:3], 0
M v[36:39], a[192:195], a[56:59], 0
s_nop 8
v_max3_f32 v2, v40, v41, v2
CV v78, v40, v41
v_max3_f32 v2, v42, v43, v2
CV v79, v42, v43
v_max3_f32 v3, v44, v45, v3
CV v142, v44, v45
v_max3_f32 v3, v46, v47, v3
CV v143, v46, v47
s_mov_b64 vcc, s[72:73]
s_cbranch_vccz Ls8_8
v_max3_f32 v225, v208, v209, v225
CV v194, v208, v209
v_max3_f32 v225, v210, v211, v225
CV v195, v210, v211
Ls8_8:
M v[208:211], a[192:195], a[112:115], 0
R a[216:219], v22, 49152
WL 5
M v[32:35], a[196:199], a[4:7], v[32:35]
M v[36:39], a[196:199], a[60:63], v[36:39]
M v[208:211], a[196:199], a[116:119], v[208:211]
R a[220:223], v23, 49152
WL 5
M v[32:35], a[200:203], a[8:11], v[32:35]
M v[36:39], a[200:203], a[64:67], v[36:39]
M v[208:211], a[200:203], a[120:123], v[208:211]
R a[224:227], v16, 57344
WL 5
M v[32:35], a[204:207], a[12:15], v[32:35]
M v[36:39], a[204:207], a[68:71], v[36:39]
M v[208:211], a[204:207], a[124:127], v[208:211]
R a[228:231], v17, 57344
WL 5
M v[32:35], a[208:211], a[16:19], v[32:35]
M v[36:39], a[208:211], a[72:75], v[36:39]
M v[208:211], a[208:211], a[128:131], v[208:211]
R a[232:235], v18, 57344
WL 5
M v[32:35], a[212:215], a[20:23], v[32:35]
M v[36:39], a[212:215], a[76:79], v[36:39]
M v[208:211], a[212:215], a[132:135], v[208:211]
R a[236:239], v19, 57344
WL 5
M v[32:35], a[216:219], a[24:27], v[32:35]
M v[36:39], a[216:219], a[80:83], v[36:39]
M v[208:211], a[216:219], a[136:139], v[208:211]
R a[240:243], v20, 57344
WL 5
M v[32:35], a[220:223], a[28:31], v[32:35]
M v[36:39], a[220:223], a[84:87], v[36:39]
M v[208:211], a[220:223], a[140:143], v[208:211]
R a[244:247], v21, 57344
WL 5
M v[40:43], a[224:227], a[0:3], 0
M v[44:47], a[224:227], a[56:59], 0
s_nop 8
v_max3_f32 v2, v32, v33, v2
CV v80, v32, v33
v_max3_f32 v2, v34, v35, v2
CV v81, v34, v35
v_max3_f32 v3, v36, v37, v3
CV v144, v36, v37
v_max3_f32 v3, v38, v39, v3
CV v145, v38, v39
s_mov_b64 vcc, s[66:67]
s_cbranch_vccz Ls8_9
v_max3_f32 v225, v208, v209, v225
CV v196, v208, v209
v_max3_f32 v225, v210, v211, v225
CV v197, v210, v211
Ls8_9:
M v[208:211], a[224:227], a[112:115], 0
R a[248:251], v22, 57344
WL 5
M v[40:43], a[228:231], a[4:7], v[40:43]
M v[44:47], a[228:231], a[60:63], v[44:47]
M v[208:211], a[228:231], a[116:119], v[208:211]
R a[252:255], v23, 57344
WL 5
M v[40:43], a[232:235], a[8:11], v[40:43]
M v[44:47], a[232:235], a[64:67], v[44:47]
M v[208:211], a[232:235], a[120:123], v[208:211]
s_waitcnt vmcnt(24)
s_barrier
R a[192:195], v16, 0
WL 5
M v[40:43], a[236:239], a[12:15], v[40:43]
M v[44:47], a[236:239], a[68:71], v[44:47]
M v[208:211], a[236:239], a[124:127], v[208:211]
s_add_u32 m0, s55, 32768
s_mov_b32 s40, 196608
buffer_load_dwordx4 v9, s[12:15], s40 offen nt lds
R a[196:199], v17, 0
WL 5
M v[40:43], a[240:243], a[16:19], v[40:43]
M v[44:47], a[240:243], a[72:75], v[44:47]
M v[208:211], a[240:243], a[128:131], v[208:211]
s_add_u32 m0, s55, 36864
s_mov_b32 s40, 200704
buffer_load_dwordx4 v9, s[12:15], s40 offen nt lds
R a[200:203], v18, 0
WL 5
M v[40:43], a[244:247], a[20:23], v[40:43]
M v[44:47], a[244:247], a[76:79], v[44:47]
M v[208:211], a[244:247], a[132:135], v[208:211]
s_add_u32 m0, s55, 40960
s_mov_b32 s40, 204800
buffer_load_dwordx4 v9, s[12:15], s40 offen nt lds
R a[204:207], v19, 0
WL 5
M v[40:43], a[248:251], a[24:27], v[40:43]
M v[44:47], a[248:251], a[80:83], v[44:47]
M v[208:211], a[248:251], a[136:139], v[208:211]
s_add_u32 m0, s55, 45056
s_mov_b32 s40, 208896
buffer_load_dwordx4 v9, s[12:15], s40 offen nt lds
R a[208:211], v20, 0
WL 5
M v[40:43], a[252:255], a[28:31], v[40:43]
M v[44:47], a[252:255], a[84:87], v[44:47]
M v[208:211], a[252:255], a[140:143], v[208:211]
R a[212:215], v21, 0
WL 5
M v[32:35], a[192:195], a[0:3], 0
M v[36:39], a[192:195], a[56:59], 0
s_nop 8
v_max3_f32 v2, v40, v41, v2
CV v82, v40, v41
v_max3_f32 v2, v42, v43, v2
CV v83, v42, v43
v_max3_f32 v3, v44, v45, v3
CV v146, v44, v45
v_max3_f32 v3, v46, v47, v3
CV v147, v46, v47
s_mov_b64 vcc, s[68:69]
s_cbranch_vccz Ls8_10
v_max3_f32 v225, v208, v209, v225
CV v196, v208, v209
v_max3_f32 v225, v210, v211, v225
CV v197, v210, v211
Ls8_10:
M v[208:211], a[192:195], a[112:115], 0
R a[216:219], v22, 0
WL 5
M v[32:35], a[196:199], a[4:7], v[32:35]
M v[36:39], a[196:199], a[60:63], v[36:39]
M v[208:211], a[196:199], a[116:119], v[208:211]
R a[220:223], v23, 0
WL 5
M v[32:35], a[200:203], a[8:11], v[32:35]
M v[36:39], a[200:203], a[64:67], v[36:39]
M v[208:211], a[200:203], a[120:123], v[208:211]
R a[224:227], v16, 8192
WL 5
M v[32:35], a[204:207], a[12:15], v[32:35]
M v[36:39], a[204:207], a[68:71], v[36:39]
M v[208:211], a[204:207], a[124:127], v[208:211]
R a[228:231], v17, 8192
WL 5
M v[32:35], a[208:211], a[16:19], v[32:35]
M v[36:39], a[208:211], a[72:75], v[36:39]
M v[208:211], a[208:211], a[128:131], v[208:211]
R a[232:235], v18, 8192
WL 5
M v[32:35], a[212:215], a[20:23], v[32:35]
M v[36:39], a[212:215], a[76:79], v[36:39]
M v[208:211], a[212:215], a[132:135], v[208:211]
R a[236:239], v19, 8192
WL 5
M v[32:35], a[216:219], a[24:27], v[32:35]
M v[36:39], a[216:219], a[80:83], v[36:39]
M v[208:211], a[216:219], a[136:139], v[208:211]
R a[240:243], v20, 8192
WL 5
M v[32:35], a[220:223], a[28:31], v[32:35]
M v[36:39], a[220:223], a[84:87], v[36:39]
M v[208:211], a[220:223], a[140:143], v[208:211]
R a[244:247], v21, 8192
WL 5
M v[40:43], a[224:227], a[0:3], 0
M v[44:47], a[224:227], a[56:59], 0
s_nop 8
v_max3_f32 v2, v32, v33, v2
CV v84, v32, v33
v_max3_f32 v2, v34, v35, v2
CV v85, v34, v35
v_max3_f32 v3, v36, v37, v3
CV v148, v36, v37
v_max3_f32 v3, v38, v39, v3
CV v149, v38, v39
s_mov_b64 vcc, s[70:71]
s_cbranch_vccz Ls8_11
v_max3_f32 v225, v208, v209, v225
CV v196, v208, v209
v_max3_f32 v225, v210, v211, v225
CV v197, v210, v211
Ls8_11:
M v[208:211], a[224:227], a[112:115], 0
R a[248:251], v22, 8192
WL 5
M v[40:43], a[228:231], a[4:7], v[40:43]
M v[44:47], a[228:231], a[60:63], v[44:47]
M v[208:211], a[228:231], a[116:119], v[208:211]
R a[252:255], v23, 8192
WL 5
M v[40:43], a[232:235], a[8:11], v[40:43]
M v[44:47], a[232:235], a[64:67], v[44:47]
M v[208:211], a[232:235], a[120:123], v[208:211]
s_waitcnt vmcnt(24)
s_barrier
v_add_u32 v16, 65536, v16
v_add_u32 v17, 65536, v17
v_add_u32 v18, 65536, v18
v_add_u32 v19, 65536, v19
v_add_u32 v20, 65536, v20
v_add_u32 v21, 65536, v21
v_add_u32 v22, 65536, v22
v_add_u32 v23, 65536, v23
R a[192:195], v16, 49152
WL 5
M v[40:43], a[236:239], a[12:15], v[40:43]
M v[44:47], a[236:239], a[68:71], v[44:47]
M v[208:211], a[236:239], a[124:127], v[208:211]
s_add_u32 m0, s55, 49152
s_mov_b32 s40, 212992
buffer_load_dwordx4 v9, s[12:15], s40 offen nt lds
R a[196:199], v17, 49152
WL 5
M v[40:43], a[240:243], a[16:19], v[40:43]
M v[44:47], a[240:243], a[72:75], v[44:47]
M v[208:211], a[240:243], a[128:131], v[208:211]
s_add_u32 m0, s55, 53248
s_mov_b32 s40, 217088
buffer_load_dwordx4 v9, s[12:15], s40 offen nt lds
R a[200:203], v18, 49152
WL 5
M v[40:43], a[244:247], a[20:23], v[40:43]
M v[44:47], a[244:247], a[76:79], v[44:47]
M v[208:211], a[244:247], a[132:135], v[208:211]
s_add_u32 m0, s55, 57344
s_mov_b32 s40, 221184
buffer_load_dwordx4 v9, s[12:15], s40 offen nt lds
R a[204:207], v19, 49152
WL 5
M v[40:43], a[248:251], a[24:27], v[40:43]
M v[44:47], a[248:251], a[80:83], v[44:47]
M v[208:211], a[248:251], a[136:139], v[208:211]
s_add_u32 m0, s55, 61440
s_mov_b32 s40, 225280
buffer_load_dwordx4 v9, s[12:15], s40 offen nt lds
R a[208:211], v20, 49152
WL 5
M v[40:43], a[252:255], a[28:31], v[40:43]
M v[44:47], a[252:255], a[84:87], v[44:47]
M v[208:211], a[252:255], a[140:143], v[208:211]
R a[212:215], v21, 49152
WL 5
M v[32:35], a[192:195], a[0:3], 0
M v[36:39], a[192:195], a[56:59], 0
s_nop 8
v_max3_f32 v2, v40, v41, v2
CV v86, v40, v41
v_max3_f32 v2, v42, v43, v2
CV v87, v42, v43
v_max3_f32 v3, v44, v45, v3
CV v150, v44, v45
v_max3_f32 v3, v46, v47, v3
CV v151, v46, v47
s_mov_b64 vcc, s[72:73]
s_cbranch_vccz Ls8_12
v_max3_f32 v225, v208, v209, v225
CV v196, v208, v209
v_max3_f32 v225, v210, v211, v225
CV v197, v210, v211
Ls8_12:
M v[208:211], a[192:195], a[112:115], 0
R a[216:219], v22, 49152
WL 5
M v[32:35], a[196:199], a[4:7], v[32:35]
M v[36:39], a[196:199], a[60:63], v[36:39]
M v[208:211], a[196:199], a[116:119], v[208:211]
R a[220:223], v23, 49152
WL 5
M v[32:35], a[200:203], a[8:11], v[32:35]
M v[36:39], a[200:203], a[64:67], v[36:39]
M v[208:211], a[200:203], a[120:123], v[208:211]
R a[224:227], v16, 57344
WL 5
M v[32:35], a[204:207], a[12:15], v[32:35]
M v[36:39], a[204:207], a[68:71], v[36:39]
M v[208:211], a[204:207], a[124:127], v[208:211]
R a[228:231], v17, 57344
WL 5
M v[32:35], a[208:211], a[16:19], v[32:35]
M v[36:39], a[208:211], a[72:75], v[36:39]
M v[208:211], a[208:211], a[128:131], v[208:211]
R a[232:235], v18, 57344
WL 5
M v[32:35], a[212:215], a[20:23], v[32:35]
M v[36:39], a[212:215], a[76:79], v[36:39]
M v[208:211], a[212:215], a[132:135], v[208:211]
R a[236:239], v19, 57344
WL 5
M v[32:35], a[216:219], a[24:27], v[32:35]
M v[36:39], a[216:219], a[80:83], v[36:39]
M v[208:211], a[216:219], a[136:139], v[208:211]
R a[240:243], v20, 57344
WL 5
M v[32:35], a[220:223], a[28:31], v[32:35]
M v[36:39], a[220:223], a[84:87], v[36:39]
M v[208:211], a[220:223], a[140:143], v[208:211]
R a[244:247], v21, 57344
WL 5
M v[40:43], a[224:227], a[0:3], 0
M v[44:47], a[224:227], a[56:59], 0
s_nop 8
v_max3_f32 v2, v32, v33, v2
CV v88, v32, v33
v_max3_f32 v2, v34, v35, v2
CV v89, v34, v35
v_max3_f32 v3, v36, v37, v3
CV v152, v36, v37
v_max3_f32 v3, v38, v39, v3
CV v153, v38, v39
s_mov_b64 vcc, s[66:67]
s_cbranch_vccz Ls8_13
v_max3_f32 v225, v208, v209, v225
CV v198, v208, v209
v_max3_f32 v225, v210, v211, v225
CV v199, v210, v211
Ls8_13:
M v[208:211], a[224:227], a[112:115], 0
R a[248:251], v22, 57344
WL 5
M v[40:43], a[228:231], a[4:7], v[40:43]
M v[44:47], a[228:231], a[60:63], v[44:47]
M v[208:211], a[228:231], a[116:119], v[208:211]
R a[252:255], v23, 57344
WL 5
M v[40:43], a[232:235], a[8:11], v[40:43]
M v[44:47], a[232:235], a[64:67], v[44:47]
M v[208:211], a[232:235], a[120:123], v[208:211]
s_waitcnt vmcnt(24)
s_barrier
v_add_u32 v16, 65536, v16
v_add_u32 v17, 65536, v17
v_add_u32 v18, 65536, v18
v_add_u32 v19, 65536, v19
v_add_u32 v20, 65536, v20
v_add_u32 v21, 65536, v21
v_add_u32 v22, 65536, v22
v_add_u32 v23, 65536, v23
R a[192:195], v16, 0
WL 5
M v[40:43], a[236:239], a[12:15], v[40:43]
M v[44:47], a[236:239], a[68:71], v[44:47]
M v[208:211], a[236:239], a[124:127], v[208:211]
s_add_u32 m0, s55, 0
s_mov_b32 s40, 229376
buffer_load_dwordx4 v9, s[12:15], s40 offen nt lds
R a[196:199], v17, 0
WL 5
M v[40:43], a[240:243], a[16:19], v[40:43]
M v[44:47], a[240:243], a[72:75], v[44:47]
M v[208:211], a[240:243], a[128:131], v[208:211]
s_add_u32 m0, s55, 4096
s_mov_b32 s40, 233472
buffer_load_dwordx4 v9, s[12:15], s40 offen nt lds
R a[200:203], v18, 0
WL 5
M v[40:43], a[244:247], a[20:23], v[40:43]
M v[44:47], a[244:247], a[76:79], v[44:47]
M v[208:211], a[244:247], a[132:135], v[208:211]
s_add_u32 m0, s55, 8192
s_mov_b32 s40, 237568
buffer_load_dwordx4 v9, s[12:15], s40 offen nt lds
R a[204:207], v19, 0
WL 5
M v[40:43], a[248:251], a[24:27], v[40:43]
M v[44:47], a[248:251], a[80:83], v[44:47]
M v[208:211], a[248:251], a[136:139], v[208:211]
s_add_u32 m0, s55, 12288
s_mov_b32 s40, 241664
buffer_load_dwordx4 v9, s[12:15], s40 offen nt lds
R a[208:211], v20, 0
WL 5
M v[40:43], a[252:255], a[28:31], v[40:43]
M v[44:47], a[252:255], a[84:87], v[44:47]
M v[208:211], a[252:255], a[140:143], v[208:211]
R a[212:215], v21, 0
WL 5
M v[32:35], a[192:195], a[0:3], 0
M v[36:39], a[192:195], a[56:59], 0
s_nop 8
v_max3_f32 v2, v40, v41, v2
CV v90, v40, v41
v_max3_f32 v2, v42, v43, v2
CV v91, v42, v43
v_max3_f32 v3, v44, v45, v3
CV v154, v44, v45
v_max3_f32 v3, v46, v47, v3
CV v155, v46, v47
s_mov_b64 vcc, s[68:69]
s_cbranch_vccz Ls8_14
v_max3_f32 v225, v208, v209, v225
CV v198, v208, v209
v_max3_f32 v225, v210, v211, v225
CV v199, v210, v211
Ls8_14:
M v[208:211], a[192:195], a[112:115], 0
R a[216:219], v22, 0
WL 5
M v[32:35], a[196:199], a[4:7], v[32:35]
M v[36:39], a[196:199], a[60:63], v[36:39]
M v[208:211], a[196:199], a[116:119], v[208:211]
R a[220:223], v23, 0
WL 5
M v[32:35], a[200:203], a[8:11], v[32:35]
M v[36:39], a[200:203], a[64:67], v[36:39]
M v[208:211], a[200:203], a[120:123], v[208:211]
R a[224:227], v16, 8192
WL 5
M v[32:35], a[204:207], a[12:15], v[32:35]
M v[36:39], a[204:207], a[68:71], v[36:39]
M v[208:211], a[204:207], a[124:127], v[208:211]
R a[228:231], v17, 8192
WL 5
M v[32:35], a[208:211], a[16:19], v[32:35]
M v[36:39], a[208:211], a[72:75], v[36:39]
M v[208:211], a[208:211], a[128:131], v[208:211]
R a[232:235], v18, 8192
WL 5
M v[32:35], a[212:215], a[20:23], v[32:35]
M v[36:39], a[212:215], a[76:79], v[36:39]
M v[208:211], a[212:215], a[132:135], v[208:211]
R a[236:239], v19, 8192
WL 5
M v[32:35], a[216:219], a[24:27], v[32:35]
M v[36:39], a[216:219], a[80:83], v[36:39]
M v[208:211], a[216:219], a[136:139], v[208:211]
R a[240:243], v20, 8192
WL 5
M v[32:35], a[220:223], a[28:31], v[32:35]
M v[36:39], a[220:223], a[84:87], v[36:39]
M v[208:211], a[220:223], a[140:143], v[208:211]
R a[244:247], v21, 8192
WL 5
M v[40:43], a[224:227], a[0:3], 0
M v[44:47], a[224:227], a[56:59], 0
s_nop 8
v_max3_f32 v2, v32, v33, v2
CV v92, v32, v33
v_max3_f32 v2, v34, v35, v2
CV v93, v34, v35
v_max3_f32 v3, v36, v37, v3
CV v156, v36, v37
v_max3_f32 v3, v38, v39, v3
CV v157, v38, v39
s_mov_b64 vcc, s[70:71]
s_cbranch_vccz Ls8_15
v_max3_f32 v225, v208, v209, v225
CV v198, v208, v209
v_max3_f32 v225, v210, v211, v225
CV v199, v210, v211
Ls8_15:
M v[208:211], a[224:227], a[112:115], 0
R a[248:251], v22, 8192
WL 5
M v[40:43], a[228:231], a[4:7], v[40:43]
M v[44:47], a[228:231], a[60:63], v[44:47]
M v[208:211], a[228:231], a[116:119], v[208:211]
R a[252:255], v23, 8192
WL 5
M v[40:43], a[232:235], a[8:11], v[40:43]
M v[44:47], a[232:235], a[64:67], v[44:47]
M v[208:211], a[232:235], a[120:123], v[208:211]
s_waitcnt vmcnt(24)
s_barrier
v_add_u32 v16, 4294836224, v16
v_add_u32 v17, 4294836224, v17
v_add_u32 v18, 4294836224, v18
v_add_u32 v19, 4294836224, v19
v_add_u32 v20, 4294836224, v20
v_add_u32 v21, 4294836224, v21
v_add_u32 v22, 4294836224, v22
v_add_u32 v23, 4294836224, v23
R a[192:195], v16, 16384
WL 5
M v[40:43], a[236:239], a[12:15], v[40:43]
M v[44:47], a[236:239], a[68:71], v[44:47]
M v[208:211], a[236:239], a[124:127], v[208:211]
s_add_u32 m0, s55, 114688
s_mov_b32 s40, 245760
buffer_load_dwordx4 v9, s[12:15], s40 offen nt lds
R a[196:199], v17, 16384
WL 5
M v[40:43], a[240:243], a[16:19], v[40:43]
M v[44:47], a[240:243], a[72:75], v[44:47]
M v[208:211], a[240:243], a[128:131], v[208:211]
s_add_u32 m0, s55, 118784
s_mov_b32 s40, 249856
buffer_load_dwordx4 v9, s[12:15], s40 offen nt lds
R a[200:203], v18, 16384
WL 5
M v[40:43], a[244:247], a[20:23], v[40:43]
M v[44:47], a[244:247], a[76:79], v[44:47]
M v[208:211], a[244:247], a[132:135], v[208:211]
s_add_u32 m0, s55, 122880
s_mov_b32 s40, 253952
buffer_load_dwordx4 v9, s[12:15], s40 offen nt lds
R a[204:207], v19, 16384
WL 5
M v[40:43], a[248:251], a[24:27], v[40:43]
M v[44:47], a[248:251], a[80:83], v[44:47]
M v[208:211], a[248:251], a[136:139], v[208:211]
s_add_u32 m0, s55, 126976
s_mov_b32 s40, 258048
buffer_load_dwordx4 v9, s[12:15], s40 offen nt lds
R a[208:211], v20, 16384
WL 5
M v[40:43], a[252:255], a[28:31], v[40:43]
M v[44:47], a[252:255], a[84:87], v[44:47]
M v[208:211], a[252:255], a[140:143], v[208:211]
R a[212:215], v21, 16384
WL 5
M v[32:35], a[192:195], a[0:3], 0
M v[36:39], a[192:195], a[56:59], 0
s_nop 8
v_max3_f32 v2, v40, v41, v2
CV v94, v40, v41
v_max3_f32 v2, v42, v43, v2
CV v95, v42, v43
v_max3_f32 v3, v44, v45, v3
CV v158, v44, v45
v_max3_f32 v3, v46, v47, v3
CV v159, v46, v47
s_mov_b64 vcc, s[72:73]
s_cbranch_vccz Ls8_16
v_max3_f32 v225, v208, v209, v225
CV v198, v208, v209
v_max3_f32 v225, v210, v211, v225
CV v199, v210, v211
Ls8_16:
M v[208:211], a[192:195], a[112:115], 0
R a[216:219], v22, 16384
WL 5
M v[32:35], a[196:199], a[4:7], v[32:35]
M v[36:39], a[196:199], a[60:63], v[36:39]
M v[208:211], a[196:199], a[116:119], v[208:211]
R a[220:223], v23, 16384
WL 5
M v[32:35], a[200:203], a[8:11], v[32:35]
M v[36:39], a[200:203], a[64:67], v[36:39]
M v[208:211], a[200:203], a[120:123], v[208:211]
R a[224:227], v16, 24576
WL 5
M v[32:35], a[204:207], a[12:15], v[32:35]
M v[36:39], a[204:207], a[68:71], v[36:39]
M v[208:211], a[204:207], a[124:127], v[208:211]
R a[228:231], v17, 24576
WL 5
M v[32:35], a[208:211], a[16:19], v[32:35]
M v[36:39], a[208:211], a[72:75], v[36:39]
M v[208:211], a[208:211], a[128:131], v[208:211]
R a[232:235], v18, 24576
WL 5
M v[32:35], a[212:215], a[20:23], v[32:35]
M v[36:39], a[212:215], a[76:79], v[36:39]
M v[208:211], a[212:215], a[132:135], v[208:211]
R a[236:239], v19, 24576
WL 5
M v[32:35], a[216:219], a[24:27], v[32:35]
M v[36:39], a[216:219], a[80:83], v[36:39]
M v[208:211], a[216:219], a[136:139], v[208:211]
R a[240:243], v20, 24576
WL 5
M v[32:35], a[220:223], a[28:31], v[32:35]
M v[36:39], a[220:223], a[84:87], v[36:39]
M v[208:211], a[220:223], a[140:143], v[208:211]
R a[244:247], v21, 24576
WL 5
M v[40:43], a[224:227], a[0:3], 0
M v[44:47], a[224:227], a[56:59], 0
s_nop 8
v_max3_f32 v2, v32, v33, v2
CV v96, v32, v33
v_max3_f32 v2, v34, v35, v2
CV v97, v34, v35
v_max3_f32 v3, v36, v37, v3
CV v160, v36, v37
v_max3_f32 v3, v38, v39, v3
CV v161, v38, v39
s_mov_b64 vcc, s[66:67]
s_cbranch_vccz Ls8_17
v_max3_f32 v225, v208, v209, v225
CV v200, v208, v209
v_max3_f32 v225, v210, v211, v225
CV v201, v210, v211
Ls8_17:
M v[208:211], a[224:227], a[112:115], 0
R a[248:251], v22, 24576
WL 5
M v[40:43], a[228:231], a[4:7], v[40:43]
M v[44:47], a[228:231], a[60:63], v[44:47]
M v[208:211], a[228:231], a[116:119], v[208:211]
R a[252:255], v23, 24576
WL 5
M v[40:43], a[232:235], a[8:11], v[40:43]
M v[44:47], a[232:235], a[64:67], v[44:47]
M v[208:211], a[232:235], a[120:123], v[208:211]
s_waitcnt vmcnt(24)
s_barrier
v_add_u32 v16, 65536, v16
v_add_u32 v17, 65536, v17
v_add_u32 v18, 65536, v18
v_add_u32 v19, 65536, v19
v_add_u32 v20, 65536, v20
v_add_u32 v21, 65536, v21
v_add_u32 v22, 65536, v22
v_add_u32 v23, 65536, v23
R a[192:195], v16, 0
WL 5
M v[40:43], a[236:239], a[12:15], v[40:43]
M v[44:47], a[236:239], a[68:71], v[44:47]
M v[208:211], a[236:239], a[124:127], v[208:211]
s_add_u32 m0, s55, 131072
s_mov_b32 s40, 0
buffer_load_dwordx4 v9, s[16:19], s40 offen nt lds
R a[196:199], v17, 0
WL 5
M v[40:43], a[240:243], a[16:19], v[40:43]
M v[44:47], a[240:243], a[72:75], v[44:47]
M v[208:211], a[240:243], a[128:131], v[208:211]
s_add_u32 m0, s55, 135168
s_mov_b32 s40, 4096
buffer_load_dwordx4 v9, s[16:19], s40 offen nt lds
R a[200:203], v18, 0
WL 5
M v[40:43], a[244:247], a[20:23], v[40:43]
M v[44:47], a[244:247], a[76:79], v[44:47]
M v[208:211], a[244:247], a[132:135], v[208:211]
s_add_u32 m0, s55, 139264
s_mov_b32 s40, 8192
buffer_load_dwordx4 v9, s[16:19], s40 offen nt lds
R a[204:207], v19, 0
WL 5
M v[40:43], a[248:251], a[24:27], v[40:43]
M v[44:47], a[248:251], a[80:83], v[44:47]
M v[208:211], a[248:251], a[136:139], v[208:211]
s_add_u32 m0, s55, 143360
s_mov_b32 s40, 12288
buffer_load_dwordx4 v9, s[16:19], s40 offen nt lds
R a[208:211], v20, 0
WL 5
M v[40:43], a[252:255], a[28:31], v[40:43]
M v[44:47], a[252:255], a[84:87], v[44:47]
M v[208:211], a[252:255], a[140:143], v[208:211]
R a[212:215], v21, 0
WL 5
M v[32:35], a[192:195], a[0:3], 0
M v[36:39], a[192:195], a[56:59], 0
s_nop 8
v_max3_f32 v2, v40, v41, v2
CV v98, v40, v41
v_max3_f32 v2, v42, v43, v2
CV v99, v42, v43
v_max3_f32 v3, v44, v45, v3
CV v162, v44, v45
v_max3_f32 v3, v46, v47, v3
CV v163, v46, v47
s_mov_b64 vcc, s[68:69]
s_cbranch_vccz Ls8_18
v_max3_f32 v225, v208, v209, v225
CV v200, v208, v209
v_max3_f32 v225, v210, v211, v225
CV v201, v210, v211
Ls8_18:
M v[208:211], a[192:195], a[112:115], 0
R a[216:219], v22, 0
WL 5
M v[32:35], a[196:199], a[4:7], v[32:35]
M v[36:39], a[196:199], a[60:63], v[36:39]
M v[208:211], a[196:199], a[116:119], v[208:211]
R a[220:223], v23, 0
WL 5
M v[32:35], a[200:203], a[8:11], v[32:35]
M v[36:39], a[200:203], a[64:67], v[36:39]
M v[208:211], a[200:203], a[120:123], v[208:211]
R a[224:227], v16, 8192
WL 5
M v[32:35], a[204:207], a[12:15], v[32:35]
M v[36:39], a[204:207], a[68:71], v[36:39]
M v[208:211], a[204:207], a[124:127], v[208:211]
R a[228:231], v17, 8192
WL 5
M v[32:35], a[208:211], a[16:19], v[32:35]
M v[36:39], a[208:211], a[72:75], v[36:39]
M v[208:211], a[208:211], a[128:131], v[208:211]
R a[232:235], v18, 8192
WL 5
M v[32:35], a[212:215], a[20:23], v[32:35]
M v[36:39], a[212:215], a[76:79], v[36:39]
M v[208:211], a[212:215], a[132:135], v[208:211]
R a[236:239], v19, 8192
WL 5
M v[32:35], a[216:219], a[24:27], v[32:35]
M v[36:39], a[216:219], a[80:83], v[36:39]
M v[208:211], a[216:219], a[136:139], v[208:211]
R a[240:243], v20, 8192
WL 5
M v[32:35], a[220:223], a[28:31], v[32:35]
M v[36:39], a[220:223], a[84:87], v[36:39]
M v[208:211], a[220:223], a[140:143], v[208:211]
R a[244:247], v21, 8192
WL 5
M v[40:43], a[224:227], a[0:3], 0
M v[44:47], a[224:227], a[56:59], 0
s_nop 8
v_max3_f32 v2, v32, v33, v2
CV v100, v32, v33
v_max3_f32 v2, v34, v35, v2
CV v101, v34, v35
v_max3_f32 v3, v36, v37, v3
CV v164, v36, v37
v_max3_f32 v3, v38, v39, v3
CV v165, v38, v39
s_mov_b64 vcc, s[70:71]
s_cbranch_vccz Ls8_19
v_max3_f32 v225, v208, v209, v225
CV v200, v208, v209
v_max3_f32 v225, v210, v211, v225
CV v201, v210, v211
Ls8_19:
M v[208:211], a[224:227], a[112:115], 0
R a[248:251], v22, 8192
WL 5
M v[40:43], a[228:231], a[4:7], v[40:43]
M v[44:47], a[228:231], a[60:63], v[44:47]
M v[208:211], a[228:231], a[116:119], v[208:211]
R a[252:255], v23, 8192
WL 5
M v[40:43], a[232:235], a[8:11], v[40:43]
M v[44:47], a[232:235], a[64:67], v[44:47]
M v[208:211], a[232:235], a[120:123], v[208:211]
s_waitcnt vmcnt(24)
s_barrier
R a[192:195], v16, 16384
WL 5
M v[40:43], a[236:239], a[12:15], v[40:43]
M v[44:47], a[236:239], a[68:71], v[44:47]
M v[208:211], a[236:239], a[124:127], v[208:211]
s_add_u32 m0, s55, 16384
s_mov_b32 s40, 16384
buffer_load_dwordx4 v9, s[16:19], s40 offen nt lds
R a[196:199], v17, 16384
WL 5
M v[40:43], a[240:243], a[16:19], v[40:43]
M v[44:47], a[240:243], a[72:75], v[44:47]
M v[208:211], a[240:243], a[128:131], v[208:211]
s_add_u32 m0, s55, 20480
s_mov_b32 s40, 20480
buffer_load_dwordx4 v9, s[16:19], s40 offen nt lds
R a[200:203], v18, 16384
WL 5
M v[40:43], a[244:247], a[20:23], v[40:43]
M v[44:47], a[244:247], a[76:79], v[44:47]
M v[208:211], a[244:247], a[132:135], v[208:211]
s_add_u32 m0, s55, 24576
s_mov_b32 s40, 24576
buffer_load_dwordx4 v9, s[16:19], s40 offen nt lds
R a[204:207], v19, 16384
WL 5
M v[40:43], a[248:251], a[24:27], v[40:43]
M v[44:47], a[248:251], a[80:83], v[44:47]
M v[208:211], a[248:251], a[136:139], v[208:211]
s_add_u32 m0, s55, 28672
s_mov_b32 s40, 28672
buffer_load_dwordx4 v9, s[16:19], s40 offen nt lds
R a[208:211], v20, 16384
WL 5
M v[40:43], a[252:255], a[28:31], v[40:43]
M v[44:47], a[252:255], a[84:87], v[44:47]
M v[208:211], a[252:255], a[140:143], v[208:211]
R a[212:215], v21, 16384
WL 5
M v[32:35], a[192:195], a[0:3], 0
M v[36:39], a[192:195], a[56:59], 0
s_nop 8
v_max3_f32 v2, v40, v41, v2
CV v102, v40, v41
v_max3_f32 v2, v42, v43, v2
CV v103, v42, v43
v_max3_f32 v3, v44, v45, v3
CV v166, v44, v45
v_max3_f32 v3, v46, v47, v3
CV v167, v46, v47
s_mov_b64 vcc, s[72:73]
s_cbranch_vccz Ls8_20
v_max3_f32 v225, v208, v209, v225
CV v200, v208, v209
v_max3_f32 v225, v210, v211, v225
CV v201, v210, v211
Ls8_20:
M v[208:211], a[192:195], a[112:115], 0
R a[216:219], v22, 16384
WL 5
M v[32:35], a[196:199], a[4:7], v[32:35]
M v[36:39], a[196:199], a[60:63], v[36:39]
M v[208:211], a[196:199], a[116:119], v[208:211]
R a[220:223], v23, 16384
WL 5
M v[32:35], a[200:203], a[8:11], v[32:35]
M v[36:39], a[200:203], a[64:67], v[36:39]
M v[208:211], a[200:203], a[120:123], v[208:211]
R a[224:227], v16, 24576
WL 5
M v[32:35], a[204:207], a[12:15], v[32:35]
M v[36:39], a[204:207], a[68:71], v[36:39]
M v[208:211], a[204:207], a[124:127], v[208:211]
R a[228:231], v17, 24576
WL 5
M v[32:35], a[208:211], a[16:19], v[32:35]
M v[36:39], a[208:211], a[72:75], v[36:39]
M v[208:211], a[208:211], a[128:131], v[208:211]
R a[232:235], v18, 24576
WL 5
M v[32:35], a[212:215], a[20:23], v[32:35]
M v[36:39], a[212:215], a[76:79], v[36:39]
M v[208:211], a[212:215], a[132:135], v[208:211]
R a[236:239], v19, 24576
WL 5
M v[32:35], a[216:219], a[24:27], v[32:35]
M v[36:39], a[216:219], a[80:83], v[36:39]
M v[208:211], a[216:219], a[136:139], v[208:211]
R a[240:243], v20, 24576
WL 5
M v[32:35], a[220:223], a[28:31], v[32:35]
M v[36:39], a[220:223], a[84:87], v[36:39]
M v[208:211], a[220:223], a[140:143], v[208:211]
R a[244:247], v21, 24576
WL 5
M v[40:43], a[224:227], a[0:3], 0
M v[44:47], a[224:227], a[56:59], 0
s_nop 8
v_max3_f32 v2, v32, v33, v2
CV v104, v32, v33
v_max3_f32 v2, v34, v35, v2
CV v105, v34, v35
v_max3_f32 v3, v36, v37, v3
CV v168, v36, v37
v_max3_f32 v3, v38, v39, v3
CV v169, v38, v39
s_mov_b64 vcc, s[66:67]
s_cbranch_vccz Ls8_21
v_max3_f32 v225, v208, v209, v225
CV v202, v208, v209
v_max3_f32 v225, v210, v211, v225
CV v203, v210, v211
Ls8_21:
M v[208:211], a[224:227], a[112:115], 0
R a[248:251], v22, 24576
WL 5
M v[40:43], a[228:231], a[4:7], v[40:43]
M v[44:47], a[228:231], a[60:63], v[44:47]
M v[208:211], a[228:231], a[116:119], v[208:211]
R a[252:255], v23, 24576
WL 5
M v[40:43], a[232:235], a[8:11], v[40:43]
M v[44:47], a[232:235], a[64:67], v[44:47]
M v[208:211], a[232:235], a[120:123], v[208:211]
s_waitcnt vmcnt(24)
s_barrier
R a[192:195], v16, 32768
WL 5
M v[40:43], a[236:239], a[12:15], v[40:43]
M v[44:47], a[236:239], a[68:71], v[44:47]
M v[208:211], a[236:239], a[124:127], v[208:211]
s_add_u32 m0, s55, 65536
s_mov_b32 s40, 32768
buffer_load_dwordx4 v9, s[16:19], s40 offen nt lds
R a[196:199], v17, 32768
WL 5
M v[40:43], a[240:243], a[16:19], v[40:43]
M v[44:47], a[240:243], a[72:75], v[44:47]
M v[208:211], a[240:243], a[128:131], v[208:211]
s_add_u32 m0, s55, 69632
s_mov_b32 s40, 36864
buffer_load_dwordx4 v9, s[16:19], s40 offen nt lds
R a[200:203], v18, 32768
WL 5
M v[40:43], a[244:247], a[20:23], v[40:43]
M v[44:47], a[244:247], a[76:79], v[44:47]
M v[208:211], a[244:247], a[132:135], v[208:211]
s_add_u32 m0, s55, 73728
s_mov_b32 s40, 40960
buffer_load_dwordx4 v9, s[16:19], s40 offen nt lds
R a[204:207], v19, 32768
WL 5
M v[40:43], a[248:251], a[24:27], v[40:43]
M v[44:47], a[248:251], a[80:83], v[44:47]
M v[208:211], a[248:251], a[136:139], v[208:211]
s_add_u32 m0, s55, 77824
s_mov_b32 s40, 45056
buffer_load_dwordx4 v9, s[16:19], s40 offen nt lds
R a[208:211], v20, 32768
WL 5
M v[40:43], a[252:255], a[28:31], v[40:43]
M v[44:47], a[252:255], a[84:87], v[44:47]
M v[208:211], a[252:255], a[140:143], v[208:211]
R a[212:215], v21, 32768
WL 5
M v[32:35], a[192:195], a[0:3], 0
M v[36:39], a[192:195], a[56:59], 0
s_nop 8
v_max3_f32 v2, v40, v41, v2
CV v106, v40, v41
v_max3_f32 v2, v42, v43, v2
CV v107, v42, v43
v_max3_f32 v3, v44, v45, v3
CV v170, v44, v45
v_max3_f32 v3, v46, v47, v3
CV v171, v46, v47
s_mov_b64 vcc, s[68:69]
s_cbranch_vccz Ls8_22
v_max3_f32 v225, v208, v209, v225
CV v202, v208, v209
v_max3_f32 v225, v210, v211, v225
CV v203, v210, v211
Ls8_22:
M v[208:211], a[192:195], a[112:115], 0
R a[216:219], v22, 32768
WL 5
M v[32:35], a[196:199], a[4:7], v[32:35]
M v[36:39], a[196:199], a[60:63], v[36:39]
M v[208:211], a[196:199], a[116:119], v[208:211]
R a[220:223], v23, 32768
WL 5
M v[32:35], a[200:203], a[8:11], v[32:35]
M v[36:39], a[200:203], a[64:67], v[36:39]
M v[208:211], a[200:203], a[120:123], v[208:211]
R a[224:227], v16, 40960
WL 5
M v[32:35], a[204:207], a[12:15], v[32:35]
M v[36:39], a[204:207], a[68:71], v[36:39]
M v[208:211], a[204:207], a[124:127], v[208:211]
R a[228:231], v17, 40960
WL 5
M v[32:35], a[208:211], a[16:19], v[32:35]
M v[36:39], a[208:211], a[72:75], v[36:39]
M v[208:211], a[208:211], a[128:131], v[208:211]
R a[232:235], v18, 40960
WL 5
M v[32:35], a[212:215], a[20:23], v[32:35]
M v[36:39], a[212:215], a[76:79], v[36:39]
M v[208:211], a[212:215], a[132:135], v[208:211]
R a[236:239], v19, 40960
WL 5
M v[32:35], a[216:219], a[24:27], v[32:35]
M v[36:39], a[216:219], a[80:83], v[36:39]
M v[208:211], a[216:219], a[136:139], v[208:211]
R a[240:243], v20, 40960
WL 5
M v[32:35], a[220:223], a[28:31], v[32:35]
M v[36:39], a[220:223], a[84:87], v[36:39]
M v[208:211], a[220:223], a[140:143], v[208:211]
R a[244:247], v21, 40960
WL 5
M v[40:43], a[224:227], a[0:3], 0
M v[44:47], a[224:227], a[56:59], 0
s_nop 8
v_max3_f32 v2, v32, v33, v2
CV v108, v32, v33
v_max3_f32 v2, v34, v35, v2
CV v109, v34, v35
v_max3_f32 v3, v36, v37, v3
CV v172, v36, v37
v_max3_f32 v3, v38, v39, v3
CV v173, v38, v39
s_mov_b64 vcc, s[70:71]
s_cbranch_vccz Ls8_23
v_max3_f32 v225, v208, v209, v225
CV v202, v208, v209
v_max3_f32 v225, v210, v211, v225
CV v203, v210, v211
Ls8_23:
M v[208:211], a[224:227], a[112:115], 0
R a[248:251], v22, 40960
WL 5
M v[40:43], a[228:231], a[4:7], v[40:43]
M v[44:47], a[228:231], a[60:63], v[44:47]
M v[208:211], a[228:231], a[116:119], v[208:211]
R a[252:255], v23, 40960
WL 5
M v[40:43], a[232:235], a[8:11], v[40:43]
M v[44:47], a[232:235], a[64:67], v[44:47]
M v[208:211], a[232:235], a[120:123], v[208:211]
s_waitcnt vmcnt(24)
s_barrier
v_add_u32 v16, 4294901760, v16
v_add_u32 v17, 4294901760, v17
v_add_u32 v18, 4294901760, v18
v_add_u32 v19, 4294901760, v19
v_add_u32 v20, 4294901760, v20
v_add_u32 v21, 4294901760, v21
v_add_u32 v22, 4294901760, v22
v_add_u32 v23, 4294901760, v23
R a[192:195], v16, 32768
WL 5
M v[40:43], a[236:239], a[12:15], v[40:43]
M v[44:47], a[236:239], a[68:71], v[44:47]
M v[208:211], a[236:239], a[124:127], v[208:211]
s_add_u32 m0, s55, 81920
s_mov_b32 s40, 49152
buffer_load_dwordx4 v9, s[16:19], s40 offen nt lds
R a[196:199], v17, 32768
WL 5
M v[40:43], a[240:243], a[16:19], v[40:43]
M v[44:47], a[240:243], a[72:75], v[44:47]
M v[208:211], a[240:243], a[128:131], v[208:211]
s_add_u32 m0, s55, 86016
s_mov_b32 s40, 53248
buffer_load_dwordx4 v9, s[16:19], s40 offen nt lds
R a[200:203], v18, 32768
WL 5
M v[40:43], a[244:247], a[20:23], v[40:43]
M v[44:47], a[244:247], a[76:79], v[44:47]
M v[208:211], a[244:247], a[132:135], v[208:211]
s_add_u32 m0, s55, 90112
s_mov_b32 s40, 57344
buffer_load_dwordx4 v9, s[16:19], s40 offen nt lds
R a[204:207], v19, 32768
WL 5
M v[40:43], a[248:251], a[24:27], v[40:43]
M v[44:47], a[248:251], a[80:83], v[44:47]
M v[208:211], a[248:251], a[136:139], v[208:211]
s_add_u32 m0, s55, 94208
s_mov_b32 s40, 61440
buffer_load_dwordx4 v9, s[16:19], s40 offen nt lds
R a[208:211], v20, 32768
WL 5
M v[40:43], a[252:255], a[28:31], v[40:43]
M v[44:47], a[252:255], a[84:87], v[44:47]
M v[208:211], a[252:255], a[140:143], v[208:211]
R a[212:215], v21, 32768
WL 5
M v[32:35], a[192:195], a[0:3], 0
M v[36:39], a[192:195], a[56:59], 0
s_nop 8
v_max3_f32 v2, v40, v41, v2
CV v110, v40, v41
v_max3_f32 v2, v42, v43, v2
CV v111, v42, v43
v_max3_f32 v3, v44, v45, v3
CV v174, v44, v45
v_max3_f32 v3, v46, v47, v3
CV v175, v46, v47
s_mov_b64 vcc, s[72:73]
s_cbranch_vccz Ls8_24
v_max3_f32 v225, v208, v209, v225
CV v202, v208, v209
v_max3_f32 v225, v210, v211, v225
CV v203, v210, v211
Ls8_24:
M v[208:211], a[192:195], a[112:115], 0
R a[216:219], v22, 32768
WL 5
M v[32:35], a[196:199], a[4:7], v[32:35]
M v[36:39], a[196:199], a[60:63], v[36:39]
M v[208:211], a[196:199], a[116:119], v[208:211]
R a[220:223], v23, 32768
WL 5
M v[32:35], a[200:203], a[8:11], v[32:35]
M v[36:39], a[200:203], a[64:67], v[36:39]
M v[208:211], a[200:203], a[120:123], v[208:211]
R a[224:227], v16, 40960
WL 5
M v[32:35], a[204:207], a[12:15], v[32:35]
M v[36:39], a[204:207], a[68:71], v[36:39]
M v[208:211], a[204:207], a[124:127], v[208:211]
R a[228:231], v17, 40960
WL 5
M v[32:35], a[208:211], a[16:19], v[32:35]
M v[36:39], a[208:211], a[72:75], v[36:39]
M v[208:211], a[208:211], a[128:131], v[208:211]
R a[232:235], v18, 40960
WL 5
M v[32:35], a[212:215], a[20:23], v[32:35]
M v[36:39], a[212:215], a[76:79], v[36:39]
M v[208:211], a[212:215], a[132:135], v[208:211]
R a[236:239], v19, 40960
WL 5
M v[32:35], a[216:219], a[24:27], v[32:35]
M v[36:39], a[216:219], a[80:83], v[36:39]
M v[208:211], a[216:219], a[136:139], v[208:211]
R a[240:243], v20, 40960
WL 5
M v[32:35], a[220:223], a[28:31], v[32:35]
M v[36:39], a[220:223], a[84:87], v[36:39]
M v[208:211], a[220:223], a[140:143], v[208:211]
R a[244:247], v21, 40960
WL 5
M v[40:43], a[224:227], a[0:3], 0
M v[44:47], a[224:227], a[56:59], 0
s_nop 8
v_max3_f32 v2, v32, v33, v2
CV v112, v32, v33
v_max3_f32 v2, v34, v35, v2
CV v113, v34, v35
v_max3_f32 v3, v36, v37, v3
CV v176, v36, v37
v_max3_f32 v3, v38, v39, v3
CV v177, v38, v39
s_mov_b64 vcc, s[66:67]
s_cbranch_vccz Ls8_25
v_max3_f32 v225, v208, v209, v225
CV v204, v208, v209
v_max3_f32 v225, v210, v211, v225
CV v205, v210, v211
Ls8_25:
M v[208:211], a[224:227], a[112:115], 0
R a[248:251], v22, 40960
WL 5
M v[40:43], a[228:231], a[4:7], v[40:43]
M v[44:47], a[228:231], a[60:63], v[44:47]
M v[208:211], a[228:231], a[116:119], v[208:211]
R a[252:255], v23, 40960
WL 5
M v[40:43], a[232:235], a[8:11], v[40:43]
M v[44:47], a[232:235], a[64:67], v[44:47]
M v[208:211], a[232:235], a[120:123], v[208:211]
s_waitcnt vmcnt(24)
s_barrier
R a[192:195], v16, 49152
WL 5
M v[40:43], a[236:239], a[12:15], v[40:43]
M v[44:47], a[236:239], a[68:71], v[44:47]
M v[208:211], a[236:239], a[124:127], v[208:211]
s_add_u32 m0, s55, 98304
s_mov_b32 s40, 65536
buffer_load_dwordx4 v9, s[16:19], s40 offen nt lds
R a[196:199], v17, 49152
WL 5
M v[40:43], a[240:243], a[16:19], v[40:43]
M v[44:47], a[240:243], a[72:75], v[44:47]
M v[208:211], a[240:243], a[128:131], v[208:211]
s_add_u32 m0, s55, 102400
s_mov_b32 s40, 69632
buffer_load_dwordx4 v9, s[16:19], s40 offen nt lds
R a[200:203], v18, 49152
WL 5
M v[40:43], a[244:247], a[20:23], v[40:43]
M v[44:47], a[244:247], a[76:79], v[44:47]
M v[208:211], a[244:247], a[132:135], v[208:211]
s_add_u32 m0, s55, 106496
s_mov_b32 s40, 73728
buffer_load_dwordx4 v9, s[16:19], s40 offen nt lds
R a[204:207], v19, 49152
WL 5
M v[40:43], a[248:251], a[24:27], v[40:43]
M v[44:47], a[248:251], a[80:83], v[44:47]
M v[208:211], a[248:251], a[136:139], v[208:211]
s_add_u32 m0, s55, 110592
s_mov_b32 s40, 77824
buffer_load_dwordx4 v9, s[16:19], s40 offen nt lds
R a[208:211], v20, 49152
WL 5
M v[40:43], a[252:255], a[28:31], v[40:43]
M v[44:47], a[252:255], a[84:87], v[44:47]
M v[208:211], a[252:255], a[140:143], v[208:211]
R a[212:215], v21, 49152
WL 5
M v[32:35], a[192:195], a[0:3], 0
M v[36:39], a[192:195], a[56:59], 0
s_nop 8
v_max3_f32 v2, v40, v41, v2
CV v114, v40, v41
v_max3_f32 v2, v42, v43, v2
CV v115, v42, v43
v_max3_f32 v3, v44, v45, v3
CV v178, v44, v45
v_max3_f32 v3, v46, v47, v3
CV v179, v46, v47
s_mov_b64 vcc, s[68:69]
s_cbranch_vccz Ls8_26
v_max3_f32 v225, v208, v209, v225
CV v204, v208, v209
v_max3_f32 v225, v210, v211, v225
CV v205, v210, v211
Ls8_26:
M v[208:211], a[192:195], a[112:115], 0
R a[216:219], v22, 49152
WL 5
M v[32:35], a[196:199], a[4:7], v[32:35]
M v[36:39], a[196:199], a[60:63], v[36:39]
M v[208:211], a[196:199], a[116:119], v[208:211]
R a[220:223], v23, 49152
WL 5
M v[32:35], a[200:203], a[8:11], v[32:35]
M v[36:39], a[200:203], a[64:67], v[36:39]
M v[208:211], a[200:203], a[120:123], v[208:211]
R a[224:227], v16, 57344
WL 5
M v[32:35], a[204:207], a[12:15], v[32:35]
M v[36:39], a[204:207], a[68:71], v[36:39]
M v[208:211], a[204:207], a[124:127], v[208:211]
R a[228:231], v17, 57344
WL 5
M v[32:35], a[208:211], a[16:19], v[32:35]
M v[36:39], a[208:211], a[72:75], v[36:39]
M v[208:211], a[208:211], a[128:131], v[208:211]
R a[232:235], v18, 57344
WL 5
M v[32:35], a[212:215], a[20:23], v[32:35]
M v[36:39], a[212:215], a[76:79], v[36:39]
M v[208:211], a[212:215], a[132:135], v[208:211]
R a[236:239], v19, 57344
WL 5
M v[32:35], a[216:219], a[24:27], v[32:35]
M v[36:39], a[216:219], a[80:83], v[36:39]
M v[208:211], a[216:219], a[136:139], v[208:211]
R a[240:243], v20, 57344
WL 5
M v[32:35], a[220:223], a[28:31], v[32:35]
M v[36:39], a[220:223], a[84:87], v[36:39]
M v[208:211], a[220:223], a[140:143], v[208:211]
R a[244:247], v21, 57344
WL 5
M v[40:43], a[224:227], a[0:3], 0
M v[44:47], a[224:227], a[56:59], 0
s_nop 8
v_max3_f32 v2, v32, v33, v2
CV v116, v32, v33
v_max3_f32 v2, v34, v35, v2
CV v117, v34, v35
v_max3_f32 v3, v36, v37, v3
CV v180, v36, v37
v_max3_f32 v3, v38, v39, v3
CV v181, v38, v39
s_mov_b64 vcc, s[70:71]
s_cbranch_vccz Ls8_27
v_max3_f32 v225, v208, v209, v225
CV v204, v208, v209
v_max3_f32 v225, v210, v211, v225
CV v205, v210, v211
Ls8_27:
M v[208:211], a[224:227], a[112:115], 0
R a[248:251], v22, 57344
WL 5
M v[40:43], a[228:231], a[4:7], v[40:43]
M v[44:47], a[228:231], a[60:63], v[44:47]
M v[208:211], a[228:231], a[116:119], v[208:211]
R a[252:255], v23, 57344
WL 5
M v[40:43], a[232:235], a[8:11], v[40:43]
M v[44:47], a[232:235], a[64:67], v[44:47]
M v[208:211], a[232:235], a[120:123], v[208:211]
s_waitcnt vmcnt(24)
s_barrier
R a[192:195], v16, 0
WL 5
M v[40:43], a[236:239], a[12:15], v[40:43]
M v[44:47], a[236:239], a[68:71], v[44:47]
M v[208:211], a[236:239], a[124:127], v[208:211]
s_add_u32 m0, s55, 32768
s_mov_b32 s40, 81920
buffer_load_dwordx4 v9, s[16:19], s40 offen nt lds
R a[196:199], v17, 0
WL 5
M v[40:43], a[240:243], a[16:19], v[40:43]
M v[44:47], a[240:243], a[72:75], v[44:47]
M v[208:211], a[240:243], a[128:131], v[208:211]
s_add_u32 m0, s55, 36864
s_mov_b32 s40, 86016
buffer_load_dwordx4 v9, s[16:19], s40 offen nt lds
R a[200:203], v18, 0
WL 5
M v[40:43], a[244:247], a[20:23], v[40:43]
M v[44:47], a[244:247], a[76:79], v[44:47]
M v[208:211], a[244:247], a[132:135], v[208:211]
s_add_u32 m0, s55, 40960
s_mov_b32 s40, 90112
buffer_load_dwordx4 v9, s[16:19], s40 offen nt lds
R a[204:207], v19, 0
WL 5
M v[40:43], a[248:251], a[24:27], v[40:43]
M v[44:47], a[248:251], a[80:83], v[44:47]
M v[208:211], a[248:251], a[136:139], v[208:211]
s_add_u32 m0, s55, 45056
s_mov_b32 s40, 94208
buffer_load_dwordx4 v9, s[16:19], s40 offen nt lds
R a[208:211], v20, 0
WL 5
M v[40:43], a[252:255], a[28:31], v[40:43]
M v[44:47], a[252:255], a[84:87], v[44:47]
M v[208:211], a[252:255], a[140:143], v[208:211]
R a[212:215], v21, 0
WL 5
M v[32:35], a[192:195], a[0:3], 0
M v[36:39], a[192:195], a[56:59], 0
s_nop 8
v_max3_f32 v2, v40, v41, v2
CV v118, v40, v41
v_max3_f32 v2, v42, v43, v2
CV v119, v42, v43
v_max3_f32 v3, v44, v45, v3
CV v182, v44, v45
v_max3_f32 v3, v46, v47, v3
CV v183, v46, v47
s_mov_b64 vcc, s[72:73]
s_cbranch_vccz Ls8_28
v_max3_f32 v225, v208, v209, v225
CV v204, v208, v209
v_max3_f32 v225, v210, v211, v225
CV v205, v210, v211
Ls8_28:
M v[208:211], a[192:195], a[112:115], 0
R a[216:219], v22, 0
WL 5
M v[32:35], a[196:199], a[4:7], v[32:35]
M v[36:39], a[196:199], a[60:63], v[36:39]
M v[208:211], a[196:199], a[116:119], v[208:211]
R a[220:223], v23, 0
WL 5
M v[32:35], a[200:203], a[8:11], v[32:35]
M v[36:39], a[200:203], a[64:67], v[36:39]
M v[208:211], a[200:203], a[120:123], v[208:211]
R a[224:227], v16, 8192
WL 5
M v[32:35], a[204:207], a[12:15], v[32:35]
M v[36:39], a[204:207], a[68:71], v[36:39]
M v[208:211], a[204:207], a[124:127], v[208:211]
R a[228:231], v17, 8192
WL 5
M v[32:35], a[208:211], a[16:19], v[32:35]
M v[36:39], a[208:211], a[72:75], v[36:39]
M v[208:211], a[208:211], a[128:131], v[208:211]
R a[232:235], v18, 8192
WL 5
M v[32:35], a[212:215], a[20:23], v[32:35]
M v[36:39], a[212:215], a[76:79], v[36:39]
M v[208:211], a[212:215], a[132:135], v[208:211]
R a[236:239], v19, 8192
WL 5
M v[32:35], a[216:219], a[24:27], v[32:35]
M v[36:39], a[216:219], a[80:83], v[36:39]
M v[208:211], a[216:219], a[136:139], v[208:211]
R a[240:243], v20, 8192
WL 5
M v[32:35], a[220:223], a[28:31], v[32:35]
M v[36:39], a[220:223], a[84:87], v[36:39]
M v[208:211], a[220:223], a[140:143], v[208:211]
R a[244:247], v21, 8192
WL 5
M v[40:43], a[224:227], a[0:3], 0
M v[44:47], a[224:227], a[56:59], 0
s_nop 8
v_max3_f32 v2, v32, v33, v2
CV v120, v32, v33
v_max3_f32 v2, v34, v35, v2
CV v121, v34, v35
v_max3_f32 v3, v36, v37, v3
CV v184, v36, v37
v_max3_f32 v3, v38, v39, v3
CV v185, v38, v39
s_mov_b64 vcc, s[66:67]
s_cbranch_vccz Ls8_29
v_max3_f32 v225, v208, v209, v225
CV v206, v208, v209
v_max3_f32 v225, v210, v211, v225
CV v207, v210, v211
Ls8_29:
M v[208:211], a[224:227], a[112:115], 0
R a[248:251], v22, 8192
WL 5
M v[40:43], a[228:231], a[4:7], v[40:43]
M v[44:47], a[228:231], a[60:63], v[44:47]
M v[208:211], a[228:231], a[116:119], v[208:211]
R a[252:255], v23, 8192
WL 5
M v[40:43], a[232:235], a[8:11], v[40:43]
M v[44:47], a[232:235], a[64:67], v[44:47]
M v[208:211], a[232:235], a[120:123], v[208:211]
s_waitcnt vmcnt(24)
s_barrier
v_add_u32 v16, 65536, v16
v_add_u32 v17, 65536, v17
v_add_u32 v18, 65536, v18
v_add_u32 v19, 65536, v19
v_add_u32 v20, 65536, v20
v_add_u32 v21, 65536, v21
v_add_u32 v22, 65536, v22
v_add_u32 v23, 65536, v23
R a[192:195], v16, 49152
WL 5
M v[40:43], a[236:239], a[12:15], v[40:43]
M v[44:47], a[236:239], a[68:71], v[44:47]
M v[208:211], a[236:239], a[124:127], v[208:211]
s_add_u32 m0, s55, 49152
s_mov_b32 s40, 98304
buffer_load_dwordx4 v9, s[16:19], s40 offen nt lds
R a[196:199], v17, 49152
WL 5
M v[40:43], a[240:243], a[16:19], v[40:43]
M v[44:47], a[240:243], a[72:75], v[44:47]
M v[208:211], a[240:243], a[128:131], v[208:211]
s_add_u32 m0, s55, 53248
s_mov_b32 s40, 102400
buffer_load_dwordx4 v9, s[16:19], s40 offen nt lds
R a[200:203], v18, 49152
WL 5
M v[40:43], a[244:247], a[20:23], v[40:43]
M v[44:47], a[244:247], a[76:79], v[44:47]
M v[208:211], a[244:247], a[132:135], v[208:211]
s_add_u32 m0, s55, 57344
s_mov_b32 s40, 106496
buffer_load_dwordx4 v9, s[16:19], s40 offen nt lds
R a[204:207], v19, 49152
WL 5
M v[40:43], a[248:251], a[24:27], v[40:43]
M v[44:47], a[248:251], a[80:83], v[44:47]
M v[208:211], a[248:251], a[136:139], v[208:211]
s_add_u32 m0, s55, 61440
s_mov_b32 s40, 110592
buffer_load_dwordx4 v9, s[16:19], s40 offen nt lds
R a[208:211], v20, 49152
WL 5
M v[40:43], a[252:255], a[28:31], v[40:43]
M v[44:47], a[252:255], a[84:87], v[44:47]
M v[208:211], a[252:255], a[140:143], v[208:211]
R a[212:215], v21, 49152
WL 5
M v[32:35], a[192:195], a[0:3], 0
M v[36:39], a[192:195], a[56:59], 0
s_nop 8
v_max3_f32 v2, v40, v41, v2
CV v122, v40, v41
v_max3_f32 v2, v42, v43, v2
CV v123, v42, v43
v_max3_f32 v3, v44, v45, v3
CV v186, v44, v45
v_max3_f32 v3, v46, v47, v3
CV v187, v46, v47
s_mov_b64 vcc, s[68:69]
s_cbranch_vccz Ls8_30
v_max3_f32 v225, v208, v209, v225
CV v206, v208, v209
v_max3_f32 v225, v210, v211, v225
CV v207, v210, v211
Ls8_30:
M v[208:211], a[192:195], a[112:115], 0
R a[216:219], v22, 49152
WL 5
M v[32:35], a[196:199], a[4:7], v[32:35]
M v[36:39], a[196:199], a[60:63], v[36:39]
M v[208:211], a[196:199], a[116:119], v[208:211]
R a[220:223], v23, 49152
WL 5
M v[32:35], a[200:203], a[8:11], v[32:35]
M v[36:39], a[200:203], a[64:67], v[36:39]
M v[208:211], a[200:203], a[120:123], v[208:211]
R a[224:227], v16, 57344
WL 5
M v[32:35], a[204:207], a[12:15], v[32:35]
M v[36:39], a[204:207], a[68:71], v[36:39]
M v[208:211], a[204:207], a[124:127], v[208:211]
R a[228:231], v17, 57344
WL 5
M v[32:35], a[208:211], a[16:19], v[32:35]
M v[36:39], a[208:211], a[72:75], v[36:39]
M v[208:211], a[208:211], a[128:131], v[208:211]
R a[232:235], v18, 57344
WL 5
M v[32:35], a[212:215], a[20:23], v[32:35]
M v[36:39], a[212:215], a[76:79], v[36:39]
M v[208:211], a[212:215], a[132:135], v[208:211]
R a[236:239], v19, 57344
WL 5
M v[32:35], a[216:219], a[24:27], v[32:35]
M v[36:39], a[216:219], a[80:83], v[36:39]
M v[208:211], a[216:219], a[136:139], v[208:211]
R a[240:243], v20, 57344
WL 5
M v[32:35], a[220:223], a[28:31], v[32:35]
M v[36:39], a[220:223], a[84:87], v[36:39]
M v[208:211], a[220:223], a[140:143], v[208:211]
R a[244:247], v21, 57344
WL 5
M v[40:43], a[224:227], a[0:3], 0
M v[44:47], a[224:227], a[56:59], 0
s_nop 8
v_max3_f32 v2, v32, v33, v2
CV v124, v32, v33
v_max3_f32 v2, v34, v35, v2
CV v125, v34, v35
v_max3_f32 v3, v36, v37, v3
CV v188, v36, v37
v_max3_f32 v3, v38, v39, v3
CV v189, v38, v39
s_mov_b64 vcc, s[70:71]
s_cbranch_vccz Ls8_31
v_max3_f32 v225, v208, v209, v225
CV v206, v208, v209
v_max3_f32 v225, v210, v211, v225
CV v207, v210, v211
Ls8_31:
M v[208:211], a[224:227], a[112:115], 0
R a[248:251], v22, 57344
WL 5
M v[40:43], a[228:231], a[4:7], v[40:43]
M v[44:47], a[228:231], a[60:63], v[44:47]
M v[208:211], a[228:231], a[116:119], v[208:211]
R a[252:255], v23, 57344
WL 5
M v[40:43], a[232:235], a[8:11], v[40:43]
M v[44:47], a[232:235], a[64:67], v[44:47]
M v[208:211], a[232:235], a[120:123], v[208:211]
s_waitcnt vmcnt(24)
s_barrier
v_lshrrev_b32 v50, 4, v1
v_bfe_u32 v51, v1, 2, 2
v_and_b32 v52, 3, v1
v_lshl_add_u32 v50, v50, 2, v51
v_lshlrev_b32 v53, 9, v50
v_and_b32 v50, 7, v50
v_lshl_add_u32 v53, v50, 5, v53
v_lshl_add_u32 v53, v52, 3, v53
s_lshl_b32 s42, s28, 7
v_xor_b32 v53, s42, v53
v_xor_b32 v16, 0, v53
v_xor_b32 v17, 32, v53
v_xor_b32 v18, 64, v53
v_xor_b32 v19, 96, v53
v_xor_b32 v20, 128, v53
v_xor_b32 v21, 160, v53
v_xor_b32 v22, 192, v53
v_xor_b32 v23, 224, v53
v_xor_b32 v24, 256, v53
v_xor_b32 v25, 288, v53
v_xor_b32 v26, 320, v53
v_xor_b32 v27, 352, v53
v_xor_b32 v28, 384, v53
v_xor_b32 v29, 416, v53
v_xor_b32 v30, 448, v53
v_xor_b32 v31, 480, v53
v_add_u32 v16, 131072, v16
v_add_u32 v17, 131072, v17
v_add_u32 v18, 131072, v18
v_add_u32 v19, 131072, v19
v_add_u32 v20, 131072, v20
v_add_u32 v21, 131072, v21
v_add_u32 v22, 131072, v22
v_add_u32 v23, 131072, v23
v_add_u32 v24, 131072, v24
v_add_u32 v25, 131072, v25
v_add_u32 v26, 131072, v26
v_add_u32 v27, 131072, v27
v_add_u32 v28, 131072, v28
v_add_u32 v29, 131072, v29
v_add_u32 v30, 131072, v30
v_add_u32 v31, 131072, v31
T a[192:193], v16, 0
T a[194:195], v16, 8192
WL 6
M v[40:43], a[236:239], a[12:15], v[40:43]
M v[44:47], a[236:239], a[68:71], v[44:47]
M v[208:211], a[236:239], a[124:127], v[208:211]
s_add_u32 m0, s55, 0
s_mov_b32 s40, 114688
buffer_load_dwordx4 v9, s[16:19], s40 offen nt lds
T a[196:197], v17, 0
T a[198:199], v17, 8192
WL 7
M v[40:43], a[240:243], a[16:19], v[40:43]
M v[44:47], a[240:243], a[72:75], v[44:47]
M v[208:211], a[240:243], a[128:131], v[208:211]
s_add_u32 m0, s55, 4096
s_mov_b32 s40, 118784
buffer_load_dwordx4 v9, s[16:19], s40 offen nt lds
T a[200:201], v18, 0
T a[202:203], v18, 8192
WL 8
M v[40:43], a[244:247], a[20:23], v[40:43]
M v[44:47], a[244:247], a[76:79], v[44:47]
M v[208:211], a[244:247], a[132:135], v[208:211]
s_add_u32 m0, s55, 8192
s_mov_b32 s40, 122880
buffer_load_dwordx4 v9, s[16:19], s40 offen nt lds
T a[204:205], v19, 0
T a[206:207], v19, 8192
WL 9
M v[40:43], a[248:251], a[24:27], v[40:43]
M v[44:47], a[248:251], a[80:83], v[44:47]
M v[208:211], a[248:251], a[136:139], v[208:211]
s_add_u32 m0, s55, 12288
s_mov_b32 s40, 126976
buffer_load_dwordx4 v9, s[16:19], s40 offen nt lds
T a[208:209], v20, 0
T a[210:211], v20, 8192
WL 10
M v[40:43], a[252:255], a[28:31], v[40:43]
M v[44:47], a[252:255], a[84:87], v[44:47]
M v[208:211], a[252:255], a[140:143], v[208:211]
T a[212:213], v21, 0
T a[214:215], v21, 8192
s_nop 10
v_max3_f32 v2, v40, v41, v2
CV v126, v40, v41
v_max3_f32 v2, v42, v43, v2
CV v127, v42, v43
v_max3_f32 v3, v44, v45, v3
CV v190, v44, v45
v_max3_f32 v3, v46, v47, v3
CV v191, v46, v47
s_mov_b64 vcc, s[72:73]
s_cbranch_vccz Ls8_32
v_max3_f32 v225, v208, v209, v225
CV v206, v208, v209
v_max3_f32 v225, v210, v211, v225
CV v207, v210, v211
Ls8_32:
v_mov_b32 v50, v2
v_mov_b32 v51, v3
v_mov_b32 v52, v225
s_nop 1
v_permlane32_swap_b32 v50, v2
v_permlane32_swap_b32 v51, v3
v_permlane32_swap_b32 v52, v225
s_nop 0
v_max_f32 v2, v2, v50
v_max_f32 v3, v3, v51
v_max_f32 v225, v225, v52
v_mov_b32 v50, v2
v_mov_b32 v51, v3
v_mov_b32 v52, v225
s_nop 1
v_permlane16_swap_b32 v50, v2
v_permlane16_swap_b32 v51, v3
v_permlane16_swap_b32 v52, v225
s_nop 0
v_max_f32 v2, v2, v50
v_max_f32 v3, v3, v51
v_max_f32 v225, v225, v52
v_and_b32 v50, 15, v1
v_lshlrev_b32 v50, 2, v50
v_add_u32 v50, 147456, v50
s_lshl_b32 s42, s28, 6
v_add_u32 v51, s42, v50
ds_write_b32 v51, v225
v_mul_f32 v6, s29, v2
v_mov_b32 v4, 0
v_mul_f32 v7, s29, v3
v_mov_b32 v5, 0
s_lshr_b32 s42, s28, 1
s_lshl_b32 s42, s42, 10
s_and_b32 s43, s28, 1
s_lshl_b32 s43, s43, 3
s_add_u32 s42, s42, s43
v_add_u32 v227, s42, v224
WL 0
s_barrier
ds_read2_b32 v[52:53], v50 offset0:0 offset1:16
ds_read2_b32 v[54:55], v50 offset0:32 offset1:48
v_lshlrev_b32 v228, 16, v64
v_and_b32 v229, 0xffff0000, v64
v_lshlrev_b32 v230, 16, v128
v_and_b32 v231, 0xffff0000, v128
v_lshlrev_b32 v232, 16, v65
v_and_b32 v233, 0xffff0000, v65
v_lshlrev_b32 v234, 16, v129
v_and_b32 v235, 0xffff0000, v129
v_lshlrev_b32 v236, 16, v66
v_and_b32 v237, 0xffff0000, v66
v_lshlrev_b32 v238, 16, v130
v_and_b32 v239, 0xffff0000, v130
v_lshlrev_b32 v240, 16, v67
v_and_b32 v241, 0xffff0000, v67
v_lshlrev_b32 v242, 16, v131
v_and_b32 v243, 0xffff0000, v131
v_fma_f32 v228, v228, s29, -v6
v_fma_f32 v229, v229, s29, -v6
v_fma_f32 v230, v230, s29, -v7
v_fma_f32 v231, v231, s29, -v7
v_fma_f32 v232, v232, s29, -v6
v_fma_f32 v233, v233, s29, -v6
v_fma_f32 v234, v234, s29, -v7
v_fma_f32 v235, v235, s29, -v7
v_fma_f32 v236, v236, s29, -v6
v_fma_f32 v237, v237, s29, -v6
v_fma_f32 v238, v238, s29, -v7
v_fma_f32 v239, v239, s29, -v7
v_fma_f32 v240, v240, s29, -v6
v_fma_f32 v241, v241, s29, -v6
v_fma_f32 v242, v242, s29, -v7
v_fma_f32 v243, v243, s29, -v7
v_exp_f32 v228, v228
v_exp_f32 v229, v229
v_exp_f32 v230, v230
v_exp_f32 v231, v231
v_exp_f32 v232, v232
v_exp_f32 v233, v233
v_exp_f32 v234, v234
v_exp_f32 v235, v235
v_exp_f32 v236, v236
v_exp_f32 v237, v237
v_exp_f32 v238, v238
v_exp_f32 v239, v239
v_exp_f32 v240, v240
v_exp_f32 v241, v241
v_exp_f32 v242, v242
v_exp_f32 v243, v243
v_add_f32 v4, v4, v228
v_add_f32 v5, v5, v230
v_add_f32 v4, v4, v232
v_add_f32 v5, v5, v234
v_add_f32 v4, v4, v236
v_add_f32 v5, v5, v238
v_add_f32 v4, v4, v240
v_add_f32 v5, v5, v242
v_add_f32 v4, v4, v229
v_add_f32 v5, v5, v231
v_add_f32 v4, v4, v233
v_add_f32 v5, v5, v235
v_add_f32 v4, v4, v237
v_add_f32 v5, v5, v239
v_add_f32 v4, v4, v241
v_add_f32 v5, v5, v243
CV v64, v228, v229
CV v128, v230, v231
CV v65, v232, v233
CV v129, v234, v235
CV v66, v236, v237
CV v130, v238, v239
CV v67, v240, v241
CV v131, v242, v243
WL 0
s_barrier
v_max3_f32 v225, v52, v53, v54
v_max_f32 v225, v225, v55
v_mul_f32 v226, s29, v225
v_lshlrev_b32 v228, 16, v192
v_and_b32 v229, 0xffff0000, v192
v_lshlrev_b32 v230, 16, v193
v_and_b32 v231, 0xffff0000, v193
v_lshlrev_b32 v232, 16, v194
v_and_b32 v233, 0xffff0000, v194
v_lshlrev_b32 v234, 16, v195
v_and_b32 v235, 0xffff0000, v195
v_lshlrev_b32 v236, 16, v196
v_and_b32 v237, 0xffff0000, v196
v_lshlrev_b32 v238, 16, v197
v_and_b32 v239, 0xffff0000, v197
v_lshlrev_b32 v240, 16, v198
v_and_b32 v241, 0xffff0000, v198
v_lshlrev_b32 v242, 16, v199
v_and_b32 v243, 0xffff0000, v199
v_fma_f32 v228, v228, s29, -v226
v_fma_f32 v229, v229, s29, -v226
v_fma_f32 v230, v230, s29, -v226
v_fma_f32 v231, v231, s29, -v226
v_fma_f32 v232, v232, s29, -v226
v_fma_f32 v233, v233, s29, -v226
v_fma_f32 v234, v234, s29, -v226
v_fma_f32 v235, v235, s29, -v226
v_fma_f32 v236, v236, s29, -v226
v_fma_f32 v237, v237, s29, -v226
v_fma_f32 v238, v238, s29, -v226
v_fma_f32 v239, v239, s29, -v226
v_fma_f32 v240, v240, s29, -v226
v_fma_f32 v241, v241, s29, -v226
v_fma_f32 v242, v242, s29, -v226
v_fma_f32 v243, v243, s29, -v226
v_exp_f32 v228, v228
v_exp_f32 v229, v229
v_exp_f32 v230, v230
v_exp_f32 v231, v231
v_exp_f32 v232, v232
v_exp_f32 v233, v233
v_exp_f32 v234, v234
v_exp_f32 v235, v235
v_exp_f32 v236, v236
v_exp_f32 v237, v237
v_exp_f32 v238, v238
v_exp_f32 v239, v239
v_exp_f32 v240, v240
v_exp_f32 v241, v241
v_exp_f32 v242, v242
v_exp_f32 v243, v243
CV v192, v228, v229
CV v193, v230, v231
CV v194, v232, v233
CV v195, v234, v235
CV v196, v236, v237
CV v197, v238, v239
CV v198, v240, v241
CV v199, v242, v243
v_lshlrev_b32 v228, 16, v200
v_and_b32 v229, 0xffff0000, v200
v_lshlrev_b32 v230, 16, v201
v_and_b32 v231, 0xffff0000, v201
v_lshlrev_b32 v232, 16, v202
v_and_b32 v233, 0xffff0000, v202
v_lshlrev_b32 v234, 16, v203
v_and_b32 v235, 0xffff0000, v203
v_lshlrev_b32 v236, 16, v204
v_and_b32 v237, 0xffff0000, v204
v_lshlrev_b32 v238, 16, v205
v_and_b32 v239, 0xffff0000, v205
v_lshlrev_b32 v240, 16, v206
v_and_b32 v241, 0xffff0000, v206
v_lshlrev_b32 v242, 16, v207
v_and_b32 v243, 0xffff0000, v207
v_fma_f32 v228, v228, s29, -v226
v_fma_f32 v229, v229, s29, -v226
v_fma_f32 v230, v230, s29, -v226
v_fma_f32 v231, v231, s29, -v226
v_fma_f32 v232, v232, s29, -v226
v_fma_f32 v233, v233, s29, -v226
v_fma_f32 v234, v234, s29, -v226
v_fma_f32 v235, v235, s29, -v226
v_fma_f32 v236, v236, s29, -v226
v_fma_f32 v237, v237, s29, -v226
v_fma_f32 v238, v238, s29, -v226
v_fma_f32 v239, v239, s29, -v226
v_fma_f32 v240, v240, s29, -v226
v_fma_f32 v241, v241, s29, -v226
v_fma_f32 v242, v242, s29, -v226
v_fma_f32 v243, v243, s29, -v226
v_exp_f32 v228, v228
v_exp_f32 v229, v229
v_exp_f32 v230, v230
v_exp_f32 v231, v231
v_exp_f32 v232, v232
v_exp_f32 v233, v233
v_exp_f32 v234, v234
v_exp_f32 v235, v235
v_exp_f32 v236, v236
v_exp_f32 v237, v237
v_exp_f32 v238, v238
v_exp_f32 v239, v239
v_exp_f32 v240, v240
v_exp_f32 v241, v241
v_exp_f32 v242, v242
v_exp_f32 v243, v243
CV v200, v228, v229
CV v201, v230, v231
CV v202, v232, v233
CV v203, v234, v235
CV v204, v236, v237
CV v205, v238, v239
CV v206, v240, v241
CV v207, v242, v243
ds_write_b64 v227, v[192:193] offset:0
ds_write_b64 v227, v[194:195] offset:2048
ds_write_b64 v227, v[196:197] offset:4096
ds_write_b64 v227, v[198:199] offset:6144
ds_write_b64 v227, v[200:201] offset:8192
ds_write_b64 v227, v[202:203] offset:10240
ds_write_b64 v227, v[204:205] offset:12288
ds_write_b64 v227, v[206:207] offset:14336
WL 0
s_barrier
R v[212:215], v224, 0
s_nop 1
M a[0:3], a[192:195], v[64:67], 0
M a[64:67], a[192:195], v[128:131], 0
R v[216:219], v224, 1024
WL 1
M a[128:131], a[192:195], v[212:215], 0
T a[216:217], v22, 0
T a[218:219], v22, 8192
M a[4:7], a[196:199], v[64:67], 0
v_lshlrev_b32 v228, 16, v68
v_and_b32 v229, 0xffff0000, v68
v_lshlrev_b32 v230, 16, v132
M a[68:71], a[196:199], v[128:131], 0
v_and_b32 v231, 0xffff0000, v132
v_lshlrev_b32 v232, 16, v69
v_and_b32 v233, 0xffff0000, v69
M a[132:135], a[196:199], v[212:215], 0
v_lshlrev_b32 v234, 16, v133
v_and_b32 v235, 0xffff0000, v133
v_lshlrev_b32 v236, 16, v70
T a[220:221], v23, 0
T a[222:223], v23, 8192
M a[8:11], a[200:203], v[64:67], 0
v_and_b32 v237, 0xffff0000, v70
v_lshlrev_b32 v238, 16, v134
v_and_b32 v239, 0xffff0000, v134
M a[72:75], a[200:203], v[128:131], 0
v_lshlrev_b32 v240, 16, v71
v_and_b32 v241, 0xffff0000, v71
v_lshlrev_b32 v242, 16, v135
M a[136:139], a[200:203], v[212:215], 0
v_and_b32 v243, 0xffff0000, v135
v_fma_f32 v228, v228, s29, -v6
v_fma_f32 v229, v229, s29, -v6
T a[224:225], v24, 0
T a[226:227], v24, 8192
M a[12:15], a[204:207], v[64:67], 0
v_fma_f32 v230, v230, s29, -v7
v_fma_f32 v231, v231, s29, -v7
v_fma_f32 v232, v232, s29, -v6
M a[76:79], a[204:207], v[128:131], 0
v_fma_f32 v233, v233, s29, -v6
v_fma_f32 v234, v234, s29, -v7
v_fma_f32 v235, v235, s29, -v7
M a[140:143], a[204:207], v[212:215], 0
v_fma_f32 v236, v236, s29, -v6
v_fma_f32 v237, v237, s29, -v6
v_fma_f32 v238, v238, s29, -v7
M a[144:147], v[220:223], v[212:215], 0
v_fma_f32 v239, v239, s29, -v7
v_fma_f32 v240, v240, s29, -v6
v_fma_f32 v241, v241, s29, -v6
T a[228:229], v25, 0
T a[230:231], v25, 8192
M a[16:19], a[208:211], v[64:67], 0
v_fma_f32 v242, v242, s29, -v7
v_fma_f32 v243, v243, s29, -v7
v_exp_f32 v228, v228
M a[80:83], a[208:211], v[128:131], 0
v_exp_f32 v229, v229
v_exp_f32 v230, v230
v_exp_f32 v231, v231
T a[232:233], v26, 0
T a[234:235], v26, 8192
M a[20:23], a[212:215], v[64:67], 0
v_exp_f32 v232, v232
v_exp_f32 v233, v233
v_exp_f32 v234, v234
M a[84:87], a[212:215], v[128:131], 0
v_exp_f32 v235, v235
v_exp_f32 v236, v236
v_exp_f32 v237, v237
T a[236:237], v27, 0
T a[238:239], v27, 8192
WL 10
M a[24:27], a[216:219], v[64:67], 0
v_exp_f32 v238, v238
v_exp_f32 v239, v239
v_exp_f32 v240, v240
M a[88:91], a[216:219], v[128:131], 0
v_exp_f32 v241, v241
v_exp_f32 v242, v242
v_exp_f32 v243, v243
T a[240:241], v28, 0
T a[242:243], v28, 8192
WL 10
M a[28:31], a[220:223], v[64:67], 0
v_add_f32 v4, v4, v228
v_add_f32 v5, v5, v230
v_add_f32 v4, v4, v232
M a[92:95], a[220:223], v[128:131], 0
v_add_f32 v5, v5, v234
v_add_f32 v4, v4, v236
v_add_f32 v5, v5, v238
T a[244:245], v29, 0
T a[246:247], v29, 8192
WL 10
M a[32:35], a[224:227], v[64:67], 0
v_add_f32 v4, v4, v240
v_add_f32 v5, v5, v242
v_add_f32 v4, v4, v229
M a[96:99], a[224:227], v[128:131], 0
v_add_f32 v5, v5, v231
v_add_f32 v4, v4, v233
v_add_f32 v5, v5, v235
T a[248:249], v30, 0
T a[250:251], v30, 8192
WL 10
M a[36:39], a[228:231], v[64:67], 0
v_add_f32 v4, v4, v237
v_add_f32 v5, v5, v239
v_add_f32 v4, v4, v241
M a[100:103], a[228:231], v[128:131], 0
v_add_f32 v5, v5, v243
CV v68, v228, v229
CV v132, v230, v231
T a[252:253], v31, 0
T a[254:255], v31, 8192
WL 10
M a[40:43], a[232:235], v[64:67], 0
CV v69, v232, v233
CV v133, v234, v235
CV v70, v236, v237
M a[104:107], a[232:235], v[128:131], 0
CV v134, v238, v239
CV v71, v240, v241
CV v135, v242, v243
s_waitcnt vmcnt(24)
s_barrier
v_add_u32 v16, 4294836224, v16
v_add_u32 v17, 4294836224, v17
v_add_u32 v18, 4294836224, v18
v_add_u32 v19, 4294836224, v19
v_add_u32 v20, 4294836224, v20
v_add_u32 v21, 4294836224, v21
v_add_u32 v22, 4294836224, v22
v_add_u32 v23, 4294836224, v23
v_add_u32 v24, 4294836224, v24
v_add_u32 v25, 4294836224, v25
v_add_u32 v26, 4294836224, v26
v_add_u32 v27, 4294836224, v27
v_add_u32 v28, 4294836224, v28
v_add_u32 v29, 4294836224, v29
v_add_u32 v30, 4294836224, v30
v_add_u32 v31, 4294836224, v31
T a[192:193], v16, 16384
T a[194:195], v16, 24576
WL 10
M a[44:47], a[236:239], v[64:67], 0
M a[108:111], a[236:239], v[128:131], 0
s_add_u32 m0, s55, 114688
s_mov_b32 s40, 131072
buffer_load_dwordx4 v9, s[16:19], s40 offen nt lds
T a[196:197], v17, 16384
T a[198:199], v17, 24576
WL 10
M a[48:51], a[240:243], v[64:67], 0
M a[112:115], a[240:243], v[128:131], 0
s_add_u32 m0, s55, 118784
s_mov_b32 s40, 135168
buffer_load_dwordx4 v9, s[16:19], s40 offen nt lds
T a[200:201], v18, 16384
T a[202:203], v18, 24576
WL 10
M a[52:55], a[244:247], v[64:67], 0
M a[116:119], a[244:247], v[128:131], 0
s_add_u32 m0, s55, 122880
s_mov_b32 s40, 139264
buffer_load_dwordx4 v9, s[16:19], s40 offen nt lds
T a[204:205], v19, 16384
T a[206:207], v19, 24576
WL 10
M a[56:59], a[248:251], v[64:67], 0
M a[120:123], a[248:251], v[128:131], 0
s_add_u32 m0, s55, 126976
s_mov_b32 s40, 143360
buffer_load_dwordx4 v9, s[16:19], s40 offen nt lds
T a[208:209], v20, 16384
T a[210:211], v20, 24576
WL 10
M a[60:63], a[252:255], v[64:67], 0
M a[124:127], a[252:255], v[128:131], 0
T a[212:213], v21, 16384
T a[214:215], v21, 24576
s_nop 1
WL 10
M a[0:3], a[192:195], v[68:71], a[0:3]
M a[64:67], a[192:195], v[132:135], a[64:67]
R v[212:215], v224, 2048
M a[128:131], a[192:195], v[216:219], a[128:131]
T a[216:217], v22, 16384
T a[218:219], v22, 24576
WL 11
M a[4:7], a[196:199], v[68:71], a[4:7]
v_lshlrev_b32 v228, 16, v72
v_and_b32 v229, 0xffff0000, v72
v_lshlrev_b32 v230, 16, v136
M a[68:71], a[196:199], v[132:135], a[68:71]
v_and_b32 v231, 0xffff0000, v136
v_lshlrev_b32 v232, 16, v73
v_and_b32 v233, 0xffff0000, v73
M a[132:135], a[196:199], v[216:219], a[132:135]
v_lshlrev_b32 v234, 16, v137
v_and_b32 v235, 0xffff0000, v137
v_lshlrev_b32 v236, 16, v74
T a[220:221], v23, 16384
T a[222:223], v23, 24576
WL 11
M a[8:11], a[200:203], v[68:71], a[8:11]
v_and_b32 v237, 0xffff0000, v74
v_lshlrev_b32 v238, 16, v138
v_and_b32 v239, 0xffff0000, v138
M a[72:75], a[200:203], v[132:135], a[72:75]
v_lshlrev_b32 v240, 16, v75
v_and_b32 v241, 0xffff0000, v75
v_lshlrev_b32 v242, 16, v139
M a[136:139], a[200:203], v[216:219], a[136:139]
v_and_b32 v243, 0xffff0000, v139
v_fma_f32 v228, v228, s29, -v6
v_fma_f32 v229, v229, s29, -v6
T a[224:225], v24, 16384
T a[226:227], v24, 24576
WL 11
M a[12:15], a[204:207], v[68:71], a[12:15]
v_fma_f32 v230, v230, s29, -v7
v_fma_f32 v231, v231, s29, -v7
v_fma_f32 v232, v232, s29, -v6
M a[76:79], a[204:207], v[132:135], a[76:79]
v_fma_f32 v233, v233, s29, -v6
v_fma_f32 v234, v234, s29, -v7
v_fma_f32 v235, v235, s29, -v7
M a[140:143], a[204:207], v[216:219], a[140:143]
v_fma_f32 v236, v236, s29, -v6
v_fma_f32 v237, v237, s29, -v6
v_fma_f32 v238, v238, s29, -v7
M a[144:147], v[220:223], v[216:219], a[144:147]
v_fma_f32 v239, v239, s29, -v7
v_fma_f32 v240, v240, s29, -v6
v_fma_f32 v241, v241, s29, -v6
T a[228:229], v25, 16384
T a[230:231], v25, 24576
WL 11
M a[16:19], a[208:211], v[68:71], a[16:19]
v_fma_f32 v242, v242, s29, -v7
v_fma_f32 v243, v243, s29, -v7
v_exp_f32 v228, v228
M a[80:83], a[208:211], v[132:135], a[80:83]
v_exp_f32 v229, v229
v_exp_f32 v230, v230
v_exp_f32 v231, v231
T a[232:233], v26, 16384
T a[234:235], v26, 24576
WL 11
M a[20:23], a[212:215], v[68:71], a[20:23]
v_exp_f32 v232, v232
v_exp_f32 v233, v233
v_exp_f32 v234, v234
M a[84:87], a[212:215], v[132:135], a[84:87]
v_exp_f32 v235, v235
v_exp_f32 v236, v236
v_exp_f32 v237, v237
T a[236:237], v27, 16384
T a[238:239], v27, 24576
WL 10
M a[24:27], a[216:219], v[68:71], a[24:27]
v_exp_f32 v238, v238
v_exp_f32 v239, v239
v_exp_f32 v240, v240
M a[88:91], a[216:219], v[132:135], a[88:91]
v_exp_f32 v241, v241
v_exp_f32 v242, v242
v_exp_f32 v243, v243
T a[240:241], v28, 16384
T a[242:243], v28, 24576
WL 10
M a[28:31], a[220:223], v[68:71], a[28:31]
v_add_f32 v4, v4, v228
v_add_f32 v5, v5, v230
v_add_f32 v4, v4, v232
M a[92:95], a[220:223], v[132:135], a[92:95]
v_add_f32 v5, v5, v234
v_add_f32 v4, v4, v236
v_add_f32 v5, v5, v238
T a[244:245], v29, 16384
T a[246:247], v29, 24576
WL 10
M a[32:35], a[224:227], v[68:71], a[32:35]
v_add_f32 v4, v4, v240
v_add_f32 v5, v5, v242
v_add_f32 v4, v4, v229
M a[96:99], a[224:227], v[132:135], a[96:99]
v_add_f32 v5, v5, v231
v_add_f32 v4, v4, v233
v_add_f32 v5, v5, v235
T a[248:249], v30, 16384
T a[250:251], v30, 24576
WL 10
M a[36:39], a[228:231], v[68:71], a[36:39]
v_add_f32 v4, v4, v237
v_add_f32 v5, v5, v239
v_add_f32 v4, v4, v241
M a[100:103], a[228:231], v[132:135], a[100:103]
v_add_f32 v5, v5, v243
CV v72, v228, v229
CV v136, v230, v231
T a[252:253], v31, 16384
T a[254:255], v31, 24576
WL 10
M a[40:43], a[232:235], v[68:71], a[40:43]
CV v73, v232, v233
CV v137, v234, v235
CV v74, v236, v237
M a[104:107], a[232:235], v[132:135], a[104:107]
CV v138, v238, v239
CV v75, v240, v241
CV v139, v242, v243
s_waitcnt vmcnt(24)
s_barrier
v_add_u32 v16, 65536, v16
v_add_u32 v17, 65536, v17
v_add_u32 v18, 65536, v18
v_add_u32 v19, 65536, v19
v_add_u32 v20, 65536, v20
v_add_u32 v21, 65536, v21
v_add_u32 v22, 65536, v22
v_add_u32 v23, 65536, v23
v_add_u32 v24, 65536, v24
v_add_u32 v25, 65536, v25
v_add_u32 v26, 65536, v26
v_add_u32 v27, 65536, v27
v_add_u32 v28, 65536, v28
v_add_u32 v29, 65536, v29
v_add_u32 v30, 65536, v30
v_add_u32 v31, 65536, v31
T a[192:193], v16, 0
T a[194:195], v16, 8192
WL 10
M a[44:47], a[236:239], v[68:71], a[44:47]
M a[108:111], a[236:239], v[132:135], a[108:111]
s_add_u32 m0, s55, 131072
s_mov_b32 s40, 147456
buffer_load_dwordx4 v9, s[16:19], s40 offen nt lds
T a[196:197], v17, 0
T a[198:199], v17, 8192
WL 10
M a[48:51], a[240:243], v[68:71], a[48:51]
M a[112:115], a[240:243], v[132:135], a[112:115]
s_add_u32 m0, s55, 135168
s_mov_b32 s40, 151552
buffer_load_dwordx4 v9, s[16:19], s40 offen nt lds
T a[200:201], v18, 0
T a[202:203], v18, 8192
WL 10
M a[52:55], a[244:247], v[68:71], a[52:55]
M a[116:119], a[244:247], v[132:135], a[116:119]
s_add_u32 m0, s55, 139264
s_mov_b32 s40, 155648
buffer_load_dwordx4 v9, s[16:19], s40 offen nt lds
T a[204:205], v19, 0
T a[206:207], v19, 8192
WL 10
M a[56:59], a[248:251], v[68:71], a[56:59]
M a[120:123], a[248:251], v[132:135], a[120:123]
s_add_u32 m0, s55, 143360
s_mov_b32 s40, 159744
buffer_load_dwordx4 v9, s[16:19], s40 offen nt lds
T a[208:209], v20, 0
T a[210:211], v20, 8192
WL 10
M a[60:63], a[252:255], v[68:71], a[60:63]
M a[124:127], a[252:255], v[132:135], a[124:127]
T a[212:213], v21, 0
T a[214:215], v21, 8192
s_nop 1
WL 10
M a[0:3], a[192:195], v[72:75], a[0:3]
M a[64:67], a[192:195], v[136:139], a[64:67]
R v[216:219], v224, 3072
M a[128:131], a[192:195], v[212:215], a[128:131]
T a[216:217], v22, 0
T a[218:219], v22, 8192
WL 11
M a[4:7], a[196:199], v[72:75], a[4:7]
v_lshlrev_b32 v228, 16, v76
v_and_b32 v229, 0xffff0000, v76
v_lshlrev_b32 v230, 16, v140
M a[68:71], a[196:199], v[136:139], a[68:71]
v_and_b32 v231, 0xffff0000, v140
v_lshlrev_b32 v232, 16, v77
v_and_b32 v233, 0xffff0000, v77
M a[132:135], a[196:199], v[212:215], a[132:135]
v_lshlrev_b32 v234, 16, v141
v_and_b32 v235, 0xffff0000, v141
v_lshlrev_b32 v236, 16, v78
T a[220:221], v23, 0
T a[222:223], v23, 8192
WL 11
M a[8:11], a[200:203], v[72:75], a[8:11]
v_and_b32 v237, 0xffff0000, v78
v_lshlrev_b32 v238, 16, v142
v_and_b32 v239, 0xffff0000, v142
M a[72:75], a[200:203], v[136:139], a[72:75]
v_lshlrev_b32 v240, 16, v79
v_and_b32 v241, 0xffff0000, v79
v_lshlrev_b32 v242, 16, v143
M a[136:139], a[200:203], v[212:215], a[136:139]
v_and_b32 v243, 0xffff0000, v143
v_fma_f32 v228, v228, s29, -v6
v_fma_f32 v229, v229, s29, -v6
T a[224:225], v24, 0
T a[226:227], v24, 8192
WL 11
M a[12:15], a[204:207], v[72:75], a[12:15]
v_fma_f32 v230, v230, s29, -v7
v_fma_f32 v231, v231, s29, -v7
v_fma_f32 v232, v232, s29, -v6
M a[76:79], a[204:207], v[136:139], a[76:79]
v_fma_f32 v233, v233, s29, -v6
v_fma_f32 v234, v234, s29, -v7
v_fma_f32 v235, v235, s29, -v7
M a[140:143], a[204:207], v[212:215], a[140:143]
v_fma_f32 v236, v236, s29, -v6
v_fma_f32 v237, v237, s29, -v6
v_fma_f32 v238, v238, s29, -v7
M a[144:147], v[220:223], v[212:215], a[144:147]
v_fma_f32 v239, v239, s29, -v7
v_fma_f32 v240, v240, s29, -v6
v_fma_f32 v241, v241, s29, -v6
T a[228:229], v25, 0
T a[230:231], v25, 8192
WL 11
M a[16:19], a[208:211], v[72:75], a[16:19]
v_fma_f32 v242, v242, s29, -v7
v_fma_f32 v243, v243, s29, -v7
v_exp_f32 v228, v228
M a[80:83], a[208:211], v[136:139], a[80:83]
v_exp_f32 v229, v229
v_exp_f32 v230, v230
v_exp_f32 v231, v231
T a[232:233], v26, 0
T a[234:235], v26, 8192
WL 11
M a[20:23], a[212:215], v[72:75], a[20:23]
v_exp_f32 v232, v232
v_exp_f32 v233, v233
v_exp_f32 v234, v234
M a[84:87], a[212:215], v[136:139], a[84:87]
v_exp_f32 v235, v235
v_exp_f32 v236, v236
v_exp_f32 v237, v237
T a[236:237], v27, 0
T a[238:239], v27, 8192
WL 10
M a[24:27], a[216:219], v[72:75], a[24:27]
v_exp_f32 v238, v238
v_exp_f32 v239, v239
v_exp_f32 v240, v240
M a[88:91], a[216:219], v[136:139], a[88:91]
v_exp_f32 v241, v241
v_exp_f32 v242, v242
v_exp_f32 v243, v243
T a[240:241], v28, 0
T a[242:243], v28, 8192
WL 10
M a[28:31], a[220:223], v[72:75], a[28:31]
v_add_f32 v4, v4, v228
v_add_f32 v5, v5, v230
v_add_f32 v4, v4, v232
M a[92:95], a[220:223], v[136:139], a[92:95]
v_add_f32 v5, v5, v234
v_add_f32 v4, v4, v236
v_add_f32 v5, v5, v238
T a[244:245], v29, 0
T a[246:247], v29, 8192
WL 10
M a[32:35], a[224:227], v[72:75], a[32:35]
v_add_f32 v4, v4, v240
v_add_f32 v5, v5, v242
v_add_f32 v4, v4, v229
M a[96:99], a[224:227], v[136:139], a[96:99]
v_add_f32 v5, v5, v231
v_add_f32 v4, v4, v233
v_add_f32 v5, v5, v235
T a[248:249], v30, 0
T a[250:251], v30, 8192
WL 10
M a[36:39], a[228:231], v[72:75], a[36:39]
v_add_f32 v4, v4, v237
v_add_f32 v5, v5, v239
v_add_f32 v4, v4, v241
M a[100:103], a[228:231], v[136:139], a[100:103]
v_add_f32 v5, v5, v243
CV v76, v228, v229
CV v140, v230, v231
T a[252:253], v31, 0
T a[254:255], v31, 8192
WL 10
M a[40:43], a[232:235], v[72:75], a[40:43]
CV v77, v232, v233
CV v141, v234, v235
CV v78, v236, v237
M a[104:107], a[232:235], v[136:139], a[104:107]
CV v142, v238, v239
CV v79, v240, v241
CV v143, v242, v243
s_waitcnt vmcnt(24)
s_barrier
T a[192:193], v16, 16384
T a[194:195], v16, 24576
WL 10
M a[44:47], a[236:239], v[72:75], a[44:47]
M a[108:111], a[236:239], v[136:139], a[108:111]
s_add_u32 m0, s55, 16384
s_mov_b32 s40, 163840
buffer_load_dwordx4 v9, s[16:19], s40 offen nt lds
T a[196:197], v17, 16384
T a[198:199], v17, 24576
WL 10
M a[48:51], a[240:243], v[72:75], a[48:51]
M a[112:115], a[240:243], v[136:139], a[112:115]
s_add_u32 m0, s55, 20480
s_mov_b32 s40, 167936
buffer_load_dwordx4 v9, s[16:19], s40 offen nt lds
T a[200:201], v18, 16384
T a[202:203], v18, 24576
WL 10
M a[52:55], a[244:247], v[72:75], a[52:55]
M a[116:119], a[244:247], v[136:139], a[116:119]
s_add_u32 m0, s55, 24576
s_mov_b32 s40, 172032
buffer_load_dwordx4 v9, s[16:19], s40 offen nt lds
T a[204:205], v19, 16384
T a[206:207], v19, 24576
WL 10
M a[56:59], a[248:251], v[72:75], a[56:59]
M a[120:123], a[248:251], v[136:139], a[120:123]
s_add_u32 m0, s55, 28672
s_mov_b32 s40, 176128
buffer_load_dwordx4 v9, s[16:19], s40 offen nt lds
T a[208:209], v20, 16384
T a[210:211], v20, 24576
WL 10
M a[60:63], a[252:255], v[72:75], a[60:63]
M a[124:127], a[252:255], v[136:139], a[124:127]
T a[212:213], v21, 16384
T a[214:215], v21, 24576
s_nop 1
WL 10
M a[0:3], a[192:195], v[76:79], a[0:3]
M a[64:67], a[192:195], v[140:143], a[64:67]
R v[212:215], v224, 4096
M a[128:131], a[192:195], v[216:219], a[128:131]
T a[216:217], v22, 16384
T a[218:219], v22, 24576
WL 11
M a[4:7], a[196:199], v[76:79], a[4:7]
v_lshlrev_b32 v228, 16, v80
v_and_b32 v229, 0xffff0000, v80
v_lshlrev_b32 v230, 16, v144
M a[68:71], a[196:199], v[140:143], a[68:71]
v_and_b32 v231, 0xffff0000, v144
v_lshlrev_b32 v232, 16, v81
v_and_b32 v233, 0xffff0000, v81
M a[132:135], a[196:199], v[216:219], a[132:135]
v_lshlrev_b32 v234, 16, v145
v_and_b32 v235, 0xffff0000, v145
v_lshlrev_b32 v236, 16, v82
T a[220:221], v23, 16384
T a[222:223], v23, 24576
WL 11
M a[8:11], a[200:203], v[76:79], a[8:11]
v_and_b32 v237, 0xffff0000, v82
v_lshlrev_b32 v238, 16, v146
v_and_b32 v239, 0xffff0000, v146
M a[72:75], a[200:203], v[140:143], a[72:75]
v_lshlrev_b32 v240, 16, v83
v_and_b32 v241, 0xffff0000, v83
v_lshlrev_b32 v242, 16, v147
M a[136:139], a[200:203], v[216:219], a[136:139]
v_and_b32 v243, 0xffff0000, v147
v_fma_f32 v228, v228, s29, -v6
v_fma_f32 v229, v229, s29, -v6
T a[224:225], v24, 16384
T a[226:227], v24, 24576
WL 11
M a[12:15], a[204:207], v[76:79], a[12:15]
v_fma_f32 v230, v230, s29, -v7
v_fma_f32 v231, v231, s29, -v7
v_fma_f32 v232, v232, s29, -v6
M a[76:79], a[204:207], v[140:143], a[76:79]
v_fma_f32 v233, v233, s29, -v6
v_fma_f32 v234, v234, s29, -v7
v_fma_f32 v235, v235, s29, -v7
M a[140:143], a[204:207], v[216:219], a[140:143]
v_fma_f32 v236, v236, s29, -v6
v_fma_f32 v237, v237, s29, -v6
v_fma_f32 v238, v238, s29, -v7
M a[144:147], v[220:223], v[216:219], a[144:147]
v_fma_f32 v239, v239, s29, -v7
v_fma_f32 v240, v240, s29, -v6
v_fma_f32 v241, v241, s29, -v6
T a[228:229], v25, 16384
T a[230:231], v25, 24576
WL 11
M a[16:19], a[208:211], v[76:79], a[16:19]
v_fma_f32 v242, v242, s29, -v7
v_fma_f32 v243, v243, s29, -v7
v_exp_f32 v228, v228
M a[80:83], a[208:211], v[140:143], a[80:83]
v_exp_f32 v229, v229
v_exp_f32 v230, v230
v_exp_f32 v231, v231
T a[232:233], v26, 16384
T a[234:235], v26, 24576
WL 11
M a[20:23], a[212:215], v[76:79], a[20:23]
v_exp_f32 v232, v232
v_exp_f32 v233, v233
v_exp_f32 v234, v234
M a[84:87], a[212:215], v[140:143], a[84:87]
v_exp_f32 v235, v235
v_exp_f32 v236, v236
v_exp_f32 v237, v237
T a[236:237], v27, 16384
T a[238:239], v27, 24576
WL 10
M a[24:27], a[216:219], v[76:79], a[24:27]
v_exp_f32 v238, v238
v_exp_f32 v239, v239
v_exp_f32 v240, v240
M a[88:91], a[216:219], v[140:143], a[88:91]
v_exp_f32 v241, v241
v_exp_f32 v242, v242
v_exp_f32 v243, v243
T a[240:241], v28, 16384
T a[242:243], v28, 24576
WL 10
M a[28:31], a[220:223], v[76:79], a[28:31]
v_add_f32 v4, v4, v228
v_add_f32 v5, v5, v230
v_add_f32 v4, v4, v232
M a[92:95], a[220:223], v[140:143], a[92:95]
v_add_f32 v5, v5, v234
v_add_f32 v4, v4, v236
v_add_f32 v5, v5, v238
T a[244:245], v29, 16384
T a[246:247], v29, 24576
WL 10
M a[32:35], a[224:227], v[76:79], a[32:35]
v_add_f32 v4, v4, v240
v_add_f32 v5, v5, v242
v_add_f32 v4, v4, v229
M a[96:99], a[224:227], v[140:143], a[96:99]
v_add_f32 v5, v5, v231
v_add_f32 v4, v4, v233
v_add_f32 v5, v5, v235
T a[248:249], v30, 16384
T a[250:251], v30, 24576
WL 10
M a[36:39], a[228:231], v[76:79], a[36:39]
v_add_f32 v4, v4, v237
v_add_f32 v5, v5, v239
v_add_f32 v4, v4, v241
M a[100:103], a[228:231], v[140:143], a[100:103]
v_add_f32 v5, v5, v243
CV v80, v228, v229
CV v144, v230, v231
T a[252:253], v31, 16384
T a[254:255], v31, 24576
WL 10
M a[40:43], a[232:235], v[76:79], a[40:43]
CV v81, v232, v233
CV v145, v234, v235
CV v82, v236, v237
M a[104:107], a[232:235], v[140:143], a[104:107]
CV v146, v238, v239
CV v83, v240, v241
CV v147, v242, v243
s_waitcnt vmcnt(24)
s_barrier
T a[192:193], v16, 32768
T a[194:195], v16, 40960
WL 10
M a[44:47], a[236:239], v[76:79], a[44:47]
M a[108:111], a[236:239], v[140:143], a[108:111]
s_add_u32 m0, s55, 65536
s_mov_b32 s40, 180224
buffer_load_dwordx4 v9, s[16:19], s40 offen nt lds
T a[196:197], v17, 32768
T a[198:199], v17, 40960
WL 10
M a[48:51], a[240:243], v[76:79], a[48:51]
M a[112:115], a[240:243], v[140:143], a[112:115]
s_add_u32 m0, s55, 69632
s_mov_b32 s40, 184320
buffer_load_dwordx4 v9, s[16:19], s40 offen nt lds
T a[200:201], v18, 32768
T a[202:203], v18, 40960
WL 10
M a[52:55], a[244:247], v[76:79], a[52:55]
M a[116:119], a[244:247], v[140:143], a[116:119]
s_add_u32 m0, s55, 73728
s_mov_b32 s40, 188416
buffer_load_dwordx4 v9, s[16:19], s40 offen nt lds
T a[204:205], v19, 32768
T a[206:207], v19, 40960
WL 10
M a[56:59], a[248:251], v[76:79], a[56:59]
M a[120:123], a[248:251], v[140:143], a[120:123]
s_add_u32 m0, s55, 77824
s_mov_b32 s40, 192512
buffer_load_dwordx4 v9, s[16:19], s40 offen nt lds
T a[208:209], v20, 32768
T a[210:211], v20, 40960
WL 10
M a[60:63], a[252:255], v[76:79], a[60:63]
M a[124:127], a[252:255], v[140:143], a[124:127]
T a[212:213], v21, 32768
T a[214:215], v21, 40960
s_nop 1
WL 10
M a[0:3], a[192:195], v[80:83], a[0:3]
M a[64:67], a[192:195], v[144:147], a[64:67]
R v[216:219], v224, 5120
M a[128:131], a[192:195], v[212:215], a[128:131]
T a[216:217], v22, 32768
T a[218:219], v22, 40960
WL 11
M a[4:7], a[196:199], v[80:83], a[4:7]
v_lshlrev_b32 v228, 16, v84
v_and_b32 v229, 0xffff0000, v84
v_lshlrev_b32 v230, 16, v148
M a[68:71], a[196:199], v[144:147], a[68:71]
v_and_b32 v231, 0xffff0000, v148
v_lshlrev_b32 v232, 16, v85
v_and_b32 v233, 0xffff0000, v85
M a[132:135], a[196:199], v[212:215], a[132:135]
v_lshlrev_b32 v234, 16, v149
v_and_b32 v235, 0xffff0000, v149
v_lshlrev_b32 v236, 16, v86
T a[220:221], v23, 32768
T a[222:223], v23, 40960
WL 11
M a[8:11], a[200:203], v[80:83], a[8:11]
v_and_b32 v237, 0xffff0000, v86
v_lshlrev_b32 v238, 16, v150
v_and_b32 v239, 0xffff0000, v150
M a[72:75], a[200:203], v[144:147], a[72:75]
v_lshlrev_b32 v240, 16, v87
v_and_b32 v241, 0xffff0000, v87
v_lshlrev_b32 v242, 16, v151
M a[136:139], a[200:203], v[212:215], a[136:139]
v_and_b32 v243, 0xffff0000, v151
v_fma_f32 v228, v228, s29, -v6
v_fma_f32 v229, v229, s29, -v6
T a[224:225], v24, 32768
T a[226:227], v24, 40960
WL 11
M a[12:15], a[204:207], v[80:83], a[12:15]
v_fma_f32 v230, v230, s29, -v7
v_fma_f32 v231, v231, s29, -v7
v_fma_f32 v232, v232, s29, -v6
M a[76:79], a[204:207], v[144:147], a[76:79]
v_fma_f32 v233, v233, s29, -v6
v_fma_f32 v234, v234, s29, -v7
v_fma_f32 v235, v235, s29, -v7
M a[140:143], a[204:207], v[212:215], a[140:143]
v_fma_f32 v236, v236, s29, -v6
v_fma_f32 v237, v237, s29, -v6
v_fma_f32 v238, v238, s29, -v7
M a[144:147], v[220:223], v[212:215], a[144:147]
v_fma_f32 v239, v239, s29, -v7
v_fma_f32 v240, v240, s29, -v6
v_fma_f32 v241, v241, s29, -v6
T a[228:229], v25, 32768
T a[230:231], v25, 40960
WL 11
M a[16:19], a[208:211], v[80:83], a[16:19]
v_fma_f32 v242, v242, s29, -v7
v_fma_f32 v243, v243, s29, -v7
v_exp_f32 v228, v228
M a[80:83], a[208:211], v[144:147], a[80:83]
v_exp_f32 v229, v229
v_exp_f32 v230, v230
v_exp_f32 v231, v231
T a[232:233], v26, 32768
T a[234:235], v26, 40960
WL 11
M a[20:23], a[212:215], v[80:83], a[20:23]
v_exp_f32 v232, v232
v_exp_f32 v233, v233
v_exp_f32 v234, v234
M a[84:87], a[212:215], v[144:147], a[84:87]
v_exp_f32 v235, v235
v_exp_f32 v236, v236
v_exp_f32 v237, v237
T a[236:237], v27, 32768
T a[238:239], v27, 40960
WL 10
M a[24:27], a[216:219], v[80:83], a[24:27]
v_exp_f32 v238, v238
v_exp_f32 v239, v239
v_exp_f32 v240, v240
M a[88:91], a[216:219], v[144:147], a[88:91]
v_exp_f32 v241, v241
v_exp_f32 v242, v242
v_exp_f32 v243, v243
T a[240:241], v28, 32768
T a[242:243], v28, 40960
WL 10
M a[28:31], a[220:223], v[80:83], a[28:31]
v_add_f32 v4, v4, v228
v_add_f32 v5, v5, v230
v_add_f32 v4, v4, v232
M a[92:95], a[220:223], v[144:147], a[92:95]
v_add_f32 v5, v5, v234
v_add_f32 v4, v4, v236
v_add_f32 v5, v5, v238
T a[244:245], v29, 32768
T a[246:247], v29, 40960
WL 10
M a[32:35], a[224:227], v[80:83], a[32:35]
v_add_f32 v4, v4, v240
v_add_f32 v5, v5, v242
v_add_f32 v4, v4, v229
M a[96:99], a[224:227], v[144:147], a[96:99]
v_add_f32 v5, v5, v231
v_add_f32 v4, v4, v233
v_add_f32 v5, v5, v235
T a[248:249], v30, 32768
T a[250:251], v30, 40960
WL 10
M a[36:39], a[228:231], v[80:83], a[36:39]
v_add_f32 v4, v4, v237
v_add_f32 v5, v5, v239
v_add_f32 v4, v4, v241
M a[100:103], a[228:231], v[144:147], a[100:103]
v_add_f32 v5, v5, v243
CV v84, v228, v229
CV v148, v230, v231
T a[252:253], v31, 32768
T a[254:255], v31, 40960
WL 10
M a[40:43], a[232:235], v[80:83], a[40:43]
CV v85, v232, v233
CV v149, v234, v235
CV v86, v236, v237
M a[104:107], a[232:235], v[144:147], a[104:107]
CV v150, v238, v239
CV v87, v240, v241
CV v151, v242, v243
s_waitcnt vmcnt(24)
s_barrier
v_add_u32 v16, 4294901760, v16
v_add_u32 v17, 4294901760, v17
v_add_u32 v18, 4294901760, v18
v_add_u32 v19, 4294901760, v19
v_add_u32 v20, 4294901760, v20
v_add_u32 v21, 4294901760, v21
v_add_u32 v22, 4294901760, v22
v_add_u32 v23, 4294901760, v23
v_add_u32 v24, 4294901760, v24
v_add_u32 v25, 4294901760, v25
v_add_u32 v26, 4294901760, v26
v_add_u32 v27, 4294901760, v27
v_add_u32 v28, 4294901760, v28
v_add_u32 v29, 4294901760, v29
v_add_u32 v30, 4294901760, v30
v_add_u32 v31, 4294901760, v31
T a[192:193], v16, 32768
T a[194:195], v16, 40960
WL 10
M a[44:47], a[236:239], v[80:83], a[44:47]
M a[108:111], a[236:239], v[144:147], a[108:111]
s_add_u32 m0, s55, 81920
s_mov_b32 s40, 196608
buffer_load_dwordx4 v9, s[16:19], s40 offen nt lds
T a[196:197], v17, 32768
T a[198:199], v17, 40960
WL 10
M a[48:51], a[240:243], v[80:83], a[48:51]
M a[112:115], a[240:243], v[144:147], a[112:115]
s_add_u32 m0, s55, 86016
s_mov_b32 s40, 200704
buffer_load_dwordx4 v9, s[16:19], s40 offen nt lds
T a[200:201], v18, 32768
T a[202:203], v18, 40960
WL 10
M a[52:55], a[244:247], v[80:83], a[52:55]
M a[116:119], a[244:247], v[144:147], a[116:119]
s_add_u32 m0, s55, 90112
s_mov_b32 s40, 204800
buffer_load_dwordx4 v9, s[16:19], s40 offen nt lds
T a[204:205], v19, 32768
T a[206:207], v19, 40960
WL 10
M a[56:59], a[248:251], v[80:83], a[56:59]
M a[120:123], a[248:251], v[144:147], a[120:123]
s_add_u32 m0, s55, 94208
s_mov_b32 s40, 208896
buffer_load_dwordx4 v9, s[16:19], s40 offen nt lds
T a[208:209], v20, 32768
T a[210:211], v20, 40960
WL 10
M a[60:63], a[252:255], v[80:83], a[60:63]
M a[124:127], a[252:255], v[144:147], a[124:127]
T a[212:213], v21, 32768
T a[214:215], v21, 40960
s_nop 1
WL 10
M a[0:3], a[192:195], v[84:87], a[0:3]
M a[64:67], a[192:195], v[148:151], a[64:67]
R v[212:215], v224, 6144
M a[128:131], a[192:195], v[216:219], a[128:131]
T a[216:217], v22, 32768
T a[218:219], v22, 40960
WL 11
M a[4:7], a[196:199], v[84:87], a[4:7]
v_lshlrev_b32 v228, 16, v88
v_and_b32 v229, 0xffff0000, v88
v_lshlrev_b32 v230, 16, v152
M a[68:71], a[196:199], v[148:151], a[68:71]
v_and_b32 v231, 0xffff0000, v152
v_lshlrev_b32 v232, 16, v89
v_and_b32 v233, 0xffff0000, v89
M a[132:135], a[196:199], v[216:219], a[132:135]
v_lshlrev_b32 v234, 16, v153
v_and_b32 v235, 0xffff0000, v153
v_lshlrev_b32 v236, 16, v90
T a[220:221], v23, 32768
T a[222:223], v23, 40960
WL 11
M a[8:11], a[200:203], v[84:87], a[8:11]
v_and_b32 v237, 0xffff0000, v90
v_lshlrev_b32 v238, 16, v154
v_and_b32 v239, 0xffff0000, v154
M a[72:75], a[200:203], v[148:151], a[72:75]
v_lshlrev_b32 v240, 16, v91
v_and_b32 v241, 0xffff0000, v91
v_lshlrev_b32 v242, 16, v155
M a[136:139], a[200:203], v[216:219], a[136:139]
v_and_b32 v243, 0xffff0000, v155
v_fma_f32 v228, v228, s29, -v6
v_fma_f32 v229, v229, s29, -v6
T a[224:225], v24, 32768
T a[226:227], v24, 40960
WL 11
M a[12:15], a[204:207], v[84:87], a[12:15]
v_fma_f32 v230, v230, s29, -v7
v_fma_f32 v231, v231, s29, -v7
v_fma_f32 v232, v232, s29, -v6
M a[76:79], a[204:207], v[148:151], a[76:79]
v_fma_f32 v233, v233, s29, -v6
v_fma_f32 v234, v234, s29, -v7
v_fma_f32 v235, v235, s29, -v7
M a[140:143], a[204:207], v[216:219], a[140:143]
v_fma_f32 v236, v236, s29, -v6
v_fma_f32 v237, v237, s29, -v6
v_fma_f32 v238, v238, s29, -v7
M a[144:147], v[220:223], v[216:219], a[144:147]
v_fma_f32 v239, v239, s29, -v7
v_fma_f32 v240, v240, s29, -v6
v_fma_f32 v241, v241, s29, -v6
T a[228:229], v25, 32768
T a[230:231], v25, 40960
WL 11
M a[16:19], a[208:211], v[84:87], a[16:19]
v_fma_f32 v242, v242, s29, -v7
v_fma_f32 v243, v243, s29, -v7
v_exp_f32 v228, v228
M a[80:83], a[208:211], v[148:151], a[80:83]
v_exp_f32 v229, v229
v_exp_f32 v230, v230
v_exp_f32 v231, v231
T a[232:233], v26, 32768
T a[234:235], v26, 40960
WL 11
M a[20:23], a[212:215], v[84:87], a[20:23]
v_exp_f32 v232, v232
v_exp_f32 v233, v233
v_exp_f32 v234, v234
M a[84:87], a[212:215], v[148:151], a[84:87]
v_exp_f32 v235, v235
v_exp_f32 v236, v236
v_exp_f32 v237, v237
T a[236:237], v27, 32768
T a[238:239], v27, 40960
WL 10
M a[24:27], a[216:219], v[84:87], a[24:27]
v_exp_f32 v238, v238
v_exp_f32 v239, v239
v_exp_f32 v240, v240
M a[88:91], a[216:219], v[148:151], a[88:91]
v_exp_f32 v241, v241
v_exp_f32 v242, v242
v_exp_f32 v243, v243
T a[240:241], v28, 32768
T a[242:243], v28, 40960
WL 10
M a[28:31], a[220:223], v[84:87], a[28:31]
v_add_f32 v4, v4, v228
v_add_f32 v5, v5, v230
v_add_f32 v4, v4, v232
M a[92:95], a[220:223], v[148:151], a[92:95]
v_add_f32 v5, v5, v234
v_add_f32 v4, v4, v236
v_add_f32 v5, v5, v238
T a[244:245], v29, 32768
T a[246:247], v29, 40960
WL 10
M a[32:35], a[224:227], v[84:87], a[32:35]
v_add_f32 v4, v4, v240
v_add_f32 v5, v5, v242
v_add_f32 v4, v4, v229
M a[96:99], a[224:227], v[148:151], a[96:99]
v_add_f32 v5, v5, v231
v_add_f32 v4, v4, v233
v_add_f32 v5, v5, v235
T a[248:249], v30, 32768
T a[250:251], v30, 40960
WL 10
M a[36:39], a[228:231], v[84:87], a[36:39]
v_add_f32 v4, v4, v237
v_add_f32 v5, v5, v239
v_add_f32 v4, v4, v241
M a[100:103], a[228:231], v[148:151], a[100:103]
v_add_f32 v5, v5, v243
CV v88, v228, v229
CV v152, v230, v231
T a[252:253], v31, 32768
T a[254:255], v31, 40960
WL 10
M a[40:43], a[232:235], v[84:87], a[40:43]
CV v89, v232, v233
CV v153, v234, v235
CV v90, v236, v237
M a[104:107], a[232:235], v[148:151], a[104:107]
CV v154, v238, v239
CV v91, v240, v241
CV v155, v242, v243
s_waitcnt vmcnt(24)
s_barrier
T a[192:193], v16, 49152
T a[194:195], v16, 57344
WL 10
M a[44:47], a[236:239], v[84:87], a[44:47]
M a[108:111], a[236:239], v[148:151], a[108:111]
s_add_u32 m0, s55, 98304
s_mov_b32 s40, 212992
buffer_load_dwordx4 v9, s[16:19], s40 offen nt lds
T a[196:197], v17, 49152
T a[198:199], v17, 57344
WL 10
M a[48:51], a[240:243], v[84:87], a[48:51]
M a[112:115], a[240:243], v[148:151], a[112:115]
s_add_u32 m0, s55, 102400
s_mov_b32 s40, 217088
buffer_load_dwordx4 v9, s[16:19], s40 offen nt lds
T a[200:201], v18, 49152
T a[202:203], v18, 57344
WL 10
M a[52:55], a[244:247], v[84:87], a[52:55]
M a[116:119], a[244:247], v[148:151], a[116:119]
s_add_u32 m0, s55, 106496
s_mov_b32 s40, 221184
buffer_load_dwordx4 v9, s[16:19], s40 offen nt lds
T a[204:205], v19, 49152
T a[206:207], v19, 57344
WL 10
M a[56:59], a[248:251], v[84:87], a[56:59]
M a[120:123], a[248:251], v[148:151], a[120:123]
s_add_u32 m0, s55, 110592
s_mov_b32 s40, 225280
buffer_load_dwordx4 v9, s[16:19], s40 offen nt lds
T a[208:209], v20, 49152
T a[210:211], v20, 57344
WL 10
M a[60:63], a[252:255], v[84:87], a[60:63]
M a[124:127], a[252:255], v[148:151], a[124:127]
T a[212:213], v21, 49152
T a[214:215], v21, 57344
s_nop 1
WL 10
M a[0:3], a[192:195], v[88:91], a[0:3]
M a[64:67], a[192:195], v[152:155], a[64:67]
R v[216:219], v224, 7168
M a[128:131], a[192:195], v[212:215], a[128:131]
T a[216:217], v22, 49152
T a[218:219], v22, 57344
WL 11
M a[4:7], a[196:199], v[88:91], a[4:7]
v_lshlrev_b32 v228, 16, v92
v_and_b32 v229, 0xffff0000, v92
v_lshlrev_b32 v230, 16, v156
M a[68:71], a[196:199], v[152:155], a[68:71]
v_and_b32 v231, 0xffff0000, v156
v_lshlrev_b32 v232, 16, v93
v_and_b32 v233, 0xffff0000, v93
M a[132:135], a[196:199], v[212:215], a[132:135]
v_lshlrev_b32 v234, 16, v157
v_and_b32 v235, 0xffff0000, v157
v_lshlrev_b32 v236, 16, v94
T a[220:221], v23, 49152
T a[222:223], v23, 57344
WL 11
M a[8:11], a[200:203], v[88:91], a[8:11]
v_and_b32 v237, 0xffff0000, v94
v_lshlrev_b32 v238, 16, v158
v_and_b32 v239, 0xffff0000, v158
M a[72:75], a[200:203], v[152:155], a[72:75]
v_lshlrev_b32 v240, 16, v95
v_and_b32 v241, 0xffff0000, v95
v_lshlrev_b32 v242, 16, v159
M a[136:139], a[200:203], v[212:215], a[136:139]
v_and_b32 v243, 0xffff0000, v159
v_fma_f32 v228, v228, s29, -v6
v_fma_f32 v229, v229, s29, -v6
T a[224:225], v24, 49152
T a[226:227], v24, 57344
WL 11
M a[12:15], a[204:207], v[88:91], a[12:15]
v_fma_f32 v230, v230, s29, -v7
v_fma_f32 v231, v231, s29, -v7
v_fma_f32 v232, v232, s29, -v6
M a[76:79], a[204:207], v[152:155], a[76:79]
v_fma_f32 v233, v233, s29, -v6
v_fma_f32 v234, v234, s29, -v7
v_fma_f32 v235, v235, s29, -v7
M a[140:143], a[204:207], v[212:215], a[140:143]
v_fma_f32 v236, v236, s29, -v6
v_fma_f32 v237, v237, s29, -v6
v_fma_f32 v238, v238, s29, -v7
M a[144:147], v[220:223], v[212:215], a[144:147]
v_fma_f32 v239, v239, s29, -v7
v_fma_f32 v240, v240, s29, -v6
v_fma_f32 v241, v241, s29, -v6
T a[228:229], v25, 49152
T a[230:231], v25, 57344
WL 11
M a[16:19], a[208:211], v[88:91], a[16:19]
v_fma_f32 v242, v242, s29, -v7
v_fma_f32 v243, v243, s29, -v7
v_exp_f32 v228, v228
M a[80:83], a[208:211], v[152:155], a[80:83]
v_exp_f32 v229, v229
v_exp_f32 v230, v230
v_exp_f32 v231, v231
T a[232:233], v26, 49152
T a[234:235], v26, 57344
WL 11
M a[20:23], a[212:215], v[88:91], a[20:23]
v_exp_f32 v232, v232
v_exp_f32 v233, v233
v_exp_f32 v234, v234
M a[84:87], a[212:215], v[152:155], a[84:87]
v_exp_f32 v235, v235
v_exp_f32 v236, v236
v_exp_f32 v237, v237
T a[236:237], v27, 49152
T a[238:239], v27, 57344
WL 10
M a[24:27], a[216:219], v[88:91], a[24:27]
v_exp_f32 v238, v238
v_exp_f32 v239, v239
v_exp_f32 v240, v240
M a[88:91], a[216:219], v[152:155], a[88:91]
v_exp_f32 v241, v241
v_exp_f32 v242, v242
v_exp_f32 v243, v243
T a[240:241], v28, 49152
T a[242:243], v28, 57344
WL 10
M a[28:31], a[220:223], v[88:91], a[28:31]
v_add_f32 v4, v4, v228
v_add_f32 v5, v5, v230
v_add_f32 v4, v4, v232
M a[92:95], a[220:223], v[152:155], a[92:95]
v_add_f32 v5, v5, v234
v_add_f32 v4, v4, v236
v_add_f32 v5, v5, v238
T a[244:245], v29, 49152
T a[246:247], v29, 57344
WL 10
M a[32:35], a[224:227], v[88:91], a[32:35]
v_add_f32 v4, v4, v240
v_add_f32 v5, v5, v242
v_add_f32 v4, v4, v229
M a[96:99], a[224:227], v[152:155], a[96:99]
v_add_f32 v5, v5, v231
v_add_f32 v4, v4, v233
v_add_f32 v5, v5, v235
T a[248:249], v30, 49152
T a[250:251], v30, 57344
WL 10
M a[36:39], a[228:231], v[88:91], a[36:39]
v_add_f32 v4, v4, v237
v_add_f32 v5, v5, v239
v_add_f32 v4, v4, v241
M a[100:103], a[228:231], v[152:155], a[100:103]
v_add_f32 v5, v5, v243
CV v92, v228, v229
CV v156, v230, v231
T a[252:253], v31, 49152
T a[254:255], v31, 57344
WL 10
M a[40:43], a[232:235], v[88:91], a[40:43]
CV v93, v232, v233
CV v157, v234, v235
CV v94, v236, v237
M a[104:107], a[232:235], v[152:155], a[104:107]
CV v158, v238, v239
CV v95, v240, v241
CV v159, v242, v243
s_waitcnt vmcnt(24)
s_barrier
T a[192:193], v16, 0
T a[194:195], v16, 8192
WL 10
M a[44:47], a[236:239], v[88:91], a[44:47]
M a[108:111], a[236:239], v[152:155], a[108:111]
s_add_u32 m0, s55, 32768
s_mov_b32 s40, 229376
buffer_load_dwordx4 v9, s[16:19], s40 offen nt lds
T a[196:197], v17, 0
T a[198:199], v17, 8192
WL 10
M a[48:51], a[240:243], v[88:91], a[48:51]
M a[112:115], a[240:243], v[152:155], a[112:115]
s_add_u32 m0, s55, 36864
s_mov_b32 s40, 233472
buffer_load_dwordx4 v9, s[16:19], s40 offen nt lds
T a[200:201], v18, 0
T a[202:203], v18, 8192
WL 10
M a[52:55], a[244:247], v[88:91], a[52:55]
M a[116:119], a[244:247], v[152:155], a[116:119]
s_add_u32 m0, s55, 40960
s_mov_b32 s40, 237568
buffer_load_dwordx4 v9, s[16:19], s40 offen nt lds
T a[204:205], v19, 0
T a[206:207], v19, 8192
WL 10
M a[56:59], a[248:251], v[88:91], a[56:59]
M a[120:123], a[248:251], v[152:155], a[120:123]
s_add_u32 m0, s55, 45056
s_mov_b32 s40, 241664
buffer_load_dwordx4 v9, s[16:19], s40 offen nt lds
T a[208:209], v20, 0
T a[210:211], v20, 8192
WL 10
M a[60:63], a[252:255], v[88:91], a[60:63]
M a[124:127], a[252:255], v[152:155], a[124:127]
T a[212:213], v21, 0
T a[214:215], v21, 8192
s_nop 1
WL 10
M a[0:3], a[192:195], v[92:95], a[0:3]
M a[64:67], a[192:195], v[156:159], a[64:67]
R v[212:215], v224, 8192
M a[128:131], a[192:195], v[216:219], a[128:131]
T a[216:217], v22, 0
T a[218:219], v22, 8192
WL 11
M a[4:7], a[196:199], v[92:95], a[4:7]
v_lshlrev_b32 v228, 16, v96
v_and_b32 v229, 0xffff0000, v96
v_lshlrev_b32 v230, 16, v160
M a[68:71], a[196:199], v[156:159], a[68:71]
v_and_b32 v231, 0xffff0000, v160
v_lshlrev_b32 v232, 16, v97
v_and_b32 v233, 0xffff0000, v97
M a[132:135], a[196:199], v[216:219], a[132:135]
v_lshlrev_b32 v234, 16, v161
v_and_b32 v235, 0xffff0000, v161
v_lshlrev_b32 v236, 16, v98
T a[220:221], v23, 0
T a[222:223], v23, 8192
WL 11
M a[8:11], a[200:203], v[92:95], a[8:11]
v_and_b32 v237, 0xffff0000, v98
v_lshlrev_b32 v238, 16, v162
v_and_b32 v239, 0xffff0000, v162
M a[72:75], a[200:203], v[156:159], a[72:75]
v_lshlrev_b32 v240, 16, v99
v_and_b32 v241, 0xffff0000, v99
v_lshlrev_b32 v242, 16, v163
M a[136:139], a[200:203], v[216:219], a[136:139]
v_and_b32 v243, 0xffff0000, v163
v_fma_f32 v228, v228, s29, -v6
v_fma_f32 v229, v229, s29, -v6
T a[224:225], v24, 0
T a[226:227], v24, 8192
WL 11
M a[12:15], a[204:207], v[92:95], a[12:15]
v_fma_f32 v230, v230, s29, -v7
v_fma_f32 v231, v231, s29, -v7
v_fma_f32 v232, v232, s29, -v6
M a[76:79], a[204:207], v[156:159], a[76:79]
v_fma_f32 v233, v233, s29, -v6
v_fma_f32 v234, v234, s29, -v7
v_fma_f32 v235, v235, s29, -v7
M a[140:143], a[204:207], v[216:219], a[140:143]
v_fma_f32 v236, v236, s29, -v6
v_fma_f32 v237, v237, s29, -v6
v_fma_f32 v238, v238, s29, -v7
M a[144:147], v[220:223], v[216:219], a[144:147]
v_fma_f32 v239, v239, s29, -v7
v_fma_f32 v240, v240, s29, -v6
v_fma_f32 v241, v241, s29, -v6
T a[228:229], v25, 0
T a[230:231], v25, 8192
WL 11
M a[16:19], a[208:211], v[92:95], a[16:19]
v_fma_f32 v242, v242, s29, -v7
v_fma_f32 v243, v243, s29, -v7
v_exp_f32 v228, v228
M a[80:83], a[208:211], v[156:159], a[80:83]
v_exp_f32 v229, v229
v_exp_f32 v230, v230
v_exp_f32 v231, v231
T a[232:233], v26, 0
T a[234:235], v26, 8192
WL 11
M a[20:23], a[212:215], v[92:95], a[20:23]
v_exp_f32 v232, v232
v_exp_f32 v233, v233
v_exp_f32 v234, v234
M a[84:87], a[212:215], v[156:159], a[84:87]
v_exp_f32 v235, v235
v_exp_f32 v236, v236
v_exp_f32 v237, v237
T a[236:237], v27, 0
T a[238:239], v27, 8192
WL 10
M a[24:27], a[216:219], v[92:95], a[24:27]
v_exp_f32 v238, v238
v_exp_f32 v239, v239
v_exp_f32 v240, v240
M a[88:91], a[216:219], v[156:159], a[88:91]
v_exp_f32 v241, v241
v_exp_f32 v242, v242
v_exp_f32 v243, v243
T a[240:241], v28, 0
T a[242:243], v28, 8192
WL 10
M a[28:31], a[220:223], v[92:95], a[28:31]
v_add_f32 v4, v4, v228
v_add_f32 v5, v5, v230
v_add_f32 v4, v4, v232
M a[92:95], a[220:223], v[156:159], a[92:95]
v_add_f32 v5, v5, v234
v_add_f32 v4, v4, v236
v_add_f32 v5, v5, v238
T a[244:245], v29, 0
T a[246:247], v29, 8192
WL 10
M a[32:35], a[224:227], v[92:95], a[32:35]
v_add_f32 v4, v4, v240
v_add_f32 v5, v5, v242
v_add_f32 v4, v4, v229
M a[96:99], a[224:227], v[156:159], a[96:99]
v_add_f32 v5, v5, v231
v_add_f32 v4, v4, v233
v_add_f32 v5, v5, v235
T a[248:249], v30, 0
T a[250:251], v30, 8192
WL 10
M a[36:39], a[228:231], v[92:95], a[36:39]
v_add_f32 v4, v4, v237
v_add_f32 v5, v5, v239
v_add_f32 v4, v4, v241
M a[100:103], a[228:231], v[156:159], a[100:103]
v_add_f32 v5, v5, v243
CV v96, v228, v229
CV v160, v230, v231
T a[252:253], v31, 0
T a[254:255], v31, 8192
WL 10
M a[40:43], a[232:235], v[92:95], a[40:43]
CV v97, v232, v233
CV v161, v234, v235
CV v98, v236, v237
M a[104:107], a[232:235], v[156:159], a[104:107]
CV v162, v238, v239
CV v99, v240, v241
CV v163, v242, v243
s_waitcnt vmcnt(24)
s_barrier
v_add_u32 v16, 65536, v16
v_add_u32 v17, 65536, v17
v_add_u32 v18, 65536, v18
v_add_u32 v19, 65536, v19
v_add_u32 v20, 65536, v20
v_add_u32 v21, 65536, v21
v_add_u32 v22, 65536, v22
v_add_u32 v23, 65536, v23
v_add_u32 v24, 65536, v24
v_add_u32 v25, 65536, v25
v_add_u32 v26, 65536, v26
v_add_u32 v27, 65536, v27
v_add_u32 v28, 65536, v28
v_add_u32 v29, 65536, v29
v_add_u32 v30, 65536, v30
v_add_u32 v31, 65536, v31
T a[192:193], v16, 49152
T a[194:195], v16, 57344
WL 10
M a[44:47], a[236:239], v[92:95], a[44:47]
M a[108:111], a[236:239], v[156:159], a[108:111]
s_add_u32 m0, s55, 49152
s_mov_b32 s40, 245760
buffer_load_dwordx4 v9, s[16:19], s40 offen nt lds
T a[196:197], v17, 49152
T a[198:199], v17, 57344
WL 10
M a[48:51], a[240:243], v[92:95], a[48:51]
M a[112:115], a[240:243], v[156:159], a[112:115]
s_add_u32 m0, s55, 53248
s_mov_b32 s40, 249856
buffer_load_dwordx4 v9, s[16:19], s40 offen nt lds
T a[200:201], v18, 49152
T a[202:203], v18, 57344
WL 10
M a[52:55], a[244:247], v[92:95], a[52:55]
M a[116:119], a[244:247], v[156:159], a[116:119]
s_add_u32 m0, s55, 57344
s_mov_b32 s40, 253952
buffer_load_dwordx4 v9, s[16:19], s40 offen nt lds
T a[204:205], v19, 49152
T a[206:207], v19, 57344
WL 10
M a[56:59], a[248:251], v[92:95], a[56:59]
M a[120:123], a[248:251], v[156:159], a[120:123]
s_add_u32 m0, s55, 61440
s_mov_b32 s40, 258048
buffer_load_dwordx4 v9, s[16:19], s40 offen nt lds
T a[208:209], v20, 49152
T a[210:211], v20, 57344
WL 10
M a[60:63], a[252:255], v[92:95], a[60:63]
M a[124:127], a[252:255], v[156:159], a[124:127]
T a[212:213], v21, 49152
T a[214:215], v21, 57344
s_nop 1
WL 10
M a[0:3], a[192:195], v[96:99], a[0:3]
M a[64:67], a[192:195], v[160:163], a[64:67]
R v[216:219], v224, 9216
M a[128:131], a[192:195], v[212:215], a[128:131]
T a[216:217], v22, 49152
T a[218:219], v22, 57344
WL 11
M a[4:7], a[196:199], v[96:99], a[4:7]
v_lshlrev_b32 v228, 16, v100
v_and_b32 v229, 0xffff0000, v100
v_lshlrev_b32 v230, 16, v164
M a[68:71], a[196:199], v[160:163], a[68:71]
v_and_b32 v231, 0xffff0000, v164
v_lshlrev_b32 v232, 16, v101
v_and_b32 v233, 0xffff0000, v101
M a[132:135], a[196:199], v[212:215], a[132:135]
v_lshlrev_b32 v234, 16, v165
v_and_b32 v235, 0xffff0000, v165
v_lshlrev_b32 v236, 16, v102
T a[220:221], v23, 49152
T a[222:223], v23, 57344
WL 11
M a[8:11], a[200:203], v[96:99], a[8:11]
v_and_b32 v237, 0xffff0000, v102
v_lshlrev_b32 v238, 16, v166
v_and_b32 v239, 0xffff0000, v166
M a[72:75], a[200:203], v[160:163], a[72:75]
v_lshlrev_b32 v240, 16, v103
v_and_b32 v241, 0xffff0000, v103
v_lshlrev_b32 v242, 16, v167
M a[136:139], a[200:203], v[212:215], a[136:139]
v_and_b32 v243, 0xffff0000, v167
v_fma_f32 v228, v228, s29, -v6
v_fma_f32 v229, v229, s29, -v6
T a[224:225], v24, 49152
T a[226:227], v24, 57344
WL 11
M a[12:15], a[204:207], v[96:99], a[12:15]
v_fma_f32 v230, v230, s29, -v7
v_fma_f32 v231, v231, s29, -v7
v_fma_f32 v232, v232, s29, -v6
M a[76:79], a[204:207], v[160:163], a[76:79]
v_fma_f32 v233, v233, s29, -v6
v_fma_f32 v234, v234, s29, -v7
v_fma_f32 v235, v235, s29, -v7
M a[140:143], a[204:207], v[212:215], a[140:143]
v_fma_f32 v236, v236, s29, -v6
v_fma_f32 v237, v237, s29, -v6
v_fma_f32 v238, v238, s29, -v7
M a[144:147], v[220:223], v[212:215], a[144:147]
v_fma_f32 v239, v239, s29, -v7
v_fma_f32 v240, v240, s29, -v6
v_fma_f32 v241, v241, s29, -v6
T a[228:229], v25, 49152
T a[230:231], v25, 57344
WL 11
M a[16:19], a[208:211], v[96:99], a[16:19]
v_fma_f32 v242, v242, s29, -v7
v_fma_f32 v243, v243, s29, -v7
v_exp_f32 v228, v228
M a[80:83], a[208:211], v[160:163], a[80:83]
v_exp_f32 v229, v229
v_exp_f32 v230, v230
v_exp_f32 v231, v231
T a[232:233], v26, 49152
T a[234:235], v26, 57344
WL 11
M a[20:23], a[212:215], v[96:99], a[20:23]
v_exp_f32 v232, v232
v_exp_f32 v233, v233
v_exp_f32 v234, v234
M a[84:87], a[212:215], v[160:163], a[84:87]
v_exp_f32 v235, v235
v_exp_f32 v236, v236
v_exp_f32 v237, v237
T a[236:237], v27, 49152
T a[238:239], v27, 57344
WL 10
M a[24:27], a[216:219], v[96:99], a[24:27]
v_exp_f32 v238, v238
v_exp_f32 v239, v239
v_exp_f32 v240, v240
M a[88:91], a[216:219], v[160:163], a[88:91]
v_exp_f32 v241, v241
v_exp_f32 v242, v242
v_exp_f32 v243, v243
T a[240:241], v28, 49152
T a[242:243], v28, 57344
WL 10
M a[28:31], a[220:223], v[96:99], a[28:31]
v_add_f32 v4, v4, v228
v_add_f32 v5, v5, v230
v_add_f32 v4, v4, v232
M a[92:95], a[220:223], v[160:163], a[92:95]
v_add_f32 v5, v5, v234
v_add_f32 v4, v4, v236
v_add_f32 v5, v5, v238
T a[244:245], v29, 49152
T a[246:247], v29, 57344
WL 10
M a[32:35], a[224:227], v[96:99], a[32:35]
v_add_f32 v4, v4, v240
v_add_f32 v5, v5, v242
v_add_f32 v4, v4, v229
M a[96:99], a[224:227], v[160:163], a[96:99]
v_add_f32 v5, v5, v231
v_add_f32 v4, v4, v233
v_add_f32 v5, v5, v235
T a[248:249], v30, 49152
T a[250:251], v30, 57344
WL 10
M a[36:39], a[228:231], v[96:99], a[36:39]
v_add_f32 v4, v4, v237
v_add_f32 v5, v5, v239
v_add_f32 v4, v4, v241
M a[100:103], a[228:231], v[160:163], a[100:103]
v_add_f32 v5, v5, v243
CV v100, v228, v229
CV v164, v230, v231
T a[252:253], v31, 49152
T a[254:255], v31, 57344
WL 10
M a[40:43], a[232:235], v[96:99], a[40:43]
CV v101, v232, v233
CV v165, v234, v235
CV v102, v236, v237
M a[104:107], a[232:235], v[160:163], a[104:107]
CV v166, v238, v239
CV v103, v240, v241
CV v167, v242, v243
s_waitcnt vmcnt(24)
s_barrier
v_add_u32 v16, 65536, v16
v_add_u32 v17, 65536, v17
v_add_u32 v18, 65536, v18
v_add_u32 v19, 65536, v19
v_add_u32 v20, 65536, v20
v_add_u32 v21, 65536, v21
v_add_u32 v22, 65536, v22
v_add_u32 v23, 65536, v23
v_add_u32 v24, 65536, v24
v_add_u32 v25, 65536, v25
v_add_u32 v26, 65536, v26
v_add_u32 v27, 65536, v27
v_add_u32 v28, 65536, v28
v_add_u32 v29, 65536, v29
v_add_u32 v30, 65536, v30
v_add_u32 v31, 65536, v31
T a[192:193], v16, 0
T a[194:195], v16, 8192
WL 10
M a[44:47], a[236:239], v[96:99], a[44:47]
M a[108:111], a[236:239], v[160:163], a[108:111]
T a[196:197], v17, 0
T a[198:199], v17, 8192
WL 10
M a[48:51], a[240:243], v[96:99], a[48:51]
M a[112:115], a[240:243], v[160:163], a[112:115]
T a[200:201], v18, 0
T a[202:203], v18, 8192
WL 10
M a[52:55], a[244:247], v[96:99], a[52:55]
M a[116:119], a[244:247], v[160:163], a[116:119]
T a[204:205], v19, 0
T a[206:207], v19, 8192
WL 10
M a[56:59], a[248:251], v[96:99], a[56:59]
M a[120:123], a[248:251], v[160:163], a[120:123]
T a[208:209], v20, 0
T a[210:211], v20, 8192
WL 10
M a[60:63], a[252:255], v[96:99], a[60:63]
M a[124:127], a[252:255], v[160:163], a[124:127]
T a[212:213], v21, 0
T a[214:215], v21, 8192
s_nop 1
WL 10
M a[0:3], a[192:195], v[100:103], a[0:3]
M a[64:67], a[192:195], v[164:167], a[64:67]
R v[212:215], v224, 10240
M a[128:131], a[192:195], v[216:219], a[128:131]
T a[216:217], v22, 0
T a[218:219], v22, 8192
WL 11
M a[4:7], a[196:199], v[100:103], a[4:7]
v_lshlrev_b32 v228, 16, v104
v_and_b32 v229, 0xffff0000, v104
v_lshlrev_b32 v230, 16, v168
M a[68:71], a[196:199], v[164:167], a[68:71]
v_and_b32 v231, 0xffff0000, v168
v_lshlrev_b32 v232, 16, v105
v_and_b32 v233, 0xffff0000, v105
M a[132:135], a[196:199], v[216:219], a[132:135]
v_lshlrev_b32 v234, 16, v169
v_and_b32 v235, 0xffff0000, v169
v_lshlrev_b32 v236, 16, v106
T a[220:221], v23, 0
T a[222:223], v23, 8192
WL 11
M a[8:11], a[200:203], v[100:103], a[8:11]
v_and_b32 v237, 0xffff0000, v106
v_lshlrev_b32 v238, 16, v170
v_and_b32 v239, 0xffff0000, v170
M a[72:75], a[200:203], v[164:167], a[72:75]
v_lshlrev_b32 v240, 16, v107
v_and_b32 v241, 0xffff0000, v107
v_lshlrev_b32 v242, 16, v171
M a[136:139], a[200:203], v[216:219], a[136:139]
v_and_b32 v243, 0xffff0000, v171
v_fma_f32 v228, v228, s29, -v6
v_fma_f32 v229, v229, s29, -v6
T a[224:225], v24, 0
T a[226:227], v24, 8192
WL 11
M a[12:15], a[204:207], v[100:103], a[12:15]
v_fma_f32 v230, v230, s29, -v7
v_fma_f32 v231, v231, s29, -v7
v_fma_f32 v232, v232, s29, -v6
M a[76:79], a[204:207], v[164:167], a[76:79]
v_fma_f32 v233, v233, s29, -v6
v_fma_f32 v234, v234, s29, -v7
v_fma_f32 v235, v235, s29, -v7
M a[140:143], a[204:207], v[216:219], a[140:143]
v_fma_f32 v236, v236, s29, -v6
v_fma_f32 v237, v237, s29, -v6
v_fma_f32 v238, v238, s29, -v7
M a[144:147], v[220:223], v[216:219], a[144:147]
v_fma_f32 v239, v239, s29, -v7
v_fma_f32 v240, v240, s29, -v6
v_fma_f32 v241, v241, s29, -v6
T a[228:229], v25, 0
T a[230:231], v25, 8192
WL 11
M a[16:19], a[208:211], v[100:103], a[16:19]
v_fma_f32 v242, v242, s29, -v7
v_fma_f32 v243, v243, s29, -v7
v_exp_f32 v228, v228
M a[80:83], a[208:211], v[164:167], a[80:83]
v_exp_f32 v229, v229
v_exp_f32 v230, v230
v_exp_f32 v231, v231
T a[232:233], v26, 0
T a[234:235], v26, 8192
WL 11
M a[20:23], a[212:215], v[100:103], a[20:23]
v_exp_f32 v232, v232
v_exp_f32 v233, v233
v_exp_f32 v234, v234
M a[84:87], a[212:215], v[164:167], a[84:87]
v_exp_f32 v235, v235
v_exp_f32 v236, v236
v_exp_f32 v237, v237
T a[236:237], v27, 0
T a[238:239], v27, 8192
WL 10
M a[24:27], a[216:219], v[100:103], a[24:27]
v_exp_f32 v238, v238
v_exp_f32 v239, v239
v_exp_f32 v240, v240
M a[88:91], a[216:219], v[164:167], a[88:91]
v_exp_f32 v241, v241
v_exp_f32 v242, v242
v_exp_f32 v243, v243
T a[240:241], v28, 0
T a[242:243], v28, 8192
WL 10
M a[28:31], a[220:223], v[100:103], a[28:31]
v_add_f32 v4, v4, v228
v_add_f32 v5, v5, v230
v_add_f32 v4, v4, v232
M a[92:95], a[220:223], v[164:167], a[92:95]
v_add_f32 v5, v5, v234
v_add_f32 v4, v4, v236
v_add_f32 v5, v5, v238
T a[244:245], v29, 0
T a[246:247], v29, 8192
WL 10
M a[32:35], a[224:227], v[100:103], a[32:35]
v_add_f32 v4, v4, v240
v_add_f32 v5, v5, v242
v_add_f32 v4, v4, v229
M a[96:99], a[224:227], v[164:167], a[96:99]
v_add_f32 v5, v5, v231
v_add_f32 v4, v4, v233
v_add_f32 v5, v5, v235
T a[248:249], v30, 0
T a[250:251], v30, 8192
WL 10
M a[36:39], a[228:231], v[100:103], a[36:39]
v_add_f32 v4, v4, v237
v_add_f32 v5, v5, v239
v_add_f32 v4, v4, v241
M a[100:103], a[228:231], v[164:167], a[100:103]
v_add_f32 v5, v5, v243
CV v104, v228, v229
CV v168, v230, v231
T a[252:253], v31, 0
T a[254:255], v31, 8192
WL 10
M a[40:43], a[232:235], v[100:103], a[40:43]
CV v105, v232, v233
CV v169, v234, v235
CV v106, v236, v237
M a[104:107], a[232:235], v[164:167], a[104:107]
CV v170, v238, v239
CV v107, v240, v241
CV v171, v242, v243
s_waitcnt vmcnt(20)
s_barrier
v_add_u32 v16, 4294836224, v16
v_add_u32 v17, 4294836224, v17
v_add_u32 v18, 4294836224, v18
v_add_u32 v19, 4294836224, v19
v_add_u32 v20, 4294836224, v20
v_add_u32 v21, 4294836224, v21
v_add_u32 v22, 4294836224, v22
v_add_u32 v23, 4294836224, v23
v_add_u32 v24, 4294836224, v24
v_add_u32 v25, 4294836224, v25
v_add_u32 v26, 4294836224, v26
v_add_u32 v27, 4294836224, v27
v_add_u32 v28, 4294836224, v28
v_add_u32 v29, 4294836224, v29
v_add_u32 v30, 4294836224, v30
v_add_u32 v31, 4294836224, v31
T a[192:193], v16, 16384
T a[194:195], v16, 24576
WL 10
M a[44:47], a[236:239], v[100:103], a[44:47]
M a[108:111], a[236:239], v[164:167], a[108:111]
T a[196:197], v17, 16384
T a[198:199], v17, 24576
WL 10
M a[48:51], a[240:243], v[100:103], a[48:51]
M a[112:115], a[240:243], v[164:167], a[112:115]
T a[200:201], v18, 16384
T a[202:203], v18, 24576
WL 10
M a[52:55], a[244:247], v[100:103], a[52:55]
M a[116:119], a[244:247], v[164:167], a[116:119]
T a[204:205], v19, 16384
T a[206:207], v19, 24576
WL 10
M a[56:59], a[248:251], v[100:103], a[56:59]
M a[120:123], a[248:251], v[164:167], a[120:123]
T a[208:209], v20, 16384
T a[210:211], v20, 24576
WL 10
M a[60:63], a[252:255], v[100:103], a[60:63]
M a[124:127], a[252:255], v[164:167], a[124:127]
T a[212:213], v21, 16384
T a[214:215], v21, 24576
s_nop 1
WL 10
M a[0:3], a[192:195], v[104:107], a[0:3]
M a[64:67], a[192:195], v[168:171], a[64:67]
R v[216:219], v224, 11264
M a[128:131], a[192:195], v[212:215], a[128:131]
T a[216:217], v22, 16384
T a[218:219], v22, 24576
WL 11
M a[4:7], a[196:199], v[104:107], a[4:7]
v_lshlrev_b32 v228, 16, v108
v_and_b32 v229, 0xffff0000, v108
v_lshlrev_b32 v230, 16, v172
M a[68:71], a[196:199], v[168:171], a[68:71]
v_and_b32 v231, 0xffff0000, v172
v_lshlrev_b32 v232, 16, v109
v_and_b32 v233, 0xffff0000, v109
M a[132:135], a[196:199], v[212:215], a[132:135]
v_lshlrev_b32 v234, 16, v173
v_and_b32 v235, 0xffff0000, v173
v_lshlrev_b32 v236, 16, v110
T a[220:221], v23, 16384
T a[222:223], v23, 24576
WL 11
M a[8:11], a[200:203], v[104:107], a[8:11]
v_and_b32 v237, 0xffff0000, v110
v_lshlrev_b32 v238, 16, v174
v_and_b32 v239, 0xffff0000, v174
M a[72:75], a[200:203], v[168:171], a[72:75]
v_lshlrev_b32 v240, 16, v111
v_and_b32 v241, 0xffff0000, v111
v_lshlrev_b32 v242, 16, v175
M a[136:139], a[200:203], v[212:215], a[136:139]
v_and_b32 v243, 0xffff0000, v175
v_fma_f32 v228, v228, s29, -v6
v_fma_f32 v229, v229, s29, -v6
T a[224:225], v24, 16384
T a[226:227], v24, 24576
WL 11
M a[12:15], a[204:207], v[104:107], a[12:15]
v_fma_f32 v230, v230, s29, -v7
v_fma_f32 v231, v231, s29, -v7
v_fma_f32 v232, v232, s29, -v6
M a[76:79], a[204:207], v[168:171], a[76:79]
v_fma_f32 v233, v233, s29, -v6
v_fma_f32 v234, v234, s29, -v7
v_fma_f32 v235, v235, s29, -v7
M a[140:143], a[204:207], v[212:215], a[140:143]
v_fma_f32 v236, v236, s29, -v6
v_fma_f32 v237, v237, s29, -v6
v_fma_f32 v238, v238, s29, -v7
M a[144:147], v[220:223], v[212:215], a[144:147]
v_fma_f32 v239, v239, s29, -v7
v_fma_f32 v240, v240, s29, -v6
v_fma_f32 v241, v241, s29, -v6
T a[228:229], v25, 16384
T a[230:231], v25, 24576
WL 11
M a[16:19], a[208:211], v[104:107], a[16:19]
v_fma_f32 v242, v242, s29, -v7
v_fma_f32 v243, v243, s29, -v7
v_exp_f32 v228, v228
M a[80:83], a[208:211], v[168:171], a[80:83]
v_exp_f32 v229, v229
v_exp_f32 v230, v230
v_exp_f32 v231, v231
T a[232:233], v26, 16384
T a[234:235], v26, 24576
WL 11
M a[20:23], a[212:215], v[104:107], a[20:23]
v_exp_f32 v232, v232
v_exp_f32 v233, v233
v_exp_f32 v234, v234
M a[84:87], a[212:215], v[168:171], a[84:87]
v_exp_f32 v235, v235
v_exp_f32 v236, v236
v_exp_f32 v237, v237
T a[236:237], v27, 16384
T a[238:239], v27, 24576
WL 10
M a[24:27], a[216:219], v[104:107], a[24:27]
v_exp_f32 v238, v238
v_exp_f32 v239, v239
v_exp_f32 v240, v240
M a[88:91], a[216:219], v[168:171], a[88:91]
v_exp_f32 v241, v241
v_exp_f32 v242, v242
v_exp_f32 v243, v243
T a[240:241], v28, 16384
T a[242:243], v28, 24576
WL 10
M a[28:31], a[220:223], v[104:107], a[28:31]
v_add_f32 v4, v4, v228
v_add_f32 v5, v5, v230
v_add_f32 v4, v4, v232
M a[92:95], a[220:223], v[168:171], a[92:95]
v_add_f32 v5, v5, v234
v_add_f32 v4, v4, v236
v_add_f32 v5, v5, v238
T a[244:245], v29, 16384
T a[246:247], v29, 24576
WL 10
M a[32:35], a[224:227], v[104:107], a[32:35]
v_add_f32 v4, v4, v240
v_add_f32 v5, v5, v242
v_add_f32 v4, v4, v229
M a[96:99], a[224:227], v[168:171], a[96:99]
v_add_f32 v5, v5, v231
v_add_f32 v4, v4, v233
v_add_f32 v5, v5, v235
T a[248:249], v30, 16384
T a[250:251], v30, 24576
WL 10
M a[36:39], a[228:231], v[104:107], a[36:39]
v_add_f32 v4, v4, v237
v_add_f32 v5, v5, v239
v_add_f32 v4, v4, v241
M a[100:103], a[228:231], v[168:171], a[100:103]
v_add_f32 v5, v5, v243
CV v108, v228, v229
CV v172, v230, v231
T a[252:253], v31, 16384
T a[254:255], v31, 24576
WL 10
M a[40:43], a[232:235], v[104:107], a[40:43]
CV v109, v232, v233
CV v173, v234, v235
CV v110, v236, v237
M a[104:107], a[232:235], v[168:171], a[104:107]
CV v174, v238, v239
CV v111, v240, v241
CV v175, v242, v243
s_waitcnt vmcnt(16)
s_barrier
v_add_u32 v16, 65536, v16
v_add_u32 v17, 65536, v17
v_add_u32 v18, 65536, v18
v_add_u32 v19, 65536, v19
v_add_u32 v20, 65536, v20
v_add_u32 v21, 65536, v21
v_add_u32 v22, 65536, v22
v_add_u32 v23, 65536, v23
v_add_u32 v24, 65536, v24
v_add_u32 v25, 65536, v25
v_add_u32 v26, 65536, v26
v_add_u32 v27, 65536, v27
v_add_u32 v28, 65536, v28
v_add_u32 v29, 65536, v29
v_add_u32 v30, 65536, v30
v_add_u32 v31, 65536, v31
T a[192:193], v16, 0
T a[194:195], v16, 8192
WL 10
M a[44:47], a[236:239], v[104:107], a[44:47]
M a[108:111], a[236:239], v[168:171], a[108:111]
T a[196:197], v17, 0
T a[198:199], v17, 8192
WL 10
M a[48:51], a[240:243], v[104:107], a[48:51]
M a[112:115], a[240:243], v[168:171], a[112:115]
T a[200:201], v18, 0
T a[202:203], v18, 8192
WL 10
M a[52:55], a[244:247], v[104:107], a[52:55]
M a[116:119], a[244:247], v[168:171], a[116:119]
T a[204:205], v19, 0
T a[206:207], v19, 8192
WL 10
M a[56:59], a[248:251], v[104:107], a[56:59]
M a[120:123], a[248:251], v[168:171], a[120:123]
T a[208:209], v20, 0
T a[210:211], v20, 8192
WL 10
M a[60:63], a[252:255], v[104:107], a[60:63]
M a[124:127], a[252:255], v[168:171], a[124:127]
T a[212:213], v21, 0
T a[214:215], v21, 8192
s_nop 1
WL 10
M a[0:3], a[192:195], v[108:111], a[0:3]
M a[64:67], a[192:195], v[172:175], a[64:67]
R v[212:215], v224, 12288
M a[128:131], a[192:195], v[216:219], a[128:131]
T a[216:217], v22, 0
T a[218:219], v22, 8192
WL 11
M a[4:7], a[196:199], v[108:111], a[4:7]
v_lshlrev_b32 v228, 16, v112
v_and_b32 v229, 0xffff0000, v112
v_lshlrev_b32 v230, 16, v176
M a[68:71], a[196:199], v[172:175], a[68:71]
v_and_b32 v231, 0xffff0000, v176
v_lshlrev_b32 v232, 16, v113
v_and_b32 v233, 0xffff0000, v113
M a[132:135], a[196:199], v[216:219], a[132:135]
v_lshlrev_b32 v234, 16, v177
v_and_b32 v235, 0xffff0000, v177
v_lshlrev_b32 v236, 16, v114
T a[220:221], v23, 0
T a[222:223], v23, 8192
WL 11
M a[8:11], a[200:203], v[108:111], a[8:11]
v_and_b32 v237, 0xffff0000, v114
v_lshlrev_b32 v238, 16, v178
v_and_b32 v239, 0xffff0000, v178
M a[72:75], a[200:203], v[172:175], a[72:75]
v_lshlrev_b32 v240, 16, v115
v_and_b32 v241, 0xffff0000, v115
v_lshlrev_b32 v242, 16, v179
M a[136:139], a[200:203], v[216:219], a[136:139]
v_and_b32 v243, 0xffff0000, v179
v_fma_f32 v228, v228, s29, -v6
v_fma_f32 v229, v229, s29, -v6
T a[224:225], v24, 0
T a[226:227], v24, 8192
WL 11
M a[12:15], a[204:207], v[108:111], a[12:15]
v_fma_f32 v230, v230, s29, -v7
v_fma_f32 v231, v231, s29, -v7
v_fma_f32 v232, v232, s29, -v6
M a[76:79], a[204:207], v[172:175], a[76:79]
v_fma_f32 v233, v233, s29, -v6
v_fma_f32 v234, v234, s29, -v7
v_fma_f32 v235, v235, s29, -v7
M a[140:143], a[204:207], v[216:219], a[140:143]
v_fma_f32 v236, v236, s29, -v6
v_fma_f32 v237, v237, s29, -v6
v_fma_f32 v238, v238, s29, -v7
M a[144:147], v[220:223], v[216:219], a[144:147]
v_fma_f32 v239, v239, s29, -v7
v_fma_f32 v240, v240, s29, -v6
v_fma_f32 v241, v241, s29, -v6
T a[228:229], v25, 0
T a[230:231], v25, 8192
WL 11
M a[16:19], a[208:211], v[108:111], a[16:19]
v_fma_f32 v242, v242, s29, -v7
v_fma_f32 v243, v243, s29, -v7
v_exp_f32 v228, v228
M a[80:83], a[208:211], v[172:175], a[80:83]
v_exp_f32 v229, v229
v_exp_f32 v230, v230
v_exp_f32 v231, v231
T a[232:233], v26, 0
T a[234:235], v26, 8192
WL 11
M a[20:23], a[212:215], v[108:111], a[20:23]
v_exp_f32 v232, v232
v_exp_f32 v233, v233
v_exp_f32 v234, v234
M a[84:87], a[212:215], v[172:175], a[84:87]
v_exp_f32 v235, v235
v_exp_f32 v236, v236
v_exp_f32 v237, v237
T a[236:237], v27, 0
T a[238:239], v27, 8192
WL 10
M a[24:27], a[216:219], v[108:111], a[24:27]
v_exp_f32 v238, v238
v_exp_f32 v239, v239
v_exp_f32 v240, v240
M a[88:91], a[216:219], v[172:175], a[88:91]
v_exp_f32 v241, v241
v_exp_f32 v242, v242
v_exp_f32 v243, v243
T a[240:241], v28, 0
T a[242:243], v28, 8192
WL 10
M a[28:31], a[220:223], v[108:111], a[28:31]
v_add_f32 v4, v4, v228
v_add_f32 v5, v5, v230
v_add_f32 v4, v4, v232
M a[92:95], a[220:223], v[172:175], a[92:95]
v_add_f32 v5, v5, v234
v_add_f32 v4, v4, v236
v_add_f32 v5, v5, v238
T a[244:245], v29, 0
T a[246:247], v29, 8192
WL 10
M a[32:35], a[224:227], v[108:111], a[32:35]
v_add_f32 v4, v4, v240
v_add_f32 v5, v5, v242
v_add_f32 v4, v4, v229
M a[96:99], a[224:227], v[172:175], a[96:99]
v_add_f32 v5, v5, v231
v_add_f32 v4, v4, v233
v_add_f32 v5, v5, v235
T a[248:249], v30, 0
T a[250:251], v30, 8192
WL 10
M a[36:39], a[228:231], v[108:111], a[36:39]
v_add_f32 v4, v4, v237
v_add_f32 v5, v5, v239
v_add_f32 v4, v4, v241
M a[100:103], a[228:231], v[172:175], a[100:103]
v_add_f32 v5, v5, v243
CV v112, v228, v229
CV v176, v230, v231
T a[252:253], v31, 0
T a[254:255], v31, 8192
WL 10
M a[40:43], a[232:235], v[108:111], a[40:43]
CV v113, v232, v233
CV v177, v234, v235
CV v114, v236, v237
M a[104:107], a[232:235], v[172:175], a[104:107]
CV v178, v238, v239
CV v115, v240, v241
CV v179, v242, v243
s_waitcnt vmcnt(12)
s_barrier
T a[192:193], v16, 16384
T a[194:195], v16, 24576
WL 10
M a[44:47], a[236:239], v[108:111], a[44:47]
M a[108:111], a[236:239], v[172:175], a[108:111]
T a[196:197], v17, 16384
T a[198:199], v17, 24576
WL 10
M a[48:51], a[240:243], v[108:111], a[48:51]
M a[112:115], a[240:243], v[172:175], a[112:115]
T a[200:201], v18, 16384
T a[202:203], v18, 24576
WL 10
M a[52:55], a[244:247], v[108:111], a[52:55]
M a[116:119], a[244:247], v[172:175], a[116:119]
T a[204:205], v19, 16384
T a[206:207], v19, 24576
WL 10
M a[56:59], a[248:251], v[108:111], a[56:59]
M a[120:123], a[248:251], v[172:175], a[120:123]
T a[208:209], v20, 16384
T a[210:211], v20, 24576
WL 10
M a[60:63], a[252:255], v[108:111], a[60:63]
M a[124:127], a[252:255], v[172:175], a[124:127]
T a[212:213], v21, 16384
T a[214:215], v21, 24576
s_nop 1
WL 10
M a[0:3], a[192:195], v[112:115], a[0:3]
M a[64:67], a[192:195], v[176:179], a[64:67]
R v[216:219], v224, 13312
M a[128:131], a[192:195], v[212:215], a[128:131]
T a[216:217], v22, 16384
T a[218:219], v22, 24576
WL 11
M a[4:7], a[196:199], v[112:115], a[4:7]
v_lshlrev_b32 v228, 16, v116
v_and_b32 v229, 0xffff0000, v116
v_lshlrev_b32 v230, 16, v180
M a[68:71], a[196:199], v[176:179], a[68:71]
v_and_b32 v231, 0xffff0000, v180
v_lshlrev_b32 v232, 16, v117
v_and_b32 v233, 0xffff0000, v117
M a[132:135], a[196:199], v[212:215], a[132:135]
v_lshlrev_b32 v234, 16, v181
v_and_b32 v235, 0xffff0000, v181
v_lshlrev_b32 v236, 16, v118
T a[220:221], v23, 16384
T a[222:223], v23, 24576
WL 11
M a[8:11], a[200:203], v[112:115], a[8:11]
v_and_b32 v237, 0xffff0000, v118
v_lshlrev_b32 v238, 16, v182
v_and_b32 v239, 0xffff0000, v182
M a[72:75], a[200:203], v[176:179], a[72:75]
v_lshlrev_b32 v240, 16, v119
v_and_b32 v241, 0xffff0000, v119
v_lshlrev_b32 v242, 16, v183
M a[136:139], a[200:203], v[212:215], a[136:139]
v_and_b32 v243, 0xffff0000, v183
v_fma_f32 v228, v228, s29, -v6
v_fma_f32 v229, v229, s29, -v6
T a[224:225], v24, 16384
T a[226:227], v24, 24576
WL 11
M a[12:15], a[204:207], v[112:115], a[12:15]
v_fma_f32 v230, v230, s29, -v7
v_fma_f32 v231, v231, s29, -v7
v_fma_f32 v232, v232, s29, -v6
M a[76:79], a[204:207], v[176:179], a[76:79]
v_fma_f32 v233, v233, s29, -v6
v_fma_f32 v234, v234, s29, -v7
v_fma_f32 v235, v235, s29, -v7
M a[140:143], a[204:207], v[212:215], a[140:143]
v_fma_f32 v236, v236, s29, -v6
v_fma_f32 v237, v237, s29, -v6
v_fma_f32 v238, v238, s29, -v7
M a[144:147], v[220:223], v[212:215], a[144:147]
v_fma_f32 v239, v239, s29, -v7
v_fma_f32 v240, v240, s29, -v6
v_fma_f32 v241, v241, s29, -v6
T a[228:229], v25, 16384
T a[230:231], v25, 24576
WL 11
M a[16:19], a[208:211], v[112:115], a[16:19]
v_fma_f32 v242, v242, s29, -v7
v_fma_f32 v243, v243, s29, -v7
v_exp_f32 v228, v228
M a[80:83], a[208:211], v[176:179], a[80:83]
v_exp_f32 v229, v229
v_exp_f32 v230, v230
v_exp_f32 v231, v231
T a[232:233], v26, 16384
T a[234:235], v26, 24576
WL 11
M a[20:23], a[212:215], v[112:115], a[20:23]
v_exp_f32 v232, v232
v_exp_f32 v233, v233
v_exp_f32 v234, v234
M a[84:87], a[212:215], v[176:179], a[84:87]
v_exp_f32 v235, v235
v_exp_f32 v236, v236
v_exp_f32 v237, v237
T a[236:237], v27, 16384
T a[238:239], v27, 24576
WL 10
M a[24:27], a[216:219], v[112:115], a[24:27]
v_exp_f32 v238, v238
v_exp_f32 v239, v239
v_exp_f32 v240, v240
M a[88:91], a[216:219], v[176:179], a[88:91]
v_exp_f32 v241, v241
v_exp_f32 v242, v242
v_exp_f32 v243, v243
T a[240:241], v28, 16384
T a[242:243], v28, 24576
WL 10
M a[28:31], a[220:223], v[112:115], a[28:31]
v_add_f32 v4, v4, v228
v_add_f32 v5, v5, v230
v_add_f32 v4, v4, v232
M a[92:95], a[220:223], v[176:179], a[92:95]
v_add_f32 v5, v5, v234
v_add_f32 v4, v4, v236
v_add_f32 v5, v5, v238
T a[244:245], v29, 16384
T a[246:247], v29, 24576
WL 10
M a[32:35], a[224:227], v[112:115], a[32:35]
v_add_f32 v4, v4, v240
v_add_f32 v5, v5, v242
v_add_f32 v4, v4, v229
M a[96:99], a[224:227], v[176:179], a[96:99]
v_add_f32 v5, v5, v231
v_add_f32 v4, v4, v233
v_add_f32 v5, v5, v235
T a[248:249], v30, 16384
T a[250:251], v30, 24576
WL 10
M a[36:39], a[228:231], v[112:115], a[36:39]
v_add_f32 v4, v4, v237
v_add_f32 v5, v5, v239
v_add_f32 v4, v4, v241
M a[100:103], a[228:231], v[176:179], a[100:103]
v_add_f32 v5, v5, v243
CV v116, v228, v229
CV v180, v230, v231
T a[252:253], v31, 16384
T a[254:255], v31, 24576
WL 10
M a[40:43], a[232:235], v[112:115], a[40:43]
CV v117, v232, v233
CV v181, v234, v235
CV v118, v236, v237
M a[104:107], a[232:235], v[176:179], a[104:107]
CV v182, v238, v239
CV v119, v240, v241
CV v183, v242, v243
s_waitcnt vmcnt(8)
s_barrier
T a[192:193], v16, 32768
T a[194:195], v16, 40960
WL 10
M a[44:47], a[236:239], v[112:115], a[44:47]
M a[108:111], a[236:239], v[176:179], a[108:111]
T a[196:197], v17, 32768
T a[198:199], v17, 40960
WL 10
M a[48:51], a[240:243], v[112:115], a[48:51]
M a[112:115], a[240:243], v[176:179], a[112:115]
T a[200:201], v18, 32768
T a[202:203], v18, 40960
WL 10
M a[52:55], a[244:247], v[112:115], a[52:55]
M a[116:119], a[244:247], v[176:179], a[116:119]
T a[204:205], v19, 32768
T a[206:207], v19, 40960
WL 10
M a[56:59], a[248:251], v[112:115], a[56:59]
M a[120:123], a[248:251], v[176:179], a[120:123]
T a[208:209], v20, 32768
T a[210:211], v20, 40960
WL 10
M a[60:63], a[252:255], v[112:115], a[60:63]
M a[124:127], a[252:255], v[176:179], a[124:127]
T a[212:213], v21, 32768
T a[214:215], v21, 40960
s_nop 1
WL 10
M a[0:3], a[192:195], v[116:119], a[0:3]
M a[64:67], a[192:195], v[180:183], a[64:67]
R v[212:215], v224, 14336
M a[128:131], a[192:195], v[216:219], a[128:131]
T a[216:217], v22, 32768
T a[218:219], v22, 40960
WL 11
M a[4:7], a[196:199], v[116:119], a[4:7]
v_lshlrev_b32 v228, 16, v120
v_and_b32 v229, 0xffff0000, v120
v_lshlrev_b32 v230, 16, v184
M a[68:71], a[196:199], v[180:183], a[68:71]
v_and_b32 v231, 0xffff0000, v184
v_lshlrev_b32 v232, 16, v121
v_and_b32 v233, 0xffff0000, v121
M a[132:135], a[196:199], v[216:219], a[132:135]
v_lshlrev_b32 v234, 16, v185
v_and_b32 v235, 0xffff0000, v185
v_lshlrev_b32 v236, 16, v122
T a[220:221], v23, 32768
T a[222:223], v23, 40960
WL 11
M a[8:11], a[200:203], v[116:119], a[8:11]
v_and_b32 v237, 0xffff0000, v122
v_lshlrev_b32 v238, 16, v186
v_and_b32 v239, 0xffff0000, v186
M a[72:75], a[200:203], v[180:183], a[72:75]
v_lshlrev_b32 v240, 16, v123
v_and_b32 v241, 0xffff0000, v123
v_lshlrev_b32 v242, 16, v187
M a[136:139], a[200:203], v[216:219], a[136:139]
v_and_b32 v243, 0xffff0000, v187
v_fma_f32 v228, v228, s29, -v6
v_fma_f32 v229, v229, s29, -v6
T a[224:225], v24, 32768
T a[226:227], v24, 40960
WL 11
M a[12:15], a[204:207], v[116:119], a[12:15]
v_fma_f32 v230, v230, s29, -v7
v_fma_f32 v231, v231, s29, -v7
v_fma_f32 v232, v232, s29, -v6
M a[76:79], a[204:207], v[180:183], a[76:79]
v_fma_f32 v233, v233, s29, -v6
v_fma_f32 v234, v234, s29, -v7
v_fma_f32 v235, v235, s29, -v7
M a[140:143], a[204:207], v[216:219], a[140:143]
v_fma_f32 v236, v236, s29, -v6
v_fma_f32 v237, v237, s29, -v6
v_fma_f32 v238, v238, s29, -v7
M a[144:147], v[220:223], v[216:219], a[144:147]
v_fma_f32 v239, v239, s29, -v7
v_fma_f32 v240, v240, s29, -v6
v_fma_f32 v241, v241, s29, -v6
T a[228:229], v25, 32768
T a[230:231], v25, 40960
WL 11
M a[16:19], a[208:211], v[116:119], a[16:19]
v_fma_f32 v242, v242, s29, -v7
v_fma_f32 v243, v243, s29, -v7
v_exp_f32 v228, v228
M a[80:83], a[208:211], v[180:183], a[80:83]
v_exp_f32 v229, v229
v_exp_f32 v230, v230
v_exp_f32 v231, v231
T a[232:233], v26, 32768
T a[234:235], v26, 40960
WL 11
M a[20:23], a[212:215], v[116:119], a[20:23]
v_exp_f32 v232, v232
v_exp_f32 v233, v233
v_exp_f32 v234, v234
M a[84:87], a[212:215], v[180:183], a[84:87]
v_exp_f32 v235, v235
v_exp_f32 v236, v236
v_exp_f32 v237, v237
T a[236:237], v27, 32768
T a[238:239], v27, 40960
WL 10
M a[24:27], a[216:219], v[116:119], a[24:27]
v_exp_f32 v238, v238
v_exp_f32 v239, v239
v_exp_f32 v240, v240
M a[88:91], a[216:219], v[180:183], a[88:91]
v_exp_f32 v241, v241
v_exp_f32 v242, v242
v_exp_f32 v243, v243
T a[240:241], v28, 32768
T a[242:243], v28, 40960
WL 10
M a[28:31], a[220:223], v[116:119], a[28:31]
v_add_f32 v4, v4, v228
v_add_f32 v5, v5, v230
v_add_f32 v4, v4, v232
M a[92:95], a[220:223], v[180:183], a[92:95]
v_add_f32 v5, v5, v234
v_add_f32 v4, v4, v236
v_add_f32 v5, v5, v238
T a[244:245], v29, 32768
T a[246:247], v29, 40960
WL 10
M a[32:35], a[224:227], v[116:119], a[32:35]
v_add_f32 v4, v4, v240
v_add_f32 v5, v5, v242
v_add_f32 v4, v4, v229
M a[96:99], a[224:227], v[180:183], a[96:99]
v_add_f32 v5, v5, v231
v_add_f32 v4, v4, v233
v_add_f32 v5, v5, v235
T a[248:249], v30, 32768
T a[250:251], v30, 40960
WL 10
M a[36:39], a[228:231], v[116:119], a[36:39]
v_add_f32 v4, v4, v237
v_add_f32 v5, v5, v239
v_add_f32 v4, v4, v241
M a[100:103], a[228:231], v[180:183], a[100:103]
v_add_f32 v5, v5, v243
CV v120, v228, v229
CV v184, v230, v231
T a[252:253], v31, 32768
T a[254:255], v31, 40960
WL 10
M a[40:43], a[232:235], v[116:119], a[40:43]
CV v121, v232, v233
CV v185, v234, v235
CV v122, v236, v237
M a[104:107], a[232:235], v[180:183], a[104:107]
CV v186, v238, v239
CV v123, v240, v241
CV v187, v242, v243
s_waitcnt vmcnt(4)
s_barrier
v_add_u32 v16, 4294901760, v16
v_add_u32 v17, 4294901760, v17
v_add_u32 v18, 4294901760, v18
v_add_u32 v19, 4294901760, v19
v_add_u32 v20, 4294901760, v20
v_add_u32 v21, 4294901760, v21
v_add_u32 v22, 4294901760, v22
v_add_u32 v23, 4294901760, v23
v_add_u32 v24, 4294901760, v24
v_add_u32 v25, 4294901760, v25
v_add_u32 v26, 4294901760, v26
v_add_u32 v27, 4294901760, v27
v_add_u32 v28, 4294901760, v28
v_add_u32 v29, 4294901760, v29
v_add_u32 v30, 4294901760, v30
v_add_u32 v31, 4294901760, v31
T a[192:193], v16, 32768
T a[194:195], v16, 40960
WL 10
M a[44:47], a[236:239], v[116:119], a[44:47]
M a[108:111], a[236:239], v[180:183], a[108:111]
T a[196:197], v17, 32768
T a[198:199], v17, 40960
WL 10
M a[48:51], a[240:243], v[116:119], a[48:51]
M a[112:115], a[240:243], v[180:183], a[112:115]
T a[200:201], v18, 32768
T a[202:203], v18, 40960
WL 10
M a[52:55], a[244:247], v[116:119], a[52:55]
M a[116:119], a[244:247], v[180:183], a[116:119]
T a[204:205], v19, 32768
T a[206:207], v19, 40960
WL 10
M a[56:59], a[248:251], v[116:119], a[56:59]
M a[120:123], a[248:251], v[180:183], a[120:123]
T a[208:209], v20, 32768
T a[210:211], v20, 40960
WL 10
M a[60:63], a[252:255], v[116:119], a[60:63]
M a[124:127], a[252:255], v[180:183], a[124:127]
T a[212:213], v21, 32768
T a[214:215], v21, 40960
s_nop 1
WL 10
M a[0:3], a[192:195], v[120:123], a[0:3]
M a[64:67], a[192:195], v[184:187], a[64:67]
R v[216:219], v224, 15360
M a[128:131], a[192:195], v[212:215], a[128:131]
T a[216:217], v22, 32768
T a[218:219], v22, 40960
WL 11
M a[4:7], a[196:199], v[120:123], a[4:7]
v_lshlrev_b32 v228, 16, v124
v_and_b32 v229, 0xffff0000, v124
v_lshlrev_b32 v230, 16, v188
M a[68:71], a[196:199], v[184:187], a[68:71]
v_and_b32 v231, 0xffff0000, v188
v_lshlrev_b32 v232, 16, v125
v_and_b32 v233, 0xffff0000, v125
M a[132:135], a[196:199], v[212:215], a[132:135]
v_lshlrev_b32 v234, 16, v189
v_and_b32 v235, 0xffff0000, v189
v_lshlrev_b32 v236, 16, v126
T a[220:221], v23, 32768
T a[222:223], v23, 40960
WL 11
M a[8:11], a[200:203], v[120:123], a[8:11]
v_and_b32 v237, 0xffff0000, v126
v_lshlrev_b32 v238, 16, v190
v_and_b32 v239, 0xffff0000, v190
M a[72:75], a[200:203], v[184:187], a[72:75]
v_lshlrev_b32 v240, 16, v127
v_and_b32 v241, 0xffff0000, v127
v_lshlrev_b32 v242, 16, v191
M a[136:139], a[200:203], v[212:215], a[136:139]
v_and_b32 v243, 0xffff0000, v191
v_fma_f32 v228, v228, s29, -v6
v_fma_f32 v229, v229, s29, -v6
T a[224:225], v24, 32768
T a[226:227], v24, 40960
WL 11
M a[12:15], a[204:207], v[120:123], a[12:15]
v_fma_f32 v230, v230, s29, -v7
v_fma_f32 v231, v231, s29, -v7
v_fma_f32 v232, v232, s29, -v6
M a[76:79], a[204:207], v[184:187], a[76:79]
v_fma_f32 v233, v233, s29, -v6
v_fma_f32 v234, v234, s29, -v7
v_fma_f32 v235, v235, s29, -v7
M a[140:143], a[204:207], v[212:215], a[140:143]
v_fma_f32 v236, v236, s29, -v6
v_fma_f32 v237, v237, s29, -v6
v_fma_f32 v238, v238, s29, -v7
M a[144:147], v[220:223], v[212:215], a[144:147]
v_fma_f32 v239, v239, s29, -v7
v_fma_f32 v240, v240, s29, -v6
v_fma_f32 v241, v241, s29, -v6
T a[228:229], v25, 32768
T a[230:231], v25, 40960
WL 11
M a[16:19], a[208:211], v[120:123], a[16:19]
v_fma_f32 v242, v242, s29, -v7
v_fma_f32 v243, v243, s29, -v7
v_exp_f32 v228, v228
M a[80:83], a[208:211], v[184:187], a[80:83]
v_exp_f32 v229, v229
v_exp_f32 v230, v230
v_exp_f32 v231, v231
T a[232:233], v26, 32768
T a[234:235], v26, 40960
WL 11
M a[20:23], a[212:215], v[120:123], a[20:23]
v_exp_f32 v232, v232
v_exp_f32 v233, v233
v_exp_f32 v234, v234
M a[84:87], a[212:215], v[184:187], a[84:87]
v_exp_f32 v235, v235
v_exp_f32 v236, v236
v_exp_f32 v237, v237
T a[236:237], v27, 32768
T a[238:239], v27, 40960
WL 10
M a[24:27], a[216:219], v[120:123], a[24:27]
v_exp_f32 v238, v238
v_exp_f32 v239, v239
v_exp_f32 v240, v240
M a[88:91], a[216:219], v[184:187], a[88:91]
v_exp_f32 v241, v241
v_exp_f32 v242, v242
v_exp_f32 v243, v243
T a[240:241], v28, 32768
T a[242:243], v28, 40960
WL 10
M a[28:31], a[220:223], v[120:123], a[28:31]
v_add_f32 v4, v4, v228
v_add_f32 v5, v5, v230
v_add_f32 v4, v4, v232
M a[92:95], a[220:223], v[184:187], a[92:95]
v_add_f32 v5, v5, v234
v_add_f32 v4, v4, v236
v_add_f32 v5, v5, v238
T a[244:245], v29, 32768
T a[246:247], v29, 40960
WL 10
M a[32:35], a[224:227], v[120:123], a[32:35]
v_add_f32 v4, v4, v240
v_add_f32 v5, v5, v242
v_add_f32 v4, v4, v229
M a[96:99], a[224:227], v[184:187], a[96:99]
v_add_f32 v5, v5, v231
v_add_f32 v4, v4, v233
v_add_f32 v5, v5, v235
T a[248:249], v30, 32768
T a[250:251], v30, 40960
WL 10
M a[36:39], a[228:231], v[120:123], a[36:39]
v_add_f32 v4, v4, v237
v_add_f32 v5, v5, v239
v_add_f32 v4, v4, v241
M a[100:103], a[228:231], v[184:187], a[100:103]
v_add_f32 v5, v5, v243
CV v124, v228, v229
CV v188, v230, v231
T a[252:253], v31, 32768
T a[254:255], v31, 40960
WL 10
M a[40:43], a[232:235], v[120:123], a[40:43]
CV v125, v232, v233
CV v189, v234, v235
CV v126, v236, v237
M a[104:107], a[232:235], v[184:187], a[104:107]
CV v190, v238, v239
CV v127, v240, v241
CV v191, v242, v243
s_waitcnt vmcnt(0)
s_barrier
T a[192:193], v16, 49152
T a[194:195], v16, 57344
WL 10
M a[44:47], a[236:239], v[120:123], a[44:47]
M a[108:111], a[236:239], v[184:187], a[108:111]
T a[196:197], v17, 49152
T a[198:199], v17, 57344
WL 10
M a[48:51], a[240:243], v[120:123], a[48:51]
M a[112:115], a[240:243], v[184:187], a[112:115]
T a[200:201], v18, 49152
T a[202:203], v18, 57344
WL 10
M a[52:55], a[244:247], v[120:123], a[52:55]
M a[116:119], a[244:247], v[184:187], a[116:119]
T a[204:205], v19, 49152
T a[206:207], v19, 57344
WL 10
M a[56:59], a[248:251], v[120:123], a[56:59]
M a[120:123], a[248:251], v[184:187], a[120:123]
T a[208:209], v20, 49152
T a[210:211], v20, 57344
WL 10
M a[60:63], a[252:255], v[120:123], a[60:63]
M a[124:127], a[252:255], v[184:187], a[124:127]
T a[212:213], v21, 49152
T a[214:215], v21, 57344
s_nop 1
WL 10
M a[0:3], a[192:195], v[124:127], a[0:3]
M a[64:67], a[192:195], v[188:191], a[64:67]
M a[128:131], a[192:195], v[216:219], a[128:131]
T a[216:217], v22, 49152
T a[218:219], v22, 57344
WL 10
M a[4:7], a[196:199], v[124:127], a[4:7]
v_mov_b32 v50, v4
v_mov_b32 v51, v5
s_nop 1
M a[68:71], a[196:199], v[188:191], a[68:71]
v_permlane32_swap_b32 v50, v4
v_permlane32_swap_b32 v51, v5
s_nop 0
M a[132:135], a[196:199], v[216:219], a[132:135]
v_add_f32 v4, v4, v50
v_add_f32 v5, v5, v51
v_mov_b32 v50, v4
T a[220:221], v23, 49152
T a[222:223], v23, 57344
WL 10
M a[8:11], a[200:203], v[124:127], a[8:11]
v_mov_b32 v51, v5
s_nop 1
v_permlane16_swap_b32 v50, v4
M a[72:75], a[200:203], v[188:191], a[72:75]
v_permlane16_swap_b32 v51, v5
s_nop 0
v_add_f32 v4, v4, v50
M a[136:139], a[200:203], v[216:219], a[136:139]
v_add_f32 v5, v5, v51
v_rcp_f32 v4, v4
v_rcp_f32 v5, v5
T a[224:225], v24, 49152
T a[226:227], v24, 57344
WL 10
M a[12:15], a[204:207], v[124:127], a[12:15]
s_nop 0
v_accvgpr_read_b32 v228, a0
v_accvgpr_read_b32 v229, a1
M a[76:79], a[204:207], v[188:191], a[76:79]
v_accvgpr_read_b32 v230, a2
v_accvgpr_read_b32 v231, a3
v_accvgpr_read_b32 v232, a4
M a[140:143], a[204:207], v[216:219], a[140:143]
v_accvgpr_read_b32 v233, a5
v_accvgpr_read_b32 v234, a6
v_accvgpr_read_b32 v235, a7
M a[144:147], v[220:223], v[216:219], a[144:147]
v_mul_f32 v228, v228, v4
v_mul_f32 v229, v229, v4
v_mul_f32 v230, v230, v4
T a[228:229], v25, 49152
T a[230:231], v25, 57344
WL 10
M a[16:19], a[208:211], v[124:127], a[16:19]
v_mul_f32 v231, v231, v4
v_mul_f32 v232, v232, v4
v_mul_f32 v233, v233, v4
M a[80:83], a[208:211], v[188:191], a[80:83]
v_mul_f32 v234, v234, v4
v_mul_f32 v235, v235, v4
CV v236, v228, v229
T a[232:233], v26, 49152
T a[234:235], v26, 57344
WL 10
M a[20:23], a[212:215], v[124:127], a[20:23]
CV v237, v230, v231
CV v238, v232, v233
CV v239, v234, v235
M a[84:87], a[212:215], v[188:191], a[84:87]
s_add_u32 s41, s36, s56
buffer_store_dwordx4 v[236:239], v15, s[24:27], s41 offen offset:0 sc1
v_accvgpr_read_b32 v240, a64
T a[236:237], v27, 49152
T a[238:239], v27, 57344
WL 10
M a[24:27], a[216:219], v[124:127], a[24:27]
v_accvgpr_read_b32 v241, a65
v_accvgpr_read_b32 v242, a66
v_accvgpr_read_b32 v243, a67
M a[88:91], a[216:219], v[188:191], a[88:91]
v_accvgpr_read_b32 v244, a68
v_accvgpr_read_b32 v245, a69
v_accvgpr_read_b32 v246, a70
T a[240:241], v28, 49152
T a[242:243], v28, 57344
WL 10
M a[28:31], a[220:223], v[124:127], a[28:31]
v_accvgpr_read_b32 v247, a71
v_mul_f32 v240, v240, v5
v_mul_f32 v241, v241, v5
M a[92:95], a[220:223], v[188:191], a[92:95]
v_mul_f32 v242, v242, v5
v_mul_f32 v243, v243, v5
v_mul_f32 v244, v244, v5
T a[244:245], v29, 49152
T a[246:247], v29, 57344
WL 10
M a[32:35], a[224:227], v[124:127], a[32:35]
v_mul_f32 v245, v245, v5
v_mul_f32 v246, v246, v5
v_mul_f32 v247, v247, v5
M a[96:99], a[224:227], v[188:191], a[96:99]
CV v248, v240, v241
CV v249, v242, v243
CV v250, v244, v245
T a[248:249], v30, 49152
T a[250:251], v30, 57344
WL 10
M a[36:39], a[228:231], v[124:127], a[36:39]
CV v251, v246, v247
s_add_u32 s41, s37, s56
buffer_store_dwordx4 v[248:251], v15, s[24:27], s41 offen offset:0 sc1
M a[100:103], a[228:231], v[188:191], a[100:103]
v_accvgpr_read_b32 v228, a8
v_accvgpr_read_b32 v229, a9
v_accvgpr_read_b32 v230, a10
T a[252:253], v31, 49152
T a[254:255], v31, 57344
WL 10
M a[40:43], a[232:235], v[124:127], a[40:43]
v_accvgpr_read_b32 v231, a11
v_accvgpr_read_b32 v232, a12
v_accvgpr_read_b32 v233, a13
M a[104:107], a[232:235], v[188:191], a[104:107]
v_accvgpr_read_b32 v234, a14
v_accvgpr_read_b32 v235, a15
v_mul_f32 v228, v228, v4
WL 8
M a[44:47], a[236:239], v[124:127], a[44:47]
v_mul_f32 v229, v229, v4
v_mul_f32 v230, v230, v4
v_mul_f32 v231, v231, v4
M a[108:111], a[236:239], v[188:191], a[108:111]
v_mul_f32 v232, v232, v4
v_mul_f32 v233, v233, v4
v_mul_f32 v234, v234, v4
WL 6
M a[48:51], a[240:243], v[124:127], a[48:51]
v_mul_f32 v235, v235, v4
CV v236, v228, v229
CV v237, v230, v231
M a[112:115], a[240:243], v[188:191], a[112:115]
CV v238, v232, v233
CV v239, v234, v235
s_add_u32 s41, s36, s56
WL 4
M a[52:55], a[244:247], v[124:127], a[52:55]
buffer_store_dwordx4 v[236:239], v15, s[24:27], s41 offen offset:1024 sc1
v_accvgpr_read_b32 v240, a72
v_accvgpr_read_b32 v241, a73
M a[116:119], a[244:247], v[188:191], a[116:119]
v_accvgpr_read_b32 v242, a74
v_accvgpr_read_b32 v243, a75
v_accvgpr_read_b32 v244, a76
WL 2
M a[56:59], a[248:251], v[124:127], a[56:59]
v_accvgpr_read_b32 v245, a77
v_accvgpr_read_b32 v246, a78
v_accvgpr_read_b32 v247, a79
M a[120:123], a[248:251], v[188:191], a[120:123]
v_mul_f32 v240, v240, v5
v_mul_f32 v241, v241, v5
v_mul_f32 v242, v242, v5
WL 0
M a[60:63], a[252:255], v[124:127], a[60:63]
v_mul_f32 v243, v243, v5
v_mul_f32 v244, v244, v5
v_mul_f32 v245, v245, v5
M a[124:127], a[252:255], v[188:191], a[124:127]
v_mul_f32 v246, v246, v5
v_mul_f32 v247, v247, v5
CV v248, v240, v241
CV v249, v242, v243
CV v250, v244, v245
CV v251, v246, v247
s_add_u32 s41, s37, s56
buffer_store_dwordx4 v[248:251], v15, s[24:27], s41 offen offset:1024 sc1
v_accvgpr_read_b32 v225, a144
v_rcp_f32 v225, v225
s_nop 0
v_accvgpr_read_b32 v228, a128
v_accvgpr_read_b32 v229, a129
v_accvgpr_read_b32 v230, a130
v_accvgpr_read_b32 v231, a131
v_accvgpr_read_b32 v232, a132
v_accvgpr_read_b32 v233, a133
v_accvgpr_read_b32 v234, a134
v_accvgpr_read_b32 v235, a135
v_mul_f32 v228, v228, v225
v_mul_f32 v229, v229, v225
v_mul_f32 v230, v230, v225
v_mul_f32 v231, v231, v225
v_mul_f32 v232, v232, v225
v_mul_f32 v233, v233, v225
v_mul_f32 v234, v234, v225
v_mul_f32 v235, v235, v225
CV v236, v228, v229
CV v237, v230, v231
CV v238, v232, v233
CV v239, v234, v235
s_add_u32 s41, s38, s56
buffer_store_dwordx4 v[236:239], v15, s[24:27], s41 offen offset:0 sc1
v_accvgpr_read_b32 v240, a136
v_accvgpr_read_b32 v241, a137
v_accvgpr_read_b32 v242, a138
v_accvgpr_read_b32 v243, a139
v_accvgpr_read_b32 v244, a140
v_accvgpr_read_b32 v245, a141
v_accvgpr_read_b32 v246, a142
v_accvgpr_read_b32 v247, a143
v_mul_f32 v240, v240, v225
v_mul_f32 v241, v241, v225
v_mul_f32 v242, v242, v225
v_mul_f32 v243, v243, v225
v_mul_f32 v244, v244, v225
v_mul_f32 v245, v245, v225
v_mul_f32 v246, v246, v225
v_mul_f32 v247, v247, v225
CV v248, v240, v241
CV v249, v242, v243
CV v250, v244, v245
CV v251, v246, v247
s_add_u32 s41, s38, s56
buffer_store_dwordx4 v[248:251], v15, s[24:27], s41 offen offset:1024 sc1
v_accvgpr_read_b32 v228, a16
v_accvgpr_read_b32 v229, a17
v_accvgpr_read_b32 v230, a18
v_accvgpr_read_b32 v231, a19
v_accvgpr_read_b32 v232, a20
v_accvgpr_read_b32 v233, a21
v_accvgpr_read_b32 v234, a22
v_accvgpr_read_b32 v235, a23
v_mul_f32 v228, v228, v4
v_mul_f32 v229, v229, v4
v_mul_f32 v230, v230, v4
v_mul_f32 v231, v231, v4
v_mul_f32 v232, v232, v4
v_mul_f32 v233, v233, v4
v_mul_f32 v234, v234, v4
v_mul_f32 v235, v235, v4
CV v236, v228, v229
CV v237, v230, v231
CV v238, v232, v233
CV v239, v234, v235
s_add_u32 s41, s36, s57
buffer_store_dwordx4 v[236:239], v15, s[24:27], s41 offen offset:0 sc1
v_accvgpr_read_b32 v240, a80
v_accvgpr_read_b32 v241, a81
v_accvgpr_read_b32 v242, a82
v_accvgpr_read_b32 v243, a83
v_accvgpr_read_b32 v244, a84
v_accvgpr_read_b32 v245, a85
v_accvgpr_read_b32 v246, a86
v_accvgpr_read_b32 v247, a87
v_mul_f32 v240, v240, v5
v_mul_f32 v241, v241, v5
v_mul_f32 v242, v242, v5
v_mul_f32 v243, v243, v5
v_mul_f32 v244, v244, v5
v_mul_f32 v245, v245, v5
v_mul_f32 v246, v246, v5
v_mul_f32 v247, v247, v5
CV v248, v240, v241
CV v249, v242, v243
CV v250, v244, v245
CV v251, v246, v247
s_add_u32 s41, s37, s57
buffer_store_dwordx4 v[248:251], v15, s[24:27], s41 offen offset:0 sc1
v_accvgpr_read_b32 v228, a24
v_accvgpr_read_b32 v229, a25
v_accvgpr_read_b32 v230, a26
v_accvgpr_read_b32 v231, a27
v_accvgpr_read_b32 v232, a28
v_accvgpr_read_b32 v233, a29
v_accvgpr_read_b32 v234, a30
v_accvgpr_read_b32 v235, a31
v_mul_f32 v228, v228, v4
v_mul_f32 v229, v229, v4
v_mul_f32 v230, v230, v4
v_mul_f32 v231, v231, v4
v_mul_f32 v232, v232, v4
v_mul_f32 v233, v233, v4
v_mul_f32 v234, v234, v4
v_mul_f32 v235, v235, v4
CV v236, v228, v229
CV v237, v230, v231
CV v238, v232, v233
CV v239, v234, v235
s_add_u32 s41, s36, s57
buffer_store_dwordx4 v[236:239], v15, s[24:27], s41 offen offset:1024 sc1
v_accvgpr_read_b32 v240, a88
v_accvgpr_read_b32 v241, a89
v_accvgpr_read_b32 v242, a90
v_accvgpr_read_b32 v243, a91
v_accvgpr_read_b32 v244, a92
v_accvgpr_read_b32 v245, a93
v_accvgpr_read_b32 v246, a94
v_accvgpr_read_b32 v247, a95
v_mul_f32 v240, v240, v5
v_mul_f32 v241, v241, v5
v_mul_f32 v242, v242, v5
v_mul_f32 v243, v243, v5
v_mul_f32 v244, v244, v5
v_mul_f32 v245, v245, v5
v_mul_f32 v246, v246, v5
v_mul_f32 v247, v247, v5
CV v248, v240, v241
CV v249, v242, v243
CV v250, v244, v245
CV v251, v246, v247
s_add_u32 s41, s37, s57
buffer_store_dwordx4 v[248:251], v15, s[24:27], s41 offen offset:1024 sc1
v_accvgpr_read_b32 v228, a32
v_accvgpr_read_b32 v229, a33
v_accvgpr_read_b32 v230, a34
v_accvgpr_read_b32 v231, a35
v_accvgpr_read_b32 v232, a36
v_accvgpr_read_b32 v233, a37
v_accvgpr_read_b32 v234, a38
v_accvgpr_read_b32 v235, a39
v_mul_f32 v228, v228, v4
v_mul_f32 v229, v229, v4
v_mul_f32 v230, v230, v4
v_mul_f32 v231, v231, v4
v_mul_f32 v232, v232, v4
v_mul_f32 v233, v233, v4
v_mul_f32 v234, v234, v4
v_mul_f32 v235, v235, v4
CV v236, v228, v229
CV v237, v230, v231
CV v238, v232, v233
CV v239, v234, v235
s_add_u32 s41, s36, s58
buffer_store_dwordx4 v[236:239], v15, s[24:27], s41 offen offset:0 sc1
v_accvgpr_read_b32 v240, a96
v_accvgpr_read_b32 v241, a97
v_accvgpr_read_b32 v242, a98
v_accvgpr_read_b32 v243, a99
v_accvgpr_read_b32 v244, a100
v_accvgpr_read_b32 v245, a101
v_accvgpr_read_b32 v246, a102
v_accvgpr_read_b32 v247, a103
v_mul_f32 v240, v240, v5
v_mul_f32 v241, v241, v5
v_mul_f32 v242, v242, v5
v_mul_f32 v243, v243, v5
v_mul_f32 v244, v244, v5
v_mul_f32 v245, v245, v5
v_mul_f32 v246, v246, v5
v_mul_f32 v247, v247, v5
CV v248, v240, v241
CV v249, v242, v243
CV v250, v244, v245
CV v251, v246, v247
s_add_u32 s41, s37, s58
buffer_store_dwordx4 v[248:251], v15, s[24:27], s41 offen offset:0 sc1
v_accvgpr_read_b32 v228, a40
v_accvgpr_read_b32 v229, a41
v_accvgpr_read_b32 v230, a42
v_accvgpr_read_b32 v231, a43
v_accvgpr_read_b32 v232, a44
v_accvgpr_read_b32 v233, a45
v_accvgpr_read_b32 v234, a46
v_accvgpr_read_b32 v235, a47
v_mul_f32 v228, v228, v4
v_mul_f32 v229, v229, v4
v_mul_f32 v230, v230, v4
v_mul_f32 v231, v231, v4
v_mul_f32 v232, v232, v4
v_mul_f32 v233, v233, v4
v_mul_f32 v234, v234, v4
v_mul_f32 v235, v235, v4
CV v236, v228, v229
CV v237, v230, v231
CV v238, v232, v233
CV v239, v234, v235
s_add_u32 s41, s36, s58
buffer_store_dwordx4 v[236:239], v15, s[24:27], s41 offen offset:1024 sc1
v_accvgpr_read_b32 v240, a104
v_accvgpr_read_b32 v241, a105
v_accvgpr_read_b32 v242, a106
v_accvgpr_read_b32 v243, a107
v_accvgpr_read_b32 v244, a108
v_accvgpr_read_b32 v245, a109
v_accvgpr_read_b32 v246, a110
v_accvgpr_read_b32 v247, a111
v_mul_f32 v240, v240, v5
v_mul_f32 v241, v241, v5
v_mul_f32 v242, v242, v5
v_mul_f32 v243, v243, v5
v_mul_f32 v244, v244, v5
v_mul_f32 v245, v245, v5
v_mul_f32 v246, v246, v5
v_mul_f32 v247, v247, v5
CV v248, v240, v241
CV v249, v242, v243
CV v250, v244, v245
CV v251, v246, v247
s_add_u32 s41, s37, s58
buffer_store_dwordx4 v[248:251], v15, s[24:27], s41 offen offset:1024 sc1
v_accvgpr_read_b32 v228, a48
v_accvgpr_read_b32 v229, a49
v_accvgpr_read_b32 v230, a50
v_accvgpr_read_b32 v231, a51
v_accvgpr_read_b32 v232, a52
v_accvgpr_read_b32 v233, a53
v_accvgpr_read_b32 v234, a54
v_accvgpr_read_b32 v235, a55
v_mul_f32 v228, v228, v4
v_mul_f32 v229, v229, v4
v_mul_f32 v230, v230, v4
v_mul_f32 v231, v231, v4
v_mul_f32 v232, v232, v4
v_mul_f32 v233, v233, v4
v_mul_f32 v234, v234, v4
v_mul_f32 v235, v235, v4
CV v236, v228, v229
CV v237, v230, v231
CV v238, v232, v233
CV v239, v234, v235
s_add_u32 s41, s36, s59
buffer_store_dwordx4 v[236:239], v15, s[24:27], s41 offen offset:0 sc1
v_accvgpr_read_b32 v240, a112
v_accvgpr_read_b32 v241, a113
v_accvgpr_read_b32 v242, a114
v_accvgpr_read_b32 v243, a115
v_accvgpr_read_b32 v244, a116
v_accvgpr_read_b32 v245, a117
v_accvgpr_read_b32 v246, a118
v_accvgpr_read_b32 v247, a119
v_mul_f32 v240, v240, v5
v_mul_f32 v241, v241, v5
v_mul_f32 v242, v242, v5
v_mul_f32 v243, v243, v5
v_mul_f32 v244, v244, v5
v_mul_f32 v245, v245, v5
v_mul_f32 v246, v246, v5
v_mul_f32 v247, v247, v5
CV v248, v240, v241
CV v249, v242, v243
CV v250, v244, v245
CV v251, v246, v247
s_add_u32 s41, s37, s59
buffer_store_dwordx4 v[248:251], v15, s[24:27], s41 offen offset:0 sc1
v_accvgpr_read_b32 v228, a56
v_accvgpr_read_b32 v229, a57
v_accvgpr_read_b32 v230, a58
v_accvgpr_read_b32 v231, a59
v_accvgpr_read_b32 v232, a60
v_accvgpr_read_b32 v233, a61
v_accvgpr_read_b32 v234, a62
v_accvgpr_read_b32 v235, a63
v_mul_f32 v228, v228, v4
v_mul_f32 v229, v229, v4
v_mul_f32 v230, v230, v4
v_mul_f32 v231, v231, v4
v_mul_f32 v232, v232, v4
v_mul_f32 v233, v233, v4
v_mul_f32 v234, v234, v4
v_mul_f32 v235, v235, v4
CV v236, v228, v229
CV v237, v230, v231
CV v238, v232, v233
CV v239, v234, v235
s_add_u32 s41, s36, s59
buffer_store_dwordx4 v[236:239], v15, s[24:27], s41 offen offset:1024 sc1
v_accvgpr_read_b32 v240, a120
v_accvgpr_read_b32 v241, a121
v_accvgpr_read_b32 v242, a122
v_accvgpr_read_b32 v243, a123
v_accvgpr_read_b32 v244, a124
v_accvgpr_read_b32 v245, a125
v_accvgpr_read_b32 v246, a126
v_accvgpr_read_b32 v247, a127
v_mul_f32 v240, v240, v5
v_mul_f32 v241, v241, v5
v_mul_f32 v242, v242, v5
v_mul_f32 v243, v243, v5
v_mul_f32 v244, v244, v5
v_mul_f32 v245, v245, v5
v_mul_f32 v246, v246, v5
v_mul_f32 v247, v247, v5
CV v248, v240, v241
CV v249, v242, v243
CV v250, v244, v245
CV v251, v246, v247
s_add_u32 s41, s37, s59
buffer_store_dwordx4 v[248:251], v15, s[24:27], s41 offen offset:1024 sc1
s_load_dwordx4 s[44:47], s[0:1], 32
s_load_dwordx2 s[48:49], s[0:1], 48
s_mov_b32 s87, s6
s_mov_b32 s88, s5
s_waitcnt vmcnt(0) lgkmcnt(0)
s_mov_b32 s20, s48
s_mov_b32 s21, s49
s_mov_b32 s22, 256
s_mov_b32 s23, 0x20000
s_barrier
s_cmp_lg_u32 s28, 0
s_cbranch_scc1 L_nosig1
s_lshl_b32 s42, s87, 2
v_mov_b32 v10, s42
s_lshl_b32 s42, 1, s88
v_mov_b32 v11, s42
s_mov_b64 exec, 1
buffer_atomic_or v11, v10, s[20:23], 0 offen sc1
s_mov_b64 exec, -1
L_nosig1:
s_and_b32 s3, s2, 7
s_lshr_b32 s4, s2, 3
s_lshl_b32 s3, s3, 5
s_add_u32 s3, s3, s4
s_cmp_ge_u32 s3, 252
s_cbranch_scc1 L_k1_exit
s_mul_i32 s4, s3, 9363
s_lshr_b32 s4, s4, 16
s_mul_i32 s5, s4, 7
s_sub_u32 s5, s3, s5
s_lshl_b32 s6, s5, 7
s_add_u32 s8, s44, s6
s_addc_u32 s9, s45, 0
s_sub_u32 s10, 3670016, s6
s_mov_b32 s11, 0x20000
s_lshl_b32 s7, s4, 2
s_add_u32 s7, s7, s28
s_lshl_b32 s25, s7, 17
s_add_u32 s12, s52, s25
s_addc_u32 s13, s53, 0
s_mov_b32 s14, 131072
s_mov_b32 s15, 0x20000
s_mov_b32 s16, s46
s_mov_b32 s17, s47
s_mov_b32 s18, 2064384
s_mov_b32 s19, 0x20000
s_mul_i32 s33, s7, 14336
s_add_u32 s33, s33, s6
s_mul_i32 s30, s28, 28672
s_lshl_b32 s31, s28, 12
v_lshrrev_b32 v10, 3, v1
v_mul_u32_u24 v10, 896, v10
v_bfe_u32 v11, v1, 1, 2
v_lshrrev_b32 v12, 4, v1
v_xor_b32 v11, v11, v12
v_lshl_add_u32 v10, v11, 5, v10
v_and_b32 v11, 1, v1
v_lshl_add_u32 v2, v11, 4, v10
v_lshlrev_b32 v3, 4, v1
v_and_b32 v10, 15, v1
v_mul_u32_u24 v10, 896, v10
v_lshl_add_u32 v4, v12, 3, v10
v_bfe_u32 v10, v1, 2, 2
v_lshl_add_u32 v10, v12, 2, v10
v_bfe_u32 v11, v10, 1, 2
v_lshlrev_b32 v10, 7, v10
v_lshl_add_u32 v10, v11, 5, v10
v_and_b32 v11, 3, v1
v_lshl_add_u32 v10, v11, 3, v10
v_xor_b32 v6, 0, v10
v_xor_b32 v7, 32, v10
v_xor_b32 v8, 64, v10
v_xor_b32 v9, 96, v10
s_and_b32 s78, s3, 31
s_add_u32 s80, s78, 0
s_and_b32 s80, s80, 31
s_mul_i32 s80, s80, 114688
s_add_u32 s80, s80, s30
s_add_u32 m0, s31, 0
s_add_u32 s32, s80, 0
buffer_load_dwordx4 v2, s[8:11], s32 offen lds
s_add_u32 m0, s31, 1024
s_add_u32 s32, s80, 7168
buffer_load_dwordx4 v2, s[8:11], s32 offen lds
s_add_u32 m0, s31, 2048
s_add_u32 s32, s80, 14336
buffer_load_dwordx4 v2, s[8:11], s32 offen lds
s_add_u32 m0, s31, 3072
s_add_u32 s32, s80, 21504
buffer_load_dwordx4 v2, s[8:11], s32 offen lds
s_add_u32 s80, s78, 1
s_and_b32 s80, s80, 31
s_mul_i32 s80, s80, 114688
s_add_u32 s80, s80, s30
s_add_u32 m0, s31, 16384
s_add_u32 s32, s80, 0
buffer_load_dwordx4 v2, s[8:11], s32 offen lds
s_add_u32 m0, s31, 17408
s_add_u32 s32, s80, 7168
buffer_load_dwordx4 v2, s[8:11], s32 offen lds
s_add_u32 m0, s31, 18432
s_add_u32 s32, s80, 14336
buffer_load_dwordx4 v2, s[8:11], s32 offen lds
s_add_u32 m0, s31, 19456
s_add_u32 s32, s80, 21504
buffer_load_dwordx4 v2, s[8:11], s32 offen lds
s_add_u32 s80, s78, 2
s_and_b32 s80, s80, 31
s_mul_i32 s80, s80, 114688
s_add_u32 s80, s80, s30
s_add_u32 m0, s31, 32768
s_add_u32 s32, s80, 0
buffer_load_dwordx4 v2, s[8:11], s32 offen lds
s_add_u32 m0, s31, 33792
s_add_u32 s32, s80, 7168
buffer_load_dwordx4 v2, s[8:11], s32 offen lds
s_add_u32 m0, s31, 34816
s_add_u32 s32, s80, 14336
buffer_load_dwordx4 v2, s[8:11], s32 offen lds
s_add_u32 m0, s31, 35840
s_add_u32 s32, s80, 21504
buffer_load_dwordx4 v2, s[8:11], s32 offen lds
s_add_u32 s80, s78, 3
s_and_b32 s80, s80, 31
s_mul_i32 s80, s80, 114688
s_add_u32 s80, s80, s30
s_add_u32 m0, s31, 49152
s_add_u32 s32, s80, 0
buffer_load_dwordx4 v2, s[8:11], s32 offen lds
s_add_u32 m0, s31, 50176
s_add_u32 s32, s80, 7168
buffer_load_dwordx4 v2, s[8:11], s32 offen lds
s_add_u32 m0, s31, 51200
s_add_u32 s32, s80, 14336
buffer_load_dwordx4 v2, s[8:11], s32 offen lds
s_add_u32 m0, s31, 52224
s_add_u32 s32, s80, 21504
buffer_load_dwordx4 v2, s[8:11], s32 offen lds
s_add_u32 s80, s78, 4
s_and_b32 s80, s80, 31
s_mul_i32 s80, s80, 114688
s_add_u32 s80, s80, s30
s_add_u32 m0, s31, 65536
s_add_u32 s32, s80, 0
buffer_load_dwordx4 v2, s[8:11], s32 offen lds
s_add_u32 m0, s31, 66560
s_add_u32 s32, s80, 7168
buffer_load_dwordx4 v2, s[8:11], s32 offen lds
s_add_u32 m0, s31, 67584
s_add_u32 s32, s80, 14336
buffer_load_dwordx4 v2, s[8:11], s32 offen lds
s_add_u32 m0, s31, 68608
s_add_u32 s32, s80, 21504
buffer_load_dwordx4 v2, s[8:11], s32 offen lds
s_add_u32 s80, s78, 5
s_and_b32 s80, s80, 31
s_mul_i32 s80, s80, 114688
s_add_u32 s80, s80, s30
s_add_u32 m0, s31, 81920
s_add_u32 s32, s80, 0
buffer_load_dwordx4 v2, s[8:11], s32 offen lds
s_add_u32 m0, s31, 82944
s_add_u32 s32, s80, 7168
buffer_load_dwordx4 v2, s[8:11], s32 offen lds
s_add_u32 m0, s31, 83968
s_add_u32 s32, s80, 14336
buffer_load_dwordx4 v2, s[8:11], s32 offen lds
s_add_u32 m0, s31, 84992
s_add_u32 s32, s80, 21504
buffer_load_dwordx4 v2, s[8:11], s32 offen lds
s_lshl_b32 s42, s4, 2
s_mul_i32 s43, s42, 7282
s_lshr_b32 s43, s43, 16
s_add_u32 s42, s42, 3
s_mul_i32 s42, s42, 7282
s_lshr_b32 s42, s42, 16
s_lshl_b32 s42, s42, 2
s_lshl_b32 s43, s43, 2
v_mov_b32 v30, s43
v_writelane_b32 v30, s42, 1
s_mov_b32 s85, 0
s_cmp_lg_u32 s28, 0
s_cbranch_scc1 L_nopoll
s_add_u32 s83, s78, 0
s_and_b32 s83, s83, 31
s_lshr_b32 s83, s83, 1
s_mov_b32 s86, 0
L_pc1:
s_lshr_b32 s84, s85, s83
s_and_b32 s84, s84, 1
s_cbranch_scc1 L_pd1
s_mov_b64 exec, 3
buffer_load_dword v31, v30, s[20:23], 0 offen sc1
s_waitcnt vmcnt(0)
s_mov_b64 exec, -1
v_readlane_b32 s84, v31, 0
v_readlane_b32 s85, v31, 1
s_and_b32 s85, s85, s84
s_sleep 1
s_add_u32 s86, s86, 1
s_cmp_lt_u32 s86, 0x400000
s_cbranch_scc1 L_pc1
L_pd1:
s_add_u32 s83, s78, 1
s_and_b32 s83, s83, 31
s_lshr_b32 s83, s83, 1
s_mov_b32 s86, 0
L_pc2:
s_lshr_b32 s84, s85, s83
s_and_b32 s84, s84, 1
s_cbranch_scc1 L_pd2
s_mov_b64 exec, 3
buffer_load_dword v31, v30, s[20:23], 0 offen sc1
s_waitcnt vmcnt(0)
s_mov_b64 exec, -1
v_readlane_b32 s84, v31, 0
v_readlane_b32 s85, v31, 1
s_and_b32 s85, s85, s84
s_sleep 1
s_add_u32 s86, s86, 1
s_cmp_lt_u32 s86, 0x400000
s_cbranch_scc1 L_pc2
L_pd2:
s_add_u32 s83, s78, 2
s_and_b32 s83, s83, 31
s_lshr_b32 s83, s83, 1
s_mov_b32 s86, 0
L_pc3:
s_lshr_b32 s84, s85, s83
s_and_b32 s84, s84, 1
s_cbranch_scc1 L_pd3
s_mov_b64 exec, 3
buffer_load_dword v31, v30, s[20:23], 0 offen sc1
s_waitcnt vmcnt(0)
s_mov_b64 exec, -1
v_readlane_b32 s84, v31, 0
v_readlane_b32 s85, v31, 1
s_and_b32 s85, s85, s84
s_sleep 1
s_add_u32 s86, s86, 1
s_cmp_lt_u32 s86, 0x400000
s_cbranch_scc1 L_pc3
L_pd3:
s_add_u32 s83, s78, 3
s_and_b32 s83, s83, 31
s_lshr_b32 s83, s83, 1
s_mov_b32 s86, 0
L_pc4:
s_lshr_b32 s84, s85, s83
s_and_b32 s84, s84, 1
s_cbranch_scc1 L_pd4
s_mov_b64 exec, 3
buffer_load_dword v31, v30, s[20:23], 0 offen sc1
s_waitcnt vmcnt(0)
s_mov_b64 exec, -1
v_readlane_b32 s84, v31, 0
v_readlane_b32 s85, v31, 1
s_and_b32 s85, s85, s84
s_sleep 1
s_add_u32 s86, s86, 1
s_cmp_lt_u32 s86, 0x400000
s_cbranch_scc1 L_pc4
L_pd4:
s_add_u32 s83, s78, 4
s_and_b32 s83, s83, 31
s_lshr_b32 s83, s83, 1
s_mov_b32 s86, 0
L_pc5:
s_lshr_b32 s84, s85, s83
s_and_b32 s84, s84, 1
s_cbranch_scc1 L_pd5
s_mov_b64 exec, 3
buffer_load_dword v31, v30, s[20:23], 0 offen sc1
s_waitcnt vmcnt(0)
s_mov_b64 exec, -1
v_readlane_b32 s84, v31, 0
v_readlane_b32 s85, v31, 1
s_and_b32 s85, s85, s84
s_sleep 1
s_add_u32 s86, s86, 1
s_cmp_lt_u32 s86, 0x400000
s_cbranch_scc1 L_pc5
L_pd5:
s_add_u32 s83, s78, 5
s_and_b32 s83, s83, 31
s_lshr_b32 s83, s83, 1
s_mov_b32 s86, 0
L_pc6:
s_lshr_b32 s84, s85, s83
s_and_b32 s84, s84, 1
s_cbranch_scc1 L_pd6
s_mov_b64 exec, 3
buffer_load_dword v31, v30, s[20:23], 0 offen sc1
s_waitcnt vmcnt(0)
s_mov_b64 exec, -1
v_readlane_b32 s84, v31, 0
v_readlane_b32 s85, v31, 1
s_and_b32 s85, s85, s84
s_sleep 1
s_add_u32 s86, s86, 1
s_cmp_lt_u32 s86, 0x400000
s_cbranch_scc1 L_pc6
L_pd6:
L_nopoll:
s_barrier
s_add_u32 s81, s78, 0
s_and_b32 s81, s81, 31
s_lshl_b32 s81, s81, 12
buffer_load_dwordx4 v[64:67], v3, s[12:15], s81 offen offset:0 sc1
buffer_load_dwordx4 v[68:71], v3, s[12:15], s81 offen offset:1024 sc1
buffer_load_dwordx4 v[72:75], v3, s[12:15], s81 offen offset:2048 sc1
buffer_load_dwordx4 v[76:79], v3, s[12:15], s81 offen offset:3072 sc1
s_add_u32 s81, s78, 1
s_and_b32 s81, s81, 31
s_lshl_b32 s81, s81, 12
buffer_load_dwordx4 v[80:83], v3, s[12:15], s81 offen offset:0 sc1
buffer_load_dwordx4 v[84:87], v3, s[12:15], s81 offen offset:1024 sc1
buffer_load_dwordx4 v[88:91], v3, s[12:15], s81 offen offset:2048 sc1
buffer_load_dwordx4 v[92:95], v3, s[12:15], s81 offen offset:3072 sc1
s_add_u32 s81, s78, 2
s_and_b32 s81, s81, 31
s_lshl_b32 s81, s81, 12
buffer_load_dwordx4 v[96:99], v3, s[12:15], s81 offen offset:0 sc1
buffer_load_dwordx4 v[100:103], v3, s[12:15], s81 offen offset:1024 sc1
buffer_load_dwordx4 v[104:107], v3, s[12:15], s81 offen offset:2048 sc1
buffer_load_dwordx4 v[108:111], v3, s[12:15], s81 offen offset:3072 sc1
s_add_u32 s81, s78, 3
s_and_b32 s81, s81, 31
s_lshl_b32 s81, s81, 12
buffer_load_dwordx4 v[112:115], v3, s[12:15], s81 offen offset:0 sc1
buffer_load_dwordx4 v[116:119], v3, s[12:15], s81 offen offset:1024 sc1
buffer_load_dwordx4 v[120:123], v3, s[12:15], s81 offen offset:2048 sc1
buffer_load_dwordx4 v[124:127], v3, s[12:15], s81 offen offset:3072 sc1
s_add_u32 s81, s78, 4
s_and_b32 s81, s81, 31
s_lshl_b32 s81, s81, 12
buffer_load_dwordx4 v[128:131], v3, s[12:15], s81 offen offset:0 sc1
buffer_load_dwordx4 v[132:135], v3, s[12:15], s81 offen offset:1024 sc1
buffer_load_dwordx4 v[136:139], v3, s[12:15], s81 offen offset:2048 sc1
buffer_load_dwordx4 v[140:143], v3, s[12:15], s81 offen offset:3072 sc1
s_add_u32 s81, s78, 5
s_and_b32 s81, s81, 31
s_lshl_b32 s81, s81, 12
buffer_load_dwordx4 v[144:147], v3, s[12:15], s81 offen offset:0 sc1
buffer_load_dwordx4 v[148:151], v3, s[12:15], s81 offen offset:1024 sc1
buffer_load_dwordx4 v[152:155], v3, s[12:15], s81 offen offset:2048 sc1
buffer_load_dwordx4 v[156:159], v3, s[12:15], s81 offen offset:3072 sc1
s_waitcnt vmcnt(44)
s_barrier
T v[32:33], v6, 0
T v[34:35], v6, 2048
T v[36:37], v7, 0
T v[38:39], v7, 2048
s_add_u32 s80, s78, 6
s_and_b32 s80, s80, 31
s_mul_i32 s80, s80, 114688
s_add_u32 s80, s80, s30
s_add_u32 m0, s31, 98304
s_add_u32 s32, s80, 0
buffer_load_dwordx4 v2, s[8:11], s32 offen lds
T v[40:41], v8, 0
T v[42:43], v8, 2048
T v[44:45], v9, 0
T v[46:47], v9, 2048
s_add_u32 m0, s31, 99328
s_add_u32 s32, s80, 7168
buffer_load_dwordx4 v2, s[8:11], s32 offen lds
T v[48:49], v6, 4096
T v[50:51], v6, 6144
s_waitcnt vmcnt(22)
WL 8
M v[12:15], v[32:35], v[64:67], 0
T v[52:53], v7, 4096
T v[54:55], v7, 6144
WL 8
M v[16:19], v[36:39], v[64:67], 0
s_add_u32 m0, s31, 100352
s_add_u32 s32, s80, 14336
buffer_load_dwordx4 v2, s[8:11], s32 offen lds
T v[56:57], v8, 4096
T v[58:59], v8, 6144
WL 8
M v[20:23], v[40:43], v[64:67], 0
T v[60:61], v9, 4096
T v[62:63], v9, 6144
WL 8
M v[24:27], v[44:47], v[64:67], 0
s_add_u32 m0, s31, 101376
s_add_u32 s32, s80, 21504
buffer_load_dwordx4 v2, s[8:11], s32 offen lds
T v[32:33], v6, 8192
T v[34:35], v6, 10240
WL 8
M v[12:15], v[48:51], v[68:71], v[12:15]
T v[36:37], v7, 8192
T v[38:39], v7, 10240
WL 8
M v[16:19], v[52:55], v[68:71], v[16:19]
s_add_u32 s80, s78, 7
s_and_b32 s80, s80, 31
s_mul_i32 s80, s80, 114688
s_add_u32 s80, s80, s30
s_add_u32 m0, s31, 114688
s_add_u32 s32, s80, 0
buffer_load_dwordx4 v2, s[8:11], s32 offen lds
T v[40:41], v8, 8192
T v[42:43], v8, 10240
WL 8
M v[20:23], v[56:59], v[68:71], v[20:23]
T v[44:45], v9, 8192
T v[46:47], v9, 10240
WL 8
M v[24:27], v[60:63], v[68:71], v[24:27]
s_add_u32 m0, s31, 115712
s_add_u32 s32, s80, 7168
buffer_load_dwordx4 v2, s[8:11], s32 offen lds
T v[48:49], v6, 12288
T v[50:51], v6, 14336
WL 8
M v[12:15], v[32:35], v[72:75], v[12:15]
T v[52:53], v7, 12288
T v[54:55], v7, 14336
WL 8
M v[16:19], v[36:39], v[72:75], v[16:19]
s_add_u32 m0, s31, 116736
s_add_u32 s32, s80, 14336
buffer_load_dwordx4 v2, s[8:11], s32 offen lds
T v[56:57], v8, 12288
T v[58:59], v8, 14336
WL 8
M v[20:23], v[40:43], v[72:75], v[20:23]
T v[60:61], v9, 12288
T v[62:63], v9, 14336
WL 8
M v[24:27], v[44:47], v[72:75], v[24:27]
s_add_u32 m0, s31, 117760
s_add_u32 s32, s80, 21504
buffer_load_dwordx4 v2, s[8:11], s32 offen lds
s_cmp_lg_u32 s28, 0
s_cbranch_scc1 L_np1
s_add_u32 s83, s78, 6
s_and_b32 s83, s83, 31
s_lshr_b32 s83, s83, 1
s_mov_b32 s86, 0
L_pc7:
s_lshr_b32 s84, s85, s83
s_and_b32 s84, s84, 1
s_cbranch_scc1 L_pd7
s_mov_b64 exec, 3
buffer_load_dword v31, v30, s[20:23], 0 offen sc1
s_waitcnt vmcnt(0)
s_mov_b64 exec, -1
v_readlane_b32 s84, v31, 0
v_readlane_b32 s85, v31, 1
s_and_b32 s85, s85, s84
s_sleep 1
s_add_u32 s86, s86, 1
s_cmp_lt_u32 s86, 0x400000
s_cbranch_scc1 L_pc7
L_pd7:
L_np1:
s_barrier
T v[32:33], v6, 16384
T v[34:35], v6, 18432
WL 8
M v[12:15], v[48:51], v[76:79], v[12:15]
T v[36:37], v7, 16384
T v[38:39], v7, 18432
WL 8
M v[16:19], v[52:55], v[76:79], v[16:19]
s_add_u32 s80, s78, 8
s_and_b32 s80, s80, 31
s_mul_i32 s80, s80, 114688
s_add_u32 s80, s80, s30
s_add_u32 m0, s31, 131072
s_add_u32 s32, s80, 0
buffer_load_dwordx4 v2, s[8:11], s32 offen lds
T v[40:41], v8, 16384
T v[42:43], v8, 18432
WL 8
M v[20:23], v[56:59], v[76:79], v[20:23]
T v[44:45], v9, 16384
T v[46:47], v9, 18432
WL 8
M v[24:27], v[60:63], v[76:79], v[24:27]
s_add_u32 m0, s31, 132096
s_add_u32 s32, s80, 7168
buffer_load_dwordx4 v2, s[8:11], s32 offen lds
T v[48:49], v6, 20480
T v[50:51], v6, 22528
s_waitcnt vmcnt(26)
WL 8
M v[12:15], v[32:35], v[80:83], v[12:15]
T v[52:53], v7, 20480
T v[54:55], v7, 22528
WL 8
M v[16:19], v[36:39], v[80:83], v[16:19]
s_add_u32 m0, s31, 133120
s_add_u32 s32, s80, 14336
buffer_load_dwordx4 v2, s[8:11], s32 offen lds
T v[56:57], v8, 20480
T v[58:59], v8, 22528
WL 8
M v[20:23], v[40:43], v[80:83], v[20:23]
T v[60:61], v9, 20480
T v[62:63], v9, 22528
WL 8
M v[24:27], v[44:47], v[80:83], v[24:27]
s_add_u32 m0, s31, 134144
s_add_u32 s32, s80, 21504
buffer_load_dwordx4 v2, s[8:11], s32 offen lds
T v[32:33], v6, 24576
T v[34:35], v6, 26624
WL 8
M v[12:15], v[48:51], v[84:87], v[12:15]
T v[36:37], v7, 24576
T v[38:39], v7, 26624
WL 8
M v[16:19], v[52:55], v[84:87], v[16:19]
s_add_u32 s81, s78, 6
s_and_b32 s81, s81, 31
s_lshl_b32 s81, s81, 12
buffer_load_dwordx4 v[64:67], v3, s[12:15], s81 offen offset:0 sc1
T v[40:41], v8, 24576
T v[42:43], v8, 26624
WL 8
M v[20:23], v[56:59], v[84:87], v[20:23]
T v[44:45], v9, 24576
T v[46:47], v9, 26624
WL 8
M v[24:27], v[60:63], v[84:87], v[24:27]
buffer_load_dwordx4 v[68:71], v3, s[12:15], s81 offen offset:1024 sc1
T v[48:49], v6, 28672
T v[50:51], v6, 30720
WL 8
M v[12:15], v[32:35], v[88:91], v[12:15]
T v[52:53], v7, 28672
T v[54:55], v7, 30720
WL 8
M v[16:19], v[36:39], v[88:91], v[16:19]
buffer_load_dwordx4 v[72:75], v3, s[12:15], s81 offen offset:2048 sc1
T v[56:57], v8, 28672
T v[58:59], v8, 30720
WL 8
M v[20:23], v[40:43], v[88:91], v[20:23]
T v[60:61], v9, 28672
T v[62:63], v9, 30720
WL 8
M v[24:27], v[44:47], v[88:91], v[24:27]
buffer_load_dwordx4 v[76:79], v3, s[12:15], s81 offen offset:3072 sc1
s_cmp_lg_u32 s28, 0
s_cbranch_scc1 L_np2
s_add_u32 s83, s78, 7
s_and_b32 s83, s83, 31
s_lshr_b32 s83, s83, 1
s_mov_b32 s86, 0
L_pc8:
s_lshr_b32 s84, s85, s83
s_and_b32 s84, s84, 1
s_cbranch_scc1 L_pd8
s_mov_b64 exec, 3
buffer_load_dword v31, v30, s[20:23], 0 offen sc1
s_waitcnt vmcnt(0)
s_mov_b64 exec, -1
v_readlane_b32 s84, v31, 0
v_readlane_b32 s85, v31, 1
s_and_b32 s85, s85, s84
s_sleep 1
s_add_u32 s86, s86, 1
s_cmp_lt_u32 s86, 0x400000
s_cbranch_scc1 L_pc8
L_pd8:
L_np2:
s_barrier
T v[32:33], v6, 32768
T v[34:35], v6, 34816
WL 8
M v[12:15], v[48:51], v[92:95], v[12:15]
T v[36:37], v7, 32768
T v[38:39], v7, 34816
WL 8
M v[16:19], v[52:55], v[92:95], v[16:19]
s_add_u32 s80, s78, 9
s_and_b32 s80, s80, 31
s_mul_i32 s80, s80, 114688
s_add_u32 s80, s80, s30
s_add_u32 m0, s31, 0
s_add_u32 s32, s80, 0
buffer_load_dwordx4 v2, s[8:11], s32 offen lds
T v[40:41], v8, 32768
T v[42:43], v8, 34816
WL 8
M v[20:23], v[56:59], v[92:95], v[20:23]
T v[44:45], v9, 32768
T v[46:47], v9, 34816
WL 8
M v[24:27], v[60:63], v[92:95], v[24:27]
s_add_u32 m0, s31, 1024
s_add_u32 s32, s80, 7168
buffer_load_dwordx4 v2, s[8:11], s32 offen lds
T v[48:49], v6, 36864
T v[50:51], v6, 38912
s_waitcnt vmcnt(30)
WL 8
M v[12:15], v[32:35], v[96:99], v[12:15]
T v[52:53], v7, 36864
T v[54:55], v7, 38912
WL 8
M v[16:19], v[36:39], v[96:99], v[16:19]
s_add_u32 m0, s31, 2048
s_add_u32 s32, s80, 14336
buffer_load_dwordx4 v2, s[8:11], s32 offen lds
T v[56:57], v8, 36864
T v[58:59], v8, 38912
WL 8
M v[20:23], v[40:43], v[96:99], v[20:23]
T v[60:61], v9, 36864
T v[62:63], v9, 38912
WL 8
M v[24:27], v[44:47], v[96:99], v[24:27]
s_add_u32 m0, s31, 3072
s_add_u32 s32, s80, 21504
buffer_load_dwordx4 v2, s[8:11], s32 offen lds
T v[32:33], v6, 40960
T v[34:35], v6, 43008
WL 8
M v[12:15], v[48:51], v[100:103], v[12:15]
T v[36:37], v7, 40960
T v[38:39], v7, 43008
WL 8
M v[16:19], v[52:55], v[100:103], v[16:19]
s_add_u32 s81, s78, 7
s_and_b32 s81, s81, 31
s_lshl_b32 s81, s81, 12
buffer_load_dwordx4 v[80:83], v3, s[12:15], s81 offen offset:0 sc1
T v[40:41], v8, 40960
T v[42:43], v8, 43008
WL 8
M v[20:23], v[56:59], v[100:103], v[20:23]
T v[44:45], v9, 40960
T v[46:47], v9, 43008
WL 8
M v[24:27], v[60:63], v[100:103], v[24:27]
buffer_load_dwordx4 v[84:87], v3, s[12:15], s81 offen offset:1024 sc1
T v[48:49], v6, 45056
T v[50:51], v6, 47104
WL 8
M v[12:15], v[32:35], v[104:107], v[12:15]
T v[52:53], v7, 45056
T v[54:55], v7, 47104
WL 8
M v[16:19], v[36:39], v[104:107], v[16:19]
buffer_load_dwordx4 v[88:91], v3, s[12:15], s81 offen offset:2048 sc1
T v[56:57], v8, 45056
T v[58:59], v8, 47104
WL 8
M v[20:23], v[40:43], v[104:107], v[20:23]
T v[60:61], v9, 45056
T v[62:63], v9, 47104
WL 8
M v[24:27], v[44:47], v[104:107], v[24:27]
buffer_load_dwordx4 v[92:95], v3, s[12:15], s81 offen offset:3072 sc1
s_cmp_lg_u32 s28, 0
s_cbranch_scc1 L_np3
s_add_u32 s83, s78, 8
s_and_b32 s83, s83, 31
s_lshr_b32 s83, s83, 1
s_mov_b32 s86, 0
L_pc9:
s_lshr_b32 s84, s85, s83
s_and_b32 s84, s84, 1
s_cbranch_scc1 L_pd9
s_mov_b64 exec, 3
buffer_load_dword v31, v30, s[20:23], 0 offen sc1
s_waitcnt vmcnt(0)
s_mov_b64 exec, -1
v_readlane_b32 s84, v31, 0
v_readlane_b32 s85, v31, 1
s_and_b32 s85, s85, s84
s_sleep 1
s_add_u32 s86, s86, 1
s_cmp_lt_u32 s86, 0x400000
s_cbranch_scc1 L_pc9
L_pd9:
L_np3:
s_barrier
T v[32:33], v6, 49152
T v[34:35], v6, 51200
WL 8
M v[12:15], v[48:51], v[108:111], v[12:15]
T v[36:37], v7, 49152
T v[38:39], v7, 51200
WL 8
M v[16:19], v[52:55], v[108:111], v[16:19]
s_add_u32 s80, s78, 10
s_and_b32 s80, s80, 31
s_mul_i32 s80, s80, 114688
s_add_u32 s80, s80, s30
s_add_u32 m0, s31, 16384
s_add_u32 s32, s80, 0
buffer_load_dwordx4 v2, s[8:11], s32 offen lds
T v[40:41], v8, 49152
T v[42:43], v8, 51200
WL 8
M v[20:23], v[56:59], v[108:111], v[20:23]
T v[44:45], v9, 49152
T v[46:47], v9, 51200
WL 8
M v[24:27], v[60:63], v[108:111], v[24:27]
s_add_u32 m0, s31, 17408
s_add_u32 s32, s80, 7168
buffer_load_dwordx4 v2, s[8:11], s32 offen lds
T v[48:49], v6, 53248
T v[50:51], v6, 55296
s_waitcnt vmcnt(34)
WL 8
M v[12:15], v[32:35], v[112:115], v[12:15]
T v[52:53], v7, 53248
T v[54:55], v7, 55296
WL 8
M v[16:19], v[36:39], v[112:115], v[16:19]
s_add_u32 m0, s31, 18432
s_add_u32 s32, s80, 14336
buffer_load_dwordx4 v2, s[8:11], s32 offen lds
T v[56:57], v8, 53248
T v[58:59], v8, 55296
WL 8
M v[20:23], v[40:43], v[112:115], v[20:23]
T v[60:61], v9, 53248
T v[62:63], v9, 55296
WL 8
M v[24:27], v[44:47], v[112:115], v[24:27]
s_add_u32 m0, s31, 19456
s_add_u32 s32, s80, 21504
buffer_load_dwordx4 v2, s[8:11], s32 offen lds
T v[32:33], v6, 57344
T v[34:35], v6, 59392
WL 8
M v[12:15], v[48:51], v[116:119], v[12:15]
T v[36:37], v7, 57344
T v[38:39], v7, 59392
WL 8
M v[16:19], v[52:55], v[116:119], v[16:19]
s_add_u32 s81, s78, 8
s_and_b32 s81, s81, 31
s_lshl_b32 s81, s81, 12
buffer_load_dwordx4 v[96:99], v3, s[12:15], s81 offen offset:0 sc1
T v[40:41], v8, 57344
T v[42:43], v8, 59392
WL 8
M v[20:23], v[56:59], v[116:119], v[20:23]
T v[44:45], v9, 57344
T v[46:47], v9, 59392
WL 8
M v[24:27], v[60:63], v[116:119], v[24:27]
buffer_load_dwordx4 v[100:103], v3, s[12:15], s81 offen offset:1024 sc1
T v[48:49], v6, 61440
T v[50:51], v6, 63488
WL 8
M v[12:15], v[32:35], v[120:123], v[12:15]
T v[52:53], v7, 61440
T v[54:55], v7, 63488
WL 8
M v[16:19], v[36:39], v[120:123], v[16:19]
buffer_load_dwordx4 v[104:107], v3, s[12:15], s81 offen offset:2048 sc1
T v[56:57], v8, 61440
T v[58:59], v8, 63488
WL 8
M v[20:23], v[40:43], v[120:123], v[20:23]
T v[60:61], v9, 61440
T v[62:63], v9, 63488
WL 8
M v[24:27], v[44:47], v[120:123], v[24:27]
buffer_load_dwordx4 v[108:111], v3, s[12:15], s81 offen offset:3072 sc1
s_cmp_lg_u32 s28, 0
s_cbranch_scc1 L_np4
s_add_u32 s83, s78, 9
s_and_b32 s83, s83, 31
s_lshr_b32 s83, s83, 1
s_mov_b32 s86, 0
L_pc10:
s_lshr_b32 s84, s85, s83
s_and_b32 s84, s84, 1
s_cbranch_scc1 L_pd10
s_mov_b64 exec, 3
buffer_load_dword v31, v30, s[20:23], 0 offen sc1
s_waitcnt vmcnt(0)
s_mov_b64 exec, -1
v_readlane_b32 s84, v31, 0
v_readlane_b32 s85, v31, 1
s_and_b32 s85, s85, s84
s_sleep 1
s_add_u32 s86, s86, 1
s_cmp_lt_u32 s86, 0x400000
s_cbranch_scc1 L_pc10
L_pd10:
L_np4:
s_barrier
v_add_u32 v6, 65536, v6
v_add_u32 v7, 65536, v7
v_add_u32 v8, 65536, v8
v_add_u32 v9, 65536, v9
T v[32:33], v6, 0
T v[34:35], v6, 2048
WL 8
M v[12:15], v[48:51], v[124:127], v[12:15]
T v[36:37], v7, 0
T v[38:39], v7, 2048
WL 8
M v[16:19], v[52:55], v[124:127], v[16:19]
s_add_u32 s80, s78, 11
s_and_b32 s80, s80, 31
s_mul_i32 s80, s80, 114688
s_add_u32 s80, s80, s30
s_add_u32 m0, s31, 32768
s_add_u32 s32, s80, 0
buffer_load_dwordx4 v2, s[8:11], s32 offen lds
T v[40:41], v8, 0
T v[42:43], v8, 2048
WL 8
M v[20:23], v[56:59], v[124:127], v[20:23]
T v[44:45], v9, 0
T v[46:47], v9, 2048
WL 8
M v[24:27], v[60:63], v[124:127], v[24:27]
s_add_u32 m0, s31, 33792
s_add_u32 s32, s80, 7168
buffer_load_dwordx4 v2, s[8:11], s32 offen lds
T v[48:49], v6, 4096
T v[50:51], v6, 6144
s_waitcnt vmcnt(38)
WL 8
M v[12:15], v[32:35], v[128:131], v[12:15]
T v[52:53], v7, 4096
T v[54:55], v7, 6144
WL 8
M v[16:19], v[36:39], v[128:131], v[16:19]
s_add_u32 m0, s31, 34816
s_add_u32 s32, s80, 14336
buffer_load_dwordx4 v2, s[8:11], s32 offen lds
T v[56:57], v8, 4096
T v[58:59], v8, 6144
WL 8
M v[20:23], v[40:43], v[128:131], v[20:23]
T v[60:61], v9, 4096
T v[62:63], v9, 6144
WL 8
M v[24:27], v[44:47], v[128:131], v[24:27]
s_add_u32 m0, s31, 35840
s_add_u32 s32, s80, 21504
buffer_load_dwordx4 v2, s[8:11], s32 offen lds
T v[32:33], v6, 8192
T v[34:35], v6, 10240
WL 8
M v[12:15], v[48:51], v[132:135], v[12:15]
T v[36:37], v7, 8192
T v[38:39], v7, 10240
WL 8
M v[16:19], v[52:55], v[132:135], v[16:19]
s_add_u32 s81, s78, 9
s_and_b32 s81, s81, 31
s_lshl_b32 s81, s81, 12
buffer_load_dwordx4 v[112:115], v3, s[12:15], s81 offen offset:0 sc1
T v[40:41], v8, 8192
T v[42:43], v8, 10240
WL 8
M v[20:23], v[56:59], v[132:135], v[20:23]
T v[44:45], v9, 8192
T v[46:47], v9, 10240
WL 8
M v[24:27], v[60:63], v[132:135], v[24:27]
buffer_load_dwordx4 v[116:119], v3, s[12:15], s81 offen offset:1024 sc1
T v[48:49], v6, 12288
T v[50:51], v6, 14336
WL 8
M v[12:15], v[32:35], v[136:139], v[12:15]
T v[52:53], v7, 12288
T v[54:55], v7, 14336
WL 8
M v[16:19], v[36:39], v[136:139], v[16:19]
buffer_load_dwordx4 v[120:123], v3, s[12:15], s81 offen offset:2048 sc1
T v[56:57], v8, 12288
T v[58:59], v8, 14336
WL 8
M v[20:23], v[40:43], v[136:139], v[20:23]
T v[60:61], v9, 12288
T v[62:63], v9, 14336
WL 8
M v[24:27], v[44:47], v[136:139], v[24:27]
buffer_load_dwordx4 v[124:127], v3, s[12:15], s81 offen offset:3072 sc1
s_cmp_lg_u32 s28, 0
s_cbranch_scc1 L_np5
s_add_u32 s83, s78, 10
s_and_b32 s83, s83, 31
s_lshr_b32 s83, s83, 1
s_mov_b32 s86, 0
L_pc11:
s_lshr_b32 s84, s85, s83
s_and_b32 s84, s84, 1
s_cbranch_scc1 L_pd11
s_mov_b64 exec, 3
buffer_load_dword v31, v30, s[20:23], 0 offen sc1
s_waitcnt vmcnt(0)
s_mov_b64 exec, -1
v_readlane_b32 s84, v31, 0
v_readlane_b32 s85, v31, 1
s_and_b32 s85, s85, s84
s_sleep 1
s_add_u32 s86, s86, 1
s_cmp_lt_u32 s86, 0x400000
s_cbranch_scc1 L_pc11
L_pd11:
L_np5:
s_barrier
T v[32:33], v6, 16384
T v[34:35], v6, 18432
WL 8
M v[12:15], v[48:51], v[140:143], v[12:15]
T v[36:37], v7, 16384
T v[38:39], v7, 18432
WL 8
M v[16:19], v[52:55], v[140:143], v[16:19]
s_add_u32 s80, s78, 12
s_and_b32 s80, s80, 31
s_mul_i32 s80, s80, 114688
s_add_u32 s80, s80, s30
s_add_u32 m0, s31, 49152
s_add_u32 s32, s80, 0
buffer_load_dwordx4 v2, s[8:11], s32 offen lds
T v[40:41], v8, 16384
T v[42:43], v8, 18432
WL 8
M v[20:23], v[56:59], v[140:143], v[20:23]
T v[44:45], v9, 16384
T v[46:47], v9, 18432
WL 8
M v[24:27], v[60:63], v[140:143], v[24:27]
s_add_u32 m0, s31, 50176
s_add_u32 s32, s80, 7168
buffer_load_dwordx4 v2, s[8:11], s32 offen lds
T v[48:49], v6, 20480
T v[50:51], v6, 22528
s_waitcnt vmcnt(42)
WL 8
M v[12:15], v[32:35], v[144:147], v[12:15]
T v[52:53], v7, 20480
T v[54:55], v7, 22528
WL 8
M v[16:19], v[36:39], v[144:147], v[16:19]
s_add_u32 m0, s31, 51200
s_add_u32 s32, s80, 14336
buffer_load_dwordx4 v2, s[8:11], s32 offen lds
T v[56:57], v8, 20480
T v[58:59], v8, 22528
WL 8
M v[20:23], v[40:43], v[144:147], v[20:23]
T v[60:61], v9, 20480
T v[62:63], v9, 22528
WL 8
M v[24:27], v[44:47], v[144:147], v[24:27]
s_add_u32 m0, s31, 52224
s_add_u32 s32, s80, 21504
buffer_load_dwordx4 v2, s[8:11], s32 offen lds
T v[32:33], v6, 24576
T v[34:35], v6, 26624
WL 8
M v[12:15], v[48:51], v[148:151], v[12:15]
T v[36:37], v7, 24576
T v[38:39], v7, 26624
WL 8
M v[16:19], v[52:55], v[148:151], v[16:19]
s_add_u32 s81, s78, 10
s_and_b32 s81, s81, 31
s_lshl_b32 s81, s81, 12
buffer_load_dwordx4 v[128:131], v3, s[12:15], s81 offen offset:0 sc1
T v[40:41], v8, 24576
T v[42:43], v8, 26624
WL 8
M v[20:23], v[56:59], v[148:151], v[20:23]
T v[44:45], v9, 24576
T v[46:47], v9, 26624
WL 8
M v[24:27], v[60:63], v[148:151], v[24:27]
buffer_load_dwordx4 v[132:135], v3, s[12:15], s81 offen offset:1024 sc1
T v[48:49], v6, 28672
T v[50:51], v6, 30720
WL 8
M v[12:15], v[32:35], v[152:155], v[12:15]
T v[52:53], v7, 28672
T v[54:55], v7, 30720
WL 8
M v[16:19], v[36:39], v[152:155], v[16:19]
buffer_load_dwordx4 v[136:139], v3, s[12:15], s81 offen offset:2048 sc1
T v[56:57], v8, 28672
T v[58:59], v8, 30720
WL 8
M v[20:23], v[40:43], v[152:155], v[20:23]
T v[60:61], v9, 28672
T v[62:63], v9, 30720
WL 8
M v[24:27], v[44:47], v[152:155], v[24:27]
buffer_load_dwordx4 v[140:143], v3, s[12:15], s81 offen offset:3072 sc1
s_cmp_lg_u32 s28, 0
s_cbranch_scc1 L_np6
s_add_u32 s83, s78, 11
s_and_b32 s83, s83, 31
s_lshr_b32 s83, s83, 1
s_mov_b32 s86, 0
L_pc12:
s_lshr_b32 s84, s85, s83
s_and_b32 s84, s84, 1
s_cbranch_scc1 L_pd12
s_mov_b64 exec, 3
buffer_load_dword v31, v30, s[20:23], 0 offen sc1
s_waitcnt vmcnt(0)
s_mov_b64 exec, -1
v_readlane_b32 s84, v31, 0
v_readlane_b32 s85, v31, 1
s_and_b32 s85, s85, s84
s_sleep 1
s_add_u32 s86, s86, 1
s_cmp_lt_u32 s86, 0x400000
s_cbranch_scc1 L_pc12
L_pd12:
L_np6:
s_waitcnt vmcnt(44)
s_barrier
T v[32:33], v6, 32768
T v[34:35], v6, 34816
WL 8
M v[12:15], v[48:51], v[156:159], v[12:15]
T v[36:37], v7, 32768
T v[38:39], v7, 34816
WL 8
M v[16:19], v[52:55], v[156:159], v[16:19]
s_add_u32 s80, s78, 13
s_and_b32 s80, s80, 31
s_mul_i32 s80, s80, 114688
s_add_u32 s80, s80, s30
s_add_u32 m0, s31, 65536
s_add_u32 s32, s80, 0
buffer_load_dwordx4 v2, s[8:11], s32 offen lds
T v[40:41], v8, 32768
T v[42:43], v8, 34816
WL 8
M v[20:23], v[56:59], v[156:159], v[20:23]
T v[44:45], v9, 32768
T v[46:47], v9, 34816
WL 8
M v[24:27], v[60:63], v[156:159], v[24:27]
s_add_u32 m0, s31, 66560
s_add_u32 s32, s80, 7168
buffer_load_dwordx4 v2, s[8:11], s32 offen lds
T v[48:49], v6, 36864
T v[50:51], v6, 38912
s_waitcnt vmcnt(34)
WL 8
M v[12:15], v[32:35], v[64:67], v[12:15]
T v[52:53], v7, 36864
T v[54:55], v7, 38912
WL 8
M v[16:19], v[36:39], v[64:67], v[16:19]
s_add_u32 m0, s31, 67584
s_add_u32 s32, s80, 14336
buffer_load_dwordx4 v2, s[8:11], s32 offen lds
T v[56:57], v8, 36864
T v[58:59], v8, 38912
WL 8
M v[20:23], v[40:43], v[64:67], v[20:23]
T v[60:61], v9, 36864
T v[62:63], v9, 38912
WL 8
M v[24:27], v[44:47], v[64:67], v[24:27]
s_add_u32 m0, s31, 68608
s_add_u32 s32, s80, 21504
buffer_load_dwordx4 v2, s[8:11], s32 offen lds
T v[32:33], v6, 40960
T v[34:35], v6, 43008
WL 8
M v[12:15], v[48:51], v[68:71], v[12:15]
T v[36:37], v7, 40960
T v[38:39], v7, 43008
WL 8
M v[16:19], v[52:55], v[68:71], v[16:19]
s_add_u32 s81, s78, 11
s_and_b32 s81, s81, 31
s_lshl_b32 s81, s81, 12
buffer_load_dwordx4 v[144:147], v3, s[12:15], s81 offen offset:0 sc1
T v[40:41], v8, 40960
T v[42:43], v8, 43008
WL 8
M v[20:23], v[56:59], v[68:71], v[20:23]
T v[44:45], v9, 40960
T v[46:47], v9, 43008
WL 8
M v[24:27], v[60:63], v[68:71], v[24:27]
buffer_load_dwordx4 v[148:151], v3, s[12:15], s81 offen offset:1024 sc1
T v[48:49], v6, 45056
T v[50:51], v6, 47104
WL 8
M v[12:15], v[32:35], v[72:75], v[12:15]
T v[52:53], v7, 45056
T v[54:55], v7, 47104
WL 8
M v[16:19], v[36:39], v[72:75], v[16:19]
buffer_load_dwordx4 v[152:155], v3, s[12:15], s81 offen offset:2048 sc1
T v[56:57], v8, 45056
T v[58:59], v8, 47104
WL 8
M v[20:23], v[40:43], v[72:75], v[20:23]
T v[60:61], v9, 45056
T v[62:63], v9, 47104
WL 8
M v[24:27], v[44:47], v[72:75], v[24:27]
buffer_load_dwordx4 v[156:159], v3, s[12:15], s81 offen offset:3072 sc1
s_cmp_lg_u32 s28, 0
s_cbranch_scc1 L_np7
s_add_u32 s83, s78, 12
s_and_b32 s83, s83, 31
s_lshr_b32 s83, s83, 1
s_mov_b32 s86, 0
L_pc13:
s_lshr_b32 s84, s85, s83
s_and_b32 s84, s84, 1
s_cbranch_scc1 L_pd13
s_mov_b64 exec, 3
buffer_load_dword v31, v30, s[20:23], 0 offen sc1
s_waitcnt vmcnt(0)
s_mov_b64 exec, -1
v_readlane_b32 s84, v31, 0
v_readlane_b32 s85, v31, 1
s_and_b32 s85, s85, s84
s_sleep 1
s_add_u32 s86, s86, 1
s_cmp_lt_u32 s86, 0x400000
s_cbranch_scc1 L_pc13
L_pd13:
L_np7:
s_barrier
T v[32:33], v6, 49152
T v[34:35], v6, 51200
WL 8
M v[12:15], v[48:51], v[76:79], v[12:15]
T v[36:37], v7, 49152
T v[38:39], v7, 51200
WL 8
M v[16:19], v[52:55], v[76:79], v[16:19]
s_add_u32 s80, s78, 14
s_and_b32 s80, s80, 31
s_mul_i32 s80, s80, 114688
s_add_u32 s80, s80, s30
s_add_u32 m0, s31, 81920
s_add_u32 s32, s80, 0
buffer_load_dwordx4 v2, s[8:11], s32 offen lds
T v[40:41], v8, 49152
T v[42:43], v8, 51200
WL 8
M v[20:23], v[56:59], v[76:79], v[20:23]
T v[44:45], v9, 49152
T v[46:47], v9, 51200
WL 8
M v[24:27], v[60:63], v[76:79], v[24:27]
s_add_u32 m0, s31, 82944
s_add_u32 s32, s80, 7168
buffer_load_dwordx4 v2, s[8:11], s32 offen lds
T v[48:49], v6, 53248
T v[50:51], v6, 55296
s_waitcnt vmcnt(34)
WL 8
M v[12:15], v[32:35], v[80:83], v[12:15]
T v[52:53], v7, 53248
T v[54:55], v7, 55296
WL 8
M v[16:19], v[36:39], v[80:83], v[16:19]
s_add_u32 m0, s31, 83968
s_add_u32 s32, s80, 14336
buffer_load_dwordx4 v2, s[8:11], s32 offen lds
T v[56:57], v8, 53248
T v[58:59], v8, 55296
WL 8
M v[20:23], v[40:43], v[80:83], v[20:23]
T v[60:61], v9, 53248
T v[62:63], v9, 55296
WL 8
M v[24:27], v[44:47], v[80:83], v[24:27]
s_add_u32 m0, s31, 84992
s_add_u32 s32, s80, 21504
buffer_load_dwordx4 v2, s[8:11], s32 offen lds
T v[32:33], v6, 57344
T v[34:35], v6, 59392
WL 8
M v[12:15], v[48:51], v[84:87], v[12:15]
T v[36:37], v7, 57344
T v[38:39], v7, 59392
WL 8
M v[16:19], v[52:55], v[84:87], v[16:19]
s_add_u32 s81, s78, 12
s_and_b32 s81, s81, 31
s_lshl_b32 s81, s81, 12
buffer_load_dwordx4 v[64:67], v3, s[12:15], s81 offen offset:0 sc1
T v[40:41], v8, 57344
T v[42:43], v8, 59392
WL 8
M v[20:23], v[56:59], v[84:87], v[20:23]
T v[44:45], v9, 57344
T v[46:47], v9, 59392
WL 8
M v[24:27], v[60:63], v[84:87], v[24:27]
buffer_load_dwordx4 v[68:71], v3, s[12:15], s81 offen offset:1024 sc1
T v[48:49], v6, 61440
T v[50:51], v6, 63488
WL 8
M v[12:15], v[32:35], v[88:91], v[12:15]
T v[52:53], v7, 61440
T v[54:55], v7, 63488
WL 8
M v[16:19], v[36:39], v[88:91], v[16:19]
buffer_load_dwordx4 v[72:75], v3, s[12:15], s81 offen offset:2048 sc1
T v[56:57], v8, 61440
T v[58:59], v8, 63488
WL 8
M v[20:23], v[40:43], v[88:91], v[20:23]
T v[60:61], v9, 61440
T v[62:63], v9, 63488
WL 8
M v[24:27], v[44:47], v[88:91], v[24:27]
buffer_load_dwordx4 v[76:79], v3, s[12:15], s81 offen offset:3072 sc1
s_cmp_lg_u32 s28, 0
s_cbranch_scc1 L_np8
s_add_u32 s83, s78, 13
s_and_b32 s83, s83, 31
s_lshr_b32 s83, s83, 1
s_mov_b32 s86, 0
L_pc14:
s_lshr_b32 s84, s85, s83
s_and_b32 s84, s84, 1
s_cbranch_scc1 L_pd14
s_mov_b64 exec, 3
buffer_load_dword v31, v30, s[20:23], 0 offen sc1
s_waitcnt vmcnt(0)
s_mov_b64 exec, -1
v_readlane_b32 s84, v31, 0
v_readlane_b32 s85, v31, 1
s_and_b32 s85, s85, s84
s_sleep 1
s_add_u32 s86, s86, 1
s_cmp_lt_u32 s86, 0x400000
s_cbranch_scc1 L_pc14
L_pd14:
L_np8:
s_barrier
v_add_u32 v6, 65536, v6
v_add_u32 v7, 65536, v7
v_add_u32 v8, 65536, v8
v_add_u32 v9, 65536, v9
T v[32:33], v6, 0
T v[34:35], v6, 2048
WL 8
M v[12:15], v[48:51], v[92:95], v[12:15]
T v[36:37], v7, 0
T v[38:39], v7, 2048
WL 8
M v[16:19], v[52:55], v[92:95], v[16:19]
s_add_u32 s80, s78, 15
s_and_b32 s80, s80, 31
s_mul_i32 s80, s80, 114688
s_add_u32 s80, s80, s30
s_add_u32 m0, s31, 98304
s_add_u32 s32, s80, 0
buffer_load_dwordx4 v2, s[8:11], s32 offen lds
T v[40:41], v8, 0
T v[42:43], v8, 2048
WL 8
M v[20:23], v[56:59], v[92:95], v[20:23]
T v[44:45], v9, 0
T v[46:47], v9, 2048
WL 8
M v[24:27], v[60:63], v[92:95], v[24:27]
s_add_u32 m0, s31, 99328
s_add_u32 s32, s80, 7168
buffer_load_dwordx4 v2, s[8:11], s32 offen lds
T v[48:49], v6, 4096
T v[50:51], v6, 6144
s_waitcnt vmcnt(34)
WL 8
M v[12:15], v[32:35], v[96:99], v[12:15]
T v[52:53], v7, 4096
T v[54:55], v7, 6144
WL 8
M v[16:19], v[36:39], v[96:99], v[16:19]
s_add_u32 m0, s31, 100352
s_add_u32 s32, s80, 14336
buffer_load_dwordx4 v2, s[8:11], s32 offen lds
T v[56:57], v8, 4096
T v[58:59], v8, 6144
WL 8
M v[20:23], v[40:43], v[96:99], v[20:23]
T v[60:61], v9, 4096
T v[62:63], v9, 6144
WL 8
M v[24:27], v[44:47], v[96:99], v[24:27]
s_add_u32 m0, s31, 101376
s_add_u32 s32, s80, 21504
buffer_load_dwordx4 v2, s[8:11], s32 offen lds
T v[32:33], v6, 8192
T v[34:35], v6, 10240
WL 8
M v[12:15], v[48:51], v[100:103], v[12:15]
T v[36:37], v7, 8192
T v[38:39], v7, 10240
WL 8
M v[16:19], v[52:55], v[100:103], v[16:19]
s_add_u32 s81, s78, 13
s_and_b32 s81, s81, 31
s_lshl_b32 s81, s81, 12
buffer_load_dwordx4 v[80:83], v3, s[12:15], s81 offen offset:0 sc1
T v[40:41], v8, 8192
T v[42:43], v8, 10240
WL 8
M v[20:23], v[56:59], v[100:103], v[20:23]
T v[44:45], v9, 8192
T v[46:47], v9, 10240
WL 8
M v[24:27], v[60:63], v[100:103], v[24:27]
buffer_load_dwordx4 v[84:87], v3, s[12:15], s81 offen offset:1024 sc1
T v[48:49], v6, 12288
T v[50:51], v6, 14336
WL 8
M v[12:15], v[32:35], v[104:107], v[12:15]
T v[52:53], v7, 12288
T v[54:55], v7, 14336
WL 8
M v[16:19], v[36:39], v[104:107], v[16:19]
buffer_load_dwordx4 v[88:91], v3, s[12:15], s81 offen offset:2048 sc1
T v[56:57], v8, 12288
T v[58:59], v8, 14336
WL 8
M v[20:23], v[40:43], v[104:107], v[20:23]
T v[60:61], v9, 12288
T v[62:63], v9, 14336
WL 8
M v[24:27], v[44:47], v[104:107], v[24:27]
buffer_load_dwordx4 v[92:95], v3, s[12:15], s81 offen offset:3072 sc1
s_cmp_lg_u32 s28, 0
s_cbranch_scc1 L_np9
s_add_u32 s83, s78, 14
s_and_b32 s83, s83, 31
s_lshr_b32 s83, s83, 1
s_mov_b32 s86, 0
L_pc15:
s_lshr_b32 s84, s85, s83
s_and_b32 s84, s84, 1
s_cbranch_scc1 L_pd15
s_mov_b64 exec, 3
buffer_load_dword v31, v30, s[20:23], 0 offen sc1
s_waitcnt vmcnt(0)
s_mov_b64 exec, -1
v_readlane_b32 s84, v31, 0
v_readlane_b32 s85, v31, 1
s_and_b32 s85, s85, s84
s_sleep 1
s_add_u32 s86, s86, 1
s_cmp_lt_u32 s86, 0x400000
s_cbranch_scc1 L_pc15
L_pd15:
L_np9:
s_barrier
v_add_u32 v6, 4294836224, v6
v_add_u32 v7, 4294836224, v7
v_add_u32 v8, 4294836224, v8
v_add_u32 v9, 4294836224, v9
T v[32:33], v6, 0
T v[34:35], v6, 2048
WL 8
M v[12:15], v[48:51], v[108:111], v[12:15]
T v[36:37], v7, 0
T v[38:39], v7, 2048
WL 8
M v[16:19], v[52:55], v[108:111], v[16:19]
s_add_u32 s80, s78, 16
s_and_b32 s80, s80, 31
s_mul_i32 s80, s80, 114688
s_add_u32 s80, s80, s30
s_add_u32 m0, s31, 114688
s_add_u32 s32, s80, 0
buffer_load_dwordx4 v2, s[8:11], s32 offen lds
T v[40:41], v8, 0
T v[42:43], v8, 2048
WL 8
M v[20:23], v[56:59], v[108:111], v[20:23]
T v[44:45], v9, 0
T v[46:47], v9, 2048
WL 8
M v[24:27], v[60:63], v[108:111], v[24:27]
s_add_u32 m0, s31, 115712
s_add_u32 s32, s80, 7168
buffer_load_dwordx4 v2, s[8:11], s32 offen lds
T v[48:49], v6, 4096
T v[50:51], v6, 6144
s_waitcnt vmcnt(34)
WL 8
M v[12:15], v[32:35], v[112:115], v[12:15]
T v[52:53], v7, 4096
T v[54:55], v7, 6144
WL 8
M v[16:19], v[36:39], v[112:115], v[16:19]
s_add_u32 m0, s31, 116736
s_add_u32 s32, s80, 14336
buffer_load_dwordx4 v2, s[8:11], s32 offen lds
T v[56:57], v8, 4096
T v[58:59], v8, 6144
WL 8
M v[20:23], v[40:43], v[112:115], v[20:23]
T v[60:61], v9, 4096
T v[62:63], v9, 6144
WL 8
M v[24:27], v[44:47], v[112:115], v[24:27]
s_add_u32 m0, s31, 117760
s_add_u32 s32, s80, 21504
buffer_load_dwordx4 v2, s[8:11], s32 offen lds
T v[32:33], v6, 8192
T v[34:35], v6, 10240
WL 8
M v[12:15], v[48:51], v[116:119], v[12:15]
T v[36:37], v7, 8192
T v[38:39], v7, 10240
WL 8
M v[16:19], v[52:55], v[116:119], v[16:19]
s_add_u32 s81, s78, 14
s_and_b32 s81, s81, 31
s_lshl_b32 s81, s81, 12
buffer_load_dwordx4 v[96:99], v3, s[12:15], s81 offen offset:0 sc1
T v[40:41], v8, 8192
T v[42:43], v8, 10240
WL 8
M v[20:23], v[56:59], v[116:119], v[20:23]
T v[44:45], v9, 8192
T v[46:47], v9, 10240
WL 8
M v[24:27], v[60:63], v[116:119], v[24:27]
buffer_load_dwordx4 v[100:103], v3, s[12:15], s81 offen offset:1024 sc1
T v[48:49], v6, 12288
T v[50:51], v6, 14336
WL 8
M v[12:15], v[32:35], v[120:123], v[12:15]
T v[52:53], v7, 12288
T v[54:55], v7, 14336
WL 8
M v[16:19], v[36:39], v[120:123], v[16:19]
buffer_load_dwordx4 v[104:107], v3, s[12:15], s81 offen offset:2048 sc1
T v[56:57], v8, 12288
T v[58:59], v8, 14336
WL 8
M v[20:23], v[40:43], v[120:123], v[20:23]
T v[60:61], v9, 12288
T v[62:63], v9, 14336
WL 8
M v[24:27], v[44:47], v[120:123], v[24:27]
buffer_load_dwordx4 v[108:111], v3, s[12:15], s81 offen offset:3072 sc1
s_cmp_lg_u32 s28, 0
s_cbranch_scc1 L_np10
s_add_u32 s83, s78, 15
s_and_b32 s83, s83, 31
s_lshr_b32 s83, s83, 1
s_mov_b32 s86, 0
L_pc16:
s_lshr_b32 s84, s85, s83
s_and_b32 s84, s84, 1
s_cbranch_scc1 L_pd16
s_mov_b64 exec, 3
buffer_load_dword v31, v30, s[20:23], 0 offen sc1
s_waitcnt vmcnt(0)
s_mov_b64 exec, -1
v_readlane_b32 s84, v31, 0
v_readlane_b32 s85, v31, 1
s_and_b32 s85, s85, s84
s_sleep 1
s_add_u32 s86, s86, 1
s_cmp_lt_u32 s86, 0x400000
s_cbranch_scc1 L_pc16
L_pd16:
L_np10:
s_barrier
T v[32:33], v6, 16384
T v[34:35], v6, 18432
WL 8
M v[12:15], v[48:51], v[124:127], v[12:15]
T v[36:37], v7, 16384
T v[38:39], v7, 18432
WL 8
M v[16:19], v[52:55], v[124:127], v[16:19]
s_add_u32 s80, s78, 17
s_and_b32 s80, s80, 31
s_mul_i32 s80, s80, 114688
s_add_u32 s80, s80, s30
s_add_u32 m0, s31, 131072
s_add_u32 s32, s80, 0
buffer_load_dwordx4 v2, s[8:11], s32 offen lds
T v[40:41], v8, 16384
T v[42:43], v8, 18432
WL 8
M v[20:23], v[56:59], v[124:127], v[20:23]
T v[44:45], v9, 16384
T v[46:47], v9, 18432
WL 8
M v[24:27], v[60:63], v[124:127], v[24:27]
s_add_u32 m0, s31, 132096
s_add_u32 s32, s80, 7168
buffer_load_dwordx4 v2, s[8:11], s32 offen lds
T v[48:49], v6, 20480
T v[50:51], v6, 22528
s_waitcnt vmcnt(34)
WL 8
M v[12:15], v[32:35], v[128:131], v[12:15]
T v[52:53], v7, 20480
T v[54:55], v7, 22528
WL 8
M v[16:19], v[36:39], v[128:131], v[16:19]
s_add_u32 m0, s31, 133120
s_add_u32 s32, s80, 14336
buffer_load_dwordx4 v2, s[8:11], s32 offen lds
T v[56:57], v8, 20480
T v[58:59], v8, 22528
WL 8
M v[20:23], v[40:43], v[128:131], v[20:23]
T v[60:61], v9, 20480
T v[62:63], v9, 22528
WL 8
M v[24:27], v[44:47], v[128:131], v[24:27]
s_add_u32 m0, s31, 134144
s_add_u32 s32, s80, 21504
buffer_load_dwordx4 v2, s[8:11], s32 offen lds
T v[32:33], v6, 24576
T v[34:35], v6, 26624
WL 8
M v[12:15], v[48:51], v[132:135], v[12:15]
T v[36:37], v7, 24576
T v[38:39], v7, 26624
WL 8
M v[16:19], v[52:55], v[132:135], v[16:19]
s_add_u32 s81, s78, 15
s_and_b32 s81, s81, 31
s_lshl_b32 s81, s81, 12
buffer_load_dwordx4 v[112:115], v3, s[12:15], s81 offen offset:0 sc1
T v[40:41], v8, 24576
T v[42:43], v8, 26624
WL 8
M v[20:23], v[56:59], v[132:135], v[20:23]
T v[44:45], v9, 24576
T v[46:47], v9, 26624
WL 8
M v[24:27], v[60:63], v[132:135], v[24:27]
buffer_load_dwordx4 v[116:119], v3, s[12:15], s81 offen offset:1024 sc1
T v[48:49], v6, 28672
T v[50:51], v6, 30720
WL 8
M v[12:15], v[32:35], v[136:139], v[12:15]
T v[52:53], v7, 28672
T v[54:55], v7, 30720
WL 8
M v[16:19], v[36:39], v[136:139], v[16:19]
buffer_load_dwordx4 v[120:123], v3, s[12:15], s81 offen offset:2048 sc1
T v[56:57], v8, 28672
T v[58:59], v8, 30720
WL 8
M v[20:23], v[40:43], v[136:139], v[20:23]
T v[60:61], v9, 28672
T v[62:63], v9, 30720
WL 8
M v[24:27], v[44:47], v[136:139], v[24:27]
buffer_load_dwordx4 v[124:127], v3, s[12:15], s81 offen offset:3072 sc1
s_cmp_lg_u32 s28, 0
s_cbranch_scc1 L_np11
s_add_u32 s83, s78, 16
s_and_b32 s83, s83, 31
s_lshr_b32 s83, s83, 1
s_mov_b32 s86, 0
L_pc17:
s_lshr_b32 s84, s85, s83
s_and_b32 s84, s84, 1
s_cbranch_scc1 L_pd17
s_mov_b64 exec, 3
buffer_load_dword v31, v30, s[20:23], 0 offen sc1
s_waitcnt vmcnt(0)
s_mov_b64 exec, -1
v_readlane_b32 s84, v31, 0
v_readlane_b32 s85, v31, 1
s_and_b32 s85, s85, s84
s_sleep 1
s_add_u32 s86, s86, 1
s_cmp_lt_u32 s86, 0x400000
s_cbranch_scc1 L_pc17
L_pd17:
L_np11:
s_barrier
T v[32:33], v6, 32768
T v[34:35], v6, 34816
WL 8
M v[12:15], v[48:51], v[140:143], v[12:15]
T v[36:37], v7, 32768
T v[38:39], v7, 34816
WL 8
M v[16:19], v[52:55], v[140:143], v[16:19]
s_add_u32 s80, s78, 18
s_and_b32 s80, s80, 31
s_mul_i32 s80, s80, 114688
s_add_u32 s80, s80, s30
s_add_u32 m0, s31, 0
s_add_u32 s32, s80, 0
buffer_load_dwordx4 v2, s[8:11], s32 offen lds
T v[40:41], v8, 32768
T v[42:43], v8, 34816
WL 8
M v[20:23], v[56:59], v[140:143], v[20:23]
T v[44:45], v9, 32768
T v[46:47], v9, 34816
WL 8
M v[24:27], v[60:63], v[140:143], v[24:27]
s_add_u32 m0, s31, 1024
s_add_u32 s32, s80, 7168
buffer_load_dwordx4 v2, s[8:11], s32 offen lds
T v[48:49], v6, 36864
T v[50:51], v6, 38912
s_waitcnt vmcnt(34)
WL 8
M v[12:15], v[32:35], v[144:147], v[12:15]
T v[52:53], v7, 36864
T v[54:55], v7, 38912
WL 8
M v[16:19], v[36:39], v[144:147], v[16:19]
s_add_u32 m0, s31, 2048
s_add_u32 s32, s80, 14336
buffer_load_dwordx4 v2, s[8:11], s32 offen lds
T v[56:57], v8, 36864
T v[58:59], v8, 38912
WL 8
M v[20:23], v[40:43], v[144:147], v[20:23]
T v[60:61], v9, 36864
T v[62:63], v9, 38912
WL 8
M v[24:27], v[44:47], v[144:147], v[24:27]
s_add_u32 m0, s31, 3072
s_add_u32 s32, s80, 21504
buffer_load_dwordx4 v2, s[8:11], s32 offen lds
T v[32:33], v6, 40960
T v[34:35], v6, 43008
WL 8
M v[12:15], v[48:51], v[148:151], v[12:15]
T v[36:37], v7, 40960
T v[38:39], v7, 43008
WL 8
M v[16:19], v[52:55], v[148:151], v[16:19]
s_add_u32 s81, s78, 16
s_and_b32 s81, s81, 31
s_lshl_b32 s81, s81, 12
buffer_load_dwordx4 v[128:131], v3, s[12:15], s81 offen offset:0 sc1
T v[40:41], v8, 40960
T v[42:43], v8, 43008
WL 8
M v[20:23], v[56:59], v[148:151], v[20:23]
T v[44:45], v9, 40960
T v[46:47], v9, 43008
WL 8
M v[24:27], v[60:63], v[148:151], v[24:27]
buffer_load_dwordx4 v[132:135], v3, s[12:15], s81 offen offset:1024 sc1
T v[48:49], v6, 45056
T v[50:51], v6, 47104
WL 8
M v[12:15], v[32:35], v[152:155], v[12:15]
T v[52:53], v7, 45056
T v[54:55], v7, 47104
WL 8
M v[16:19], v[36:39], v[152:155], v[16:19]
buffer_load_dwordx4 v[136:139], v3, s[12:15], s81 offen offset:2048 sc1
T v[56:57], v8, 45056
T v[58:59], v8, 47104
WL 8
M v[20:23], v[40:43], v[152:155], v[20:23]
T v[60:61], v9, 45056
T v[62:63], v9, 47104
WL 8
M v[24:27], v[44:47], v[152:155], v[24:27]
buffer_load_dwordx4 v[140:143], v3, s[12:15], s81 offen offset:3072 sc1
s_cmp_lg_u32 s28, 0
s_cbranch_scc1 L_np12
s_add_u32 s83, s78, 17
s_and_b32 s83, s83, 31
s_lshr_b32 s83, s83, 1
s_mov_b32 s86, 0
L_pc18:
s_lshr_b32 s84, s85, s83
s_and_b32 s84, s84, 1
s_cbranch_scc1 L_pd18
s_mov_b64 exec, 3
buffer_load_dword v31, v30, s[20:23], 0 offen sc1
s_waitcnt vmcnt(0)
s_mov_b64 exec, -1
v_readlane_b32 s84, v31, 0
v_readlane_b32 s85, v31, 1
s_and_b32 s85, s85, s84
s_sleep 1
s_add_u32 s86, s86, 1
s_cmp_lt_u32 s86, 0x400000
s_cbranch_scc1 L_pc18
L_pd18:
L_np12:
s_barrier
T v[32:33], v6, 49152
T v[34:35], v6, 51200
WL 8
M v[12:15], v[48:51], v[156:159], v[12:15]
T v[36:37], v7, 49152
T v[38:39], v7, 51200
WL 8
M v[16:19], v[52:55], v[156:159], v[16:19]
s_add_u32 s80, s78, 19
s_and_b32 s80, s80, 31
s_mul_i32 s80, s80, 114688
s_add_u32 s80, s80, s30
s_add_u32 m0, s31, 16384
s_add_u32 s32, s80, 0
buffer_load_dwordx4 v2, s[8:11], s32 offen lds
T v[40:41], v8, 49152
T v[42:43], v8, 51200
WL 8
M v[20:23], v[56:59], v[156:159], v[20:23]
T v[44:45], v9, 49152
T v[46:47], v9, 51200
WL 8
M v[24:27], v[60:63], v[156:159], v[24:27]
s_add_u32 m0, s31, 17408
s_add_u32 s32, s80, 7168
buffer_load_dwordx4 v2, s[8:11], s32 offen lds
T v[48:49], v6, 53248
T v[50:51], v6, 55296
s_waitcnt vmcnt(34)
WL 8
M v[12:15], v[32:35], v[64:67], v[12:15]
T v[52:53], v7, 53248
T v[54:55], v7, 55296
WL 8
M v[16:19], v[36:39], v[64:67], v[16:19]
s_add_u32 m0, s31, 18432
s_add_u32 s32, s80, 14336
buffer_load_dwordx4 v2, s[8:11], s32 offen lds
T v[56:57], v8, 53248
T v[58:59], v8, 55296
WL 8
M v[20:23], v[40:43], v[64:67], v[20:23]
T v[60:61], v9, 53248
T v[62:63], v9, 55296
WL 8
M v[24:27], v[44:47], v[64:67], v[24:27]
s_add_u32 m0, s31, 19456
s_add_u32 s32, s80, 21504
buffer_load_dwordx4 v2, s[8:11], s32 offen lds
T v[32:33], v6, 57344
T v[34:35], v6, 59392
WL 8
M v[12:15], v[48:51], v[68:71], v[12:15]
T v[36:37], v7, 57344
T v[38:39], v7, 59392
WL 8
M v[16:19], v[52:55], v[68:71], v[16:19]
s_add_u32 s81, s78, 17
s_and_b32 s81, s81, 31
s_lshl_b32 s81, s81, 12
buffer_load_dwordx4 v[144:147], v3, s[12:15], s81 offen offset:0 sc1
T v[40:41], v8, 57344
T v[42:43], v8, 59392
WL 8
M v[20:23], v[56:59], v[68:71], v[20:23]
T v[44:45], v9, 57344
T v[46:47], v9, 59392
WL 8
M v[24:27], v[60:63], v[68:71], v[24:27]
buffer_load_dwordx4 v[148:151], v3, s[12:15], s81 offen offset:1024 sc1
T v[48:49], v6, 61440
T v[50:51], v6, 63488
WL 8
M v[12:15], v[32:35], v[72:75], v[12:15]
T v[52:53], v7, 61440
T v[54:55], v7, 63488
WL 8
M v[16:19], v[36:39], v[72:75], v[16:19]
buffer_load_dwordx4 v[152:155], v3, s[12:15], s81 offen offset:2048 sc1
T v[56:57], v8, 61440
T v[58:59], v8, 63488
WL 8
M v[20:23], v[40:43], v[72:75], v[20:23]
T v[60:61], v9, 61440
T v[62:63], v9, 63488
WL 8
M v[24:27], v[44:47], v[72:75], v[24:27]
buffer_load_dwordx4 v[156:159], v3, s[12:15], s81 offen offset:3072 sc1
s_cmp_lg_u32 s28, 0
s_cbranch_scc1 L_np13
s_add_u32 s83, s78, 18
s_and_b32 s83, s83, 31
s_lshr_b32 s83, s83, 1
s_mov_b32 s86, 0
L_pc19:
s_lshr_b32 s84, s85, s83
s_and_b32 s84, s84, 1
s_cbranch_scc1 L_pd19
s_mov_b64 exec, 3
buffer_load_dword v31, v30, s[20:23], 0 offen sc1
s_waitcnt vmcnt(0)
s_mov_b64 exec, -1
v_readlane_b32 s84, v31, 0
v_readlane_b32 s85, v31, 1
s_and_b32 s85, s85, s84
s_sleep 1
s_add_u32 s86, s86, 1
s_cmp_lt_u32 s86, 0x400000
s_cbranch_scc1 L_pc19
L_pd19:
L_np13:
s_barrier
v_add_u32 v6, 65536, v6
v_add_u32 v7, 65536, v7
v_add_u32 v8, 65536, v8
v_add_u32 v9, 65536, v9
T v[32:33], v6, 0
T v[34:35], v6, 2048
WL 8
M v[12:15], v[48:51], v[76:79], v[12:15]
T v[36:37], v7, 0
T v[38:39], v7, 2048
WL 8
M v[16:19], v[52:55], v[76:79], v[16:19]
s_add_u32 s80, s78, 20
s_and_b32 s80, s80, 31
s_mul_i32 s80, s80, 114688
s_add_u32 s80, s80, s30
s_add_u32 m0, s31, 32768
s_add_u32 s32, s80, 0
buffer_load_dwordx4 v2, s[8:11], s32 offen lds
T v[40:41], v8, 0
T v[42:43], v8, 2048
WL 8
M v[20:23], v[56:59], v[76:79], v[20:23]
T v[44:45], v9, 0
T v[46:47], v9, 2048
WL 8
M v[24:27], v[60:63], v[76:79], v[24:27]
s_add_u32 m0, s31, 33792
s_add_u32 s32, s80, 7168
buffer_load_dwordx4 v2, s[8:11], s32 offen lds
T v[48:49], v6, 4096
T v[50:51], v6, 6144
s_waitcnt vmcnt(34)
WL 8
M v[12:15], v[32:35], v[80:83], v[12:15]
T v[52:53], v7, 4096
T v[54:55], v7, 6144
WL 8
M v[16:19], v[36:39], v[80:83], v[16:19]
s_add_u32 m0, s31, 34816
s_add_u32 s32, s80, 14336
buffer_load_dwordx4 v2, s[8:11], s32 offen lds
T v[56:57], v8, 4096
T v[58:59], v8, 6144
WL 8
M v[20:23], v[40:43], v[80:83], v[20:23]
T v[60:61], v9, 4096
T v[62:63], v9, 6144
WL 8
M v[24:27], v[44:47], v[80:83], v[24:27]
s_add_u32 m0, s31, 35840
s_add_u32 s32, s80, 21504
buffer_load_dwordx4 v2, s[8:11], s32 offen lds
T v[32:33], v6, 8192
T v[34:35], v6, 10240
WL 8
M v[12:15], v[48:51], v[84:87], v[12:15]
T v[36:37], v7, 8192
T v[38:39], v7, 10240
WL 8
M v[16:19], v[52:55], v[84:87], v[16:19]
s_add_u32 s81, s78, 18
s_and_b32 s81, s81, 31
s_lshl_b32 s81, s81, 12
buffer_load_dwordx4 v[64:67], v3, s[12:15], s81 offen offset:0 sc1
T v[40:41], v8, 8192
T v[42:43], v8, 10240
WL 8
M v[20:23], v[56:59], v[84:87], v[20:23]
T v[44:45], v9, 8192
T v[46:47], v9, 10240
WL 8
M v[24:27], v[60:63], v[84:87], v[24:27]
buffer_load_dwordx4 v[68:71], v3, s[12:15], s81 offen offset:1024 sc1
T v[48:49], v6, 12288
T v[50:51], v6, 14336
WL 8
M v[12:15], v[32:35], v[88:91], v[12:15]
T v[52:53], v7, 12288
T v[54:55], v7, 14336
WL 8
M v[16:19], v[36:39], v[88:91], v[16:19]
buffer_load_dwordx4 v[72:75], v3, s[12:15], s81 offen offset:2048 sc1
T v[56:57], v8, 12288
T v[58:59], v8, 14336
WL 8
M v[20:23], v[40:43], v[88:91], v[20:23]
T v[60:61], v9, 12288
T v[62:63], v9, 14336
WL 8
M v[24:27], v[44:47], v[88:91], v[24:27]
buffer_load_dwordx4 v[76:79], v3, s[12:15], s81 offen offset:3072 sc1
s_cmp_lg_u32 s28, 0
s_cbranch_scc1 L_np14
s_add_u32 s83, s78, 19
s_and_b32 s83, s83, 31
s_lshr_b32 s83, s83, 1
s_mov_b32 s86, 0
L_pc20:
s_lshr_b32 s84, s85, s83
s_and_b32 s84, s84, 1
s_cbranch_scc1 L_pd20
s_mov_b64 exec, 3
buffer_load_dword v31, v30, s[20:23], 0 offen sc1
s_waitcnt vmcnt(0)
s_mov_b64 exec, -1
v_readlane_b32 s84, v31, 0
v_readlane_b32 s85, v31, 1
s_and_b32 s85, s85, s84
s_sleep 1
s_add_u32 s86, s86, 1
s_cmp_lt_u32 s86, 0x400000
s_cbranch_scc1 L_pc20
L_pd20:
L_np14:
s_barrier
T v[32:33], v6, 16384
T v[34:35], v6, 18432
WL 8
M v[12:15], v[48:51], v[92:95], v[12:15]
T v[36:37], v7, 16384
T v[38:39], v7, 18432
WL 8
M v[16:19], v[52:55], v[92:95], v[16:19]
s_add_u32 s80, s78, 21
s_and_b32 s80, s80, 31
s_mul_i32 s80, s80, 114688
s_add_u32 s80, s80, s30
s_add_u32 m0, s31, 49152
s_add_u32 s32, s80, 0
buffer_load_dwordx4 v2, s[8:11], s32 offen lds
T v[40:41], v8, 16384
T v[42:43], v8, 18432
WL 8
M v[20:23], v[56:59], v[92:95], v[20:23]
T v[44:45], v9, 16384
T v[46:47], v9, 18432
WL 8
M v[24:27], v[60:63], v[92:95], v[24:27]
s_add_u32 m0, s31, 50176
s_add_u32 s32, s80, 7168
buffer_load_dwordx4 v2, s[8:11], s32 offen lds
T v[48:49], v6, 20480
T v[50:51], v6, 22528
s_waitcnt vmcnt(34)
WL 8
M v[12:15], v[32:35], v[96:99], v[12:15]
T v[52:53], v7, 20480
T v[54:55], v7, 22528
WL 8
M v[16:19], v[36:39], v[96:99], v[16:19]
s_add_u32 m0, s31, 51200
s_add_u32 s32, s80, 14336
buffer_load_dwordx4 v2, s[8:11], s32 offen lds
T v[56:57], v8, 20480
T v[58:59], v8, 22528
WL 8
M v[20:23], v[40:43], v[96:99], v[20:23]
T v[60:61], v9, 20480
T v[62:63], v9, 22528
WL 8
M v[24:27], v[44:47], v[96:99], v[24:27]
s_add_u32 m0, s31, 52224
s_add_u32 s32, s80, 21504
buffer_load_dwordx4 v2, s[8:11], s32 offen lds
T v[32:33], v6, 24576
T v[34:35], v6, 26624
WL 8
M v[12:15], v[48:51], v[100:103], v[12:15]
T v[36:37], v7, 24576
T v[38:39], v7, 26624
WL 8
M v[16:19], v[52:55], v[100:103], v[16:19]
s_add_u32 s81, s78, 19
s_and_b32 s81, s81, 31
s_lshl_b32 s81, s81, 12
buffer_load_dwordx4 v[80:83], v3, s[12:15], s81 offen offset:0 sc1
T v[40:41], v8, 24576
T v[42:43], v8, 26624
WL 8
M v[20:23], v[56:59], v[100:103], v[20:23]
T v[44:45], v9, 24576
T v[46:47], v9, 26624
WL 8
M v[24:27], v[60:63], v[100:103], v[24:27]
buffer_load_dwordx4 v[84:87], v3, s[12:15], s81 offen offset:1024 sc1
T v[48:49], v6, 28672
T v[50:51], v6, 30720
WL 8
M v[12:15], v[32:35], v[104:107], v[12:15]
T v[52:53], v7, 28672
T v[54:55], v7, 30720
WL 8
M v[16:19], v[36:39], v[104:107], v[16:19]
buffer_load_dwordx4 v[88:91], v3, s[12:15], s81 offen offset:2048 sc1
T v[56:57], v8, 28672
T v[58:59], v8, 30720
WL 8
M v[20:23], v[40:43], v[104:107], v[20:23]
T v[60:61], v9, 28672
T v[62:63], v9, 30720
WL 8
M v[24:27], v[44:47], v[104:107], v[24:27]
buffer_load_dwordx4 v[92:95], v3, s[12:15], s81 offen offset:3072 sc1
s_cmp_lg_u32 s28, 0
s_cbranch_scc1 L_np15
s_add_u32 s83, s78, 20
s_and_b32 s83, s83, 31
s_lshr_b32 s83, s83, 1
s_mov_b32 s86, 0
L_pc21:
s_lshr_b32 s84, s85, s83
s_and_b32 s84, s84, 1
s_cbranch_scc1 L_pd21
s_mov_b64 exec, 3
buffer_load_dword v31, v30, s[20:23], 0 offen sc1
s_waitcnt vmcnt(0)
s_mov_b64 exec, -1
v_readlane_b32 s84, v31, 0
v_readlane_b32 s85, v31, 1
s_and_b32 s85, s85, s84
s_sleep 1
s_add_u32 s86, s86, 1
s_cmp_lt_u32 s86, 0x400000
s_cbranch_scc1 L_pc21
L_pd21:
L_np15:
s_barrier
T v[32:33], v6, 32768
T v[34:35], v6, 34816
WL 8
M v[12:15], v[48:51], v[108:111], v[12:15]
T v[36:37], v7, 32768
T v[38:39], v7, 34816
WL 8
M v[16:19], v[52:55], v[108:111], v[16:19]
s_add_u32 s80, s78, 22
s_and_b32 s80, s80, 31
s_mul_i32 s80, s80, 114688
s_add_u32 s80, s80, s30
s_add_u32 m0, s31, 65536
s_add_u32 s32, s80, 0
buffer_load_dwordx4 v2, s[8:11], s32 offen lds
T v[40:41], v8, 32768
T v[42:43], v8, 34816
WL 8
M v[20:23], v[56:59], v[108:111], v[20:23]
T v[44:45], v9, 32768
T v[46:47], v9, 34816
WL 8
M v[24:27], v[60:63], v[108:111], v[24:27]
s_add_u32 m0, s31, 66560
s_add_u32 s32, s80, 7168
buffer_load_dwordx4 v2, s[8:11], s32 offen lds
T v[48:49], v6, 36864
T v[50:51], v6, 38912
s_waitcnt vmcnt(34)
WL 8
M v[12:15], v[32:35], v[112:115], v[12:15]
T v[52:53], v7, 36864
T v[54:55], v7, 38912
WL 8
M v[16:19], v[36:39], v[112:115], v[16:19]
s_add_u32 m0, s31, 67584
s_add_u32 s32, s80, 14336
buffer_load_dwordx4 v2, s[8:11], s32 offen lds
T v[56:57], v8, 36864
T v[58:59], v8, 38912
WL 8
M v[20:23], v[40:43], v[112:115], v[20:23]
T v[60:61], v9, 36864
T v[62:63], v9, 38912
WL 8
M v[24:27], v[44:47], v[112:115], v[24:27]
s_add_u32 m0, s31, 68608
s_add_u32 s32, s80, 21504
buffer_load_dwordx4 v2, s[8:11], s32 offen lds
T v[32:33], v6, 40960
T v[34:35], v6, 43008
WL 8
M v[12:15], v[48:51], v[116:119], v[12:15]
T v[36:37], v7, 40960
T v[38:39], v7, 43008
WL 8
M v[16:19], v[52:55], v[116:119], v[16:19]
s_add_u32 s81, s78, 20
s_and_b32 s81, s81, 31
s_lshl_b32 s81, s81, 12
buffer_load_dwordx4 v[96:99], v3, s[12:15], s81 offen offset:0 sc1
T v[40:41], v8, 40960
T v[42:43], v8, 43008
WL 8
M v[20:23], v[56:59], v[116:119], v[20:23]
T v[44:45], v9, 40960
T v[46:47], v9, 43008
WL 8
M v[24:27], v[60:63], v[116:119], v[24:27]
buffer_load_dwordx4 v[100:103], v3, s[12:15], s81 offen offset:1024 sc1
T v[48:49], v6, 45056
T v[50:51], v6, 47104
WL 8
M v[12:15], v[32:35], v[120:123], v[12:15]
T v[52:53], v7, 45056
T v[54:55], v7, 47104
WL 8
M v[16:19], v[36:39], v[120:123], v[16:19]
buffer_load_dwordx4 v[104:107], v3, s[12:15], s81 offen offset:2048 sc1
T v[56:57], v8, 45056
T v[58:59], v8, 47104
WL 8
M v[20:23], v[40:43], v[120:123], v[20:23]
T v[60:61], v9, 45056
T v[62:63], v9, 47104
WL 8
M v[24:27], v[44:47], v[120:123], v[24:27]
buffer_load_dwordx4 v[108:111], v3, s[12:15], s81 offen offset:3072 sc1
s_cmp_lg_u32 s28, 0
s_cbranch_scc1 L_np16
s_add_u32 s83, s78, 21
s_and_b32 s83, s83, 31
s_lshr_b32 s83, s83, 1
s_mov_b32 s86, 0
L_pc22:
s_lshr_b32 s84, s85, s83
s_and_b32 s84, s84, 1
s_cbranch_scc1 L_pd22
s_mov_b64 exec, 3
buffer_load_dword v31, v30, s[20:23], 0 offen sc1
s_waitcnt vmcnt(0)
s_mov_b64 exec, -1
v_readlane_b32 s84, v31, 0
v_readlane_b32 s85, v31, 1
s_and_b32 s85, s85, s84
s_sleep 1
s_add_u32 s86, s86, 1
s_cmp_lt_u32 s86, 0x400000
s_cbranch_scc1 L_pc22
L_pd22:
L_np16:
s_barrier
T v[32:33], v6, 49152
T v[34:35], v6, 51200
WL 8
M v[12:15], v[48:51], v[124:127], v[12:15]
T v[36:37], v7, 49152
T v[38:39], v7, 51200
WL 8
M v[16:19], v[52:55], v[124:127], v[16:19]
s_add_u32 s80, s78, 23
s_and_b32 s80, s80, 31
s_mul_i32 s80, s80, 114688
s_add_u32 s80, s80, s30
s_add_u32 m0, s31, 81920
s_add_u32 s32, s80, 0
buffer_load_dwordx4 v2, s[8:11], s32 offen lds
T v[40:41], v8, 49152
T v[42:43], v8, 51200
WL 8
M v[20:23], v[56:59], v[124:127], v[20:23]
T v[44:45], v9, 49152
T v[46:47], v9, 51200
WL 8
M v[24:27], v[60:63], v[124:127], v[24:27]
s_add_u32 m0, s31, 82944
s_add_u32 s32, s80, 7168
buffer_load_dwordx4 v2, s[8:11], s32 offen lds
T v[48:49], v6, 53248
T v[50:51], v6, 55296
s_waitcnt vmcnt(34)
WL 8
M v[12:15], v[32:35], v[128:131], v[12:15]
T v[52:53], v7, 53248
T v[54:55], v7, 55296
WL 8
M v[16:19], v[36:39], v[128:131], v[16:19]
s_add_u32 m0, s31, 83968
s_add_u32 s32, s80, 14336
buffer_load_dwordx4 v2, s[8:11], s32 offen lds
T v[56:57], v8, 53248
T v[58:59], v8, 55296
WL 8
M v[20:23], v[40:43], v[128:131], v[20:23]
T v[60:61], v9, 53248
T v[62:63], v9, 55296
WL 8
M v[24:27], v[44:47], v[128:131], v[24:27]
s_add_u32 m0, s31, 84992
s_add_u32 s32, s80, 21504
buffer_load_dwordx4 v2, s[8:11], s32 offen lds
T v[32:33], v6, 57344
T v[34:35], v6, 59392
WL 8
M v[12:15], v[48:51], v[132:135], v[12:15]
T v[36:37], v7, 57344
T v[38:39], v7, 59392
WL 8
M v[16:19], v[52:55], v[132:135], v[16:19]
s_add_u32 s81, s78, 21
s_and_b32 s81, s81, 31
s_lshl_b32 s81, s81, 12
buffer_load_dwordx4 v[112:115], v3, s[12:15], s81 offen offset:0 sc1
T v[40:41], v8, 57344
T v[42:43], v8, 59392
WL 8
M v[20:23], v[56:59], v[132:135], v[20:23]
T v[44:45], v9, 57344
T v[46:47], v9, 59392
WL 8
M v[24:27], v[60:63], v[132:135], v[24:27]
buffer_load_dwordx4 v[116:119], v3, s[12:15], s81 offen offset:1024 sc1
T v[48:49], v6, 61440
T v[50:51], v6, 63488
WL 8
M v[12:15], v[32:35], v[136:139], v[12:15]
T v[52:53], v7, 61440
T v[54:55], v7, 63488
WL 8
M v[16:19], v[36:39], v[136:139], v[16:19]
buffer_load_dwordx4 v[120:123], v3, s[12:15], s81 offen offset:2048 sc1
T v[56:57], v8, 61440
T v[58:59], v8, 63488
WL 8
M v[20:23], v[40:43], v[136:139], v[20:23]
T v[60:61], v9, 61440
T v[62:63], v9, 63488
WL 8
M v[24:27], v[44:47], v[136:139], v[24:27]
buffer_load_dwordx4 v[124:127], v3, s[12:15], s81 offen offset:3072 sc1
s_cmp_lg_u32 s28, 0
s_cbranch_scc1 L_np17
s_add_u32 s83, s78, 22
s_and_b32 s83, s83, 31
s_lshr_b32 s83, s83, 1
s_mov_b32 s86, 0
L_pc23:
s_lshr_b32 s84, s85, s83
s_and_b32 s84, s84, 1
s_cbranch_scc1 L_pd23
s_mov_b64 exec, 3
buffer_load_dword v31, v30, s[20:23], 0 offen sc1
s_waitcnt vmcnt(0)
s_mov_b64 exec, -1
v_readlane_b32 s84, v31, 0
v_readlane_b32 s85, v31, 1
s_and_b32 s85, s85, s84
s_sleep 1
s_add_u32 s86, s86, 1
s_cmp_lt_u32 s86, 0x400000
s_cbranch_scc1 L_pc23
L_pd23:
L_np17:
s_barrier
v_add_u32 v6, 65536, v6
v_add_u32 v7, 65536, v7
v_add_u32 v8, 65536, v8
v_add_u32 v9, 65536, v9
T v[32:33], v6, 0
T v[34:35], v6, 2048
WL 8
M v[12:15], v[48:51], v[140:143], v[12:15]
T v[36:37], v7, 0
T v[38:39], v7, 2048
WL 8
M v[16:19], v[52:55], v[140:143], v[16:19]
s_add_u32 s80, s78, 24
s_and_b32 s80, s80, 31
s_mul_i32 s80, s80, 114688
s_add_u32 s80, s80, s30
s_add_u32 m0, s31, 98304
s_add_u32 s32, s80, 0
buffer_load_dwordx4 v2, s[8:11], s32 offen lds
T v[40:41], v8, 0
T v[42:43], v8, 2048
WL 8
M v[20:23], v[56:59], v[140:143], v[20:23]
T v[44:45], v9, 0
T v[46:47], v9, 2048
WL 8
M v[24:27], v[60:63], v[140:143], v[24:27]
s_add_u32 m0, s31, 99328
s_add_u32 s32, s80, 7168
buffer_load_dwordx4 v2, s[8:11], s32 offen lds
T v[48:49], v6, 4096
T v[50:51], v6, 6144
s_waitcnt vmcnt(34)
WL 8
M v[12:15], v[32:35], v[144:147], v[12:15]
T v[52:53], v7, 4096
T v[54:55], v7, 6144
WL 8
M v[16:19], v[36:39], v[144:147], v[16:19]
s_add_u32 m0, s31, 100352
s_add_u32 s32, s80, 14336
buffer_load_dwordx4 v2, s[8:11], s32 offen lds
T v[56:57], v8, 4096
T v[58:59], v8, 6144
WL 8
M v[20:23], v[40:43], v[144:147], v[20:23]
T v[60:61], v9, 4096
T v[62:63], v9, 6144
WL 8
M v[24:27], v[44:47], v[144:147], v[24:27]
s_add_u32 m0, s31, 101376
s_add_u32 s32, s80, 21504
buffer_load_dwordx4 v2, s[8:11], s32 offen lds
T v[32:33], v6, 8192
T v[34:35], v6, 10240
WL 8
M v[12:15], v[48:51], v[148:151], v[12:15]
T v[36:37], v7, 8192
T v[38:39], v7, 10240
WL 8
M v[16:19], v[52:55], v[148:151], v[16:19]
s_add_u32 s81, s78, 22
s_and_b32 s81, s81, 31
s_lshl_b32 s81, s81, 12
buffer_load_dwordx4 v[128:131], v3, s[12:15], s81 offen offset:0 sc1
T v[40:41], v8, 8192
T v[42:43], v8, 10240
WL 8
M v[20:23], v[56:59], v[148:151], v[20:23]
T v[44:45], v9, 8192
T v[46:47], v9, 10240
WL 8
M v[24:27], v[60:63], v[148:151], v[24:27]
buffer_load_dwordx4 v[132:135], v3, s[12:15], s81 offen offset:1024 sc1
T v[48:49], v6, 12288
T v[50:51], v6, 14336
WL 8
M v[12:15], v[32:35], v[152:155], v[12:15]
T v[52:53], v7, 12288
T v[54:55], v7, 14336
WL 8
M v[16:19], v[36:39], v[152:155], v[16:19]
buffer_load_dwordx4 v[136:139], v3, s[12:15], s81 offen offset:2048 sc1
T v[56:57], v8, 12288
T v[58:59], v8, 14336
WL 8
M v[20:23], v[40:43], v[152:155], v[20:23]
T v[60:61], v9, 12288
T v[62:63], v9, 14336
WL 8
M v[24:27], v[44:47], v[152:155], v[24:27]
buffer_load_dwordx4 v[140:143], v3, s[12:15], s81 offen offset:3072 sc1
s_cmp_lg_u32 s28, 0
s_cbranch_scc1 L_np18
s_add_u32 s83, s78, 23
s_and_b32 s83, s83, 31
s_lshr_b32 s83, s83, 1
s_mov_b32 s86, 0
L_pc24:
s_lshr_b32 s84, s85, s83
s_and_b32 s84, s84, 1
s_cbranch_scc1 L_pd24
s_mov_b64 exec, 3
buffer_load_dword v31, v30, s[20:23], 0 offen sc1
s_waitcnt vmcnt(0)
s_mov_b64 exec, -1
v_readlane_b32 s84, v31, 0
v_readlane_b32 s85, v31, 1
s_and_b32 s85, s85, s84
s_sleep 1
s_add_u32 s86, s86, 1
s_cmp_lt_u32 s86, 0x400000
s_cbranch_scc1 L_pc24
L_pd24:
L_np18:
s_barrier
v_add_u32 v6, 4294836224, v6
v_add_u32 v7, 4294836224, v7
v_add_u32 v8, 4294836224, v8
v_add_u32 v9, 4294836224, v9
T v[32:33], v6, 0
T v[34:35], v6, 2048
WL 8
M v[12:15], v[48:51], v[156:159], v[12:15]
T v[36:37], v7, 0
T v[38:39], v7, 2048
WL 8
M v[16:19], v[52:55], v[156:159], v[16:19]
s_add_u32 s80, s78, 25
s_and_b32 s80, s80, 31
s_mul_i32 s80, s80, 114688
s_add_u32 s80, s80, s30
s_add_u32 m0, s31, 114688
s_add_u32 s32, s80, 0
buffer_load_dwordx4 v2, s[8:11], s32 offen lds
T v[40:41], v8, 0
T v[42:43], v8, 2048
WL 8
M v[20:23], v[56:59], v[156:159], v[20:23]
T v[44:45], v9, 0
T v[46:47], v9, 2048
WL 8
M v[24:27], v[60:63], v[156:159], v[24:27]
s_add_u32 m0, s31, 115712
s_add_u32 s32, s80, 7168
buffer_load_dwordx4 v2, s[8:11], s32 offen lds
T v[48:49], v6, 4096
T v[50:51], v6, 6144
s_waitcnt vmcnt(34)
WL 8
M v[12:15], v[32:35], v[64:67], v[12:15]
T v[52:53], v7, 4096
T v[54:55], v7, 6144
WL 8
M v[16:19], v[36:39], v[64:67], v[16:19]
s_add_u32 m0, s31, 116736
s_add_u32 s32, s80, 14336
buffer_load_dwordx4 v2, s[8:11], s32 offen lds
T v[56:57], v8, 4096
T v[58:59], v8, 6144
WL 8
M v[20:23], v[40:43], v[64:67], v[20:23]
T v[60:61], v9, 4096
T v[62:63], v9, 6144
WL 8
M v[24:27], v[44:47], v[64:67], v[24:27]
s_add_u32 m0, s31, 117760
s_add_u32 s32, s80, 21504
buffer_load_dwordx4 v2, s[8:11], s32 offen lds
T v[32:33], v6, 8192
T v[34:35], v6, 10240
WL 8
M v[12:15], v[48:51], v[68:71], v[12:15]
T v[36:37], v7, 8192
T v[38:39], v7, 10240
WL 8
M v[16:19], v[52:55], v[68:71], v[16:19]
s_add_u32 s81, s78, 23
s_and_b32 s81, s81, 31
s_lshl_b32 s81, s81, 12
buffer_load_dwordx4 v[144:147], v3, s[12:15], s81 offen offset:0 sc1
T v[40:41], v8, 8192
T v[42:43], v8, 10240
WL 8
M v[20:23], v[56:59], v[68:71], v[20:23]
T v[44:45], v9, 8192
T v[46:47], v9, 10240
WL 8
M v[24:27], v[60:63], v[68:71], v[24:27]
buffer_load_dwordx4 v[148:151], v3, s[12:15], s81 offen offset:1024 sc1
T v[48:49], v6, 12288
T v[50:51], v6, 14336
WL 8
M v[12:15], v[32:35], v[72:75], v[12:15]
T v[52:53], v7, 12288
T v[54:55], v7, 14336
WL 8
M v[16:19], v[36:39], v[72:75], v[16:19]
buffer_load_dwordx4 v[152:155], v3, s[12:15], s81 offen offset:2048 sc1
T v[56:57], v8, 12288
T v[58:59], v8, 14336
WL 8
M v[20:23], v[40:43], v[72:75], v[20:23]
T v[60:61], v9, 12288
T v[62:63], v9, 14336
WL 8
M v[24:27], v[44:47], v[72:75], v[24:27]
buffer_load_dwordx4 v[156:159], v3, s[12:15], s81 offen offset:3072 sc1
s_cmp_lg_u32 s28, 0
s_cbranch_scc1 L_np19
s_add_u32 s83, s78, 24
s_and_b32 s83, s83, 31
s_lshr_b32 s83, s83, 1
s_mov_b32 s86, 0
L_pc25:
s_lshr_b32 s84, s85, s83
s_and_b32 s84, s84, 1
s_cbranch_scc1 L_pd25
s_mov_b64 exec, 3
buffer_load_dword v31, v30, s[20:23], 0 offen sc1
s_waitcnt vmcnt(0)
s_mov_b64 exec, -1
v_readlane_b32 s84, v31, 0
v_readlane_b32 s85, v31, 1
s_and_b32 s85, s85, s84
s_sleep 1
s_add_u32 s86, s86, 1
s_cmp_lt_u32 s86, 0x400000
s_cbranch_scc1 L_pc25
L_pd25:
L_np19:
s_barrier
T v[32:33], v6, 16384
T v[34:35], v6, 18432
WL 8
M v[12:15], v[48:51], v[76:79], v[12:15]
T v[36:37], v7, 16384
T v[38:39], v7, 18432
WL 8
M v[16:19], v[52:55], v[76:79], v[16:19]
s_add_u32 s80, s78, 26
s_and_b32 s80, s80, 31
s_mul_i32 s80, s80, 114688
s_add_u32 s80, s80, s30
s_add_u32 m0, s31, 131072
s_add_u32 s32, s80, 0
buffer_load_dwordx4 v2, s[8:11], s32 offen lds
T v[40:41], v8, 16384
T v[42:43], v8, 18432
WL 8
M v[20:23], v[56:59], v[76:79], v[20:23]
T v[44:45], v9, 16384
T v[46:47], v9, 18432
WL 8
M v[24:27], v[60:63], v[76:79], v[24:27]
s_add_u32 m0, s31, 132096
s_add_u32 s32, s80, 7168
buffer_load_dwordx4 v2, s[8:11], s32 offen lds
T v[48:49], v6, 20480
T v[50:51], v6, 22528
s_waitcnt vmcnt(34)
WL 8
M v[12:15], v[32:35], v[80:83], v[12:15]
T v[52:53], v7, 20480
T v[54:55], v7, 22528
WL 8
M v[16:19], v[36:39], v[80:83], v[16:19]
s_add_u32 m0, s31, 133120
s_add_u32 s32, s80, 14336
buffer_load_dwordx4 v2, s[8:11], s32 offen lds
T v[56:57], v8, 20480
T v[58:59], v8, 22528
WL 8
M v[20:23], v[40:43], v[80:83], v[20:23]
T v[60:61], v9, 20480
T v[62:63], v9, 22528
WL 8
M v[24:27], v[44:47], v[80:83], v[24:27]
s_add_u32 m0, s31, 134144
s_add_u32 s32, s80, 21504
buffer_load_dwordx4 v2, s[8:11], s32 offen lds
T v[32:33], v6, 24576
T v[34:35], v6, 26624
WL 8
M v[12:15], v[48:51], v[84:87], v[12:15]
T v[36:37], v7, 24576
T v[38:39], v7, 26624
WL 8
M v[16:19], v[52:55], v[84:87], v[16:19]
s_add_u32 s81, s78, 24
s_and_b32 s81, s81, 31
s_lshl_b32 s81, s81, 12
buffer_load_dwordx4 v[64:67], v3, s[12:15], s81 offen offset:0 sc1
T v[40:41], v8, 24576
T v[42:43], v8, 26624
WL 8
M v[20:23], v[56:59], v[84:87], v[20:23]
T v[44:45], v9, 24576
T v[46:47], v9, 26624
WL 8
M v[24:27], v[60:63], v[84:87], v[24:27]
buffer_load_dwordx4 v[68:71], v3, s[12:15], s81 offen offset:1024 sc1
T v[48:49], v6, 28672
T v[50:51], v6, 30720
WL 8
M v[12:15], v[32:35], v[88:91], v[12:15]
T v[52:53], v7, 28672
T v[54:55], v7, 30720
WL 8
M v[16:19], v[36:39], v[88:91], v[16:19]
buffer_load_dwordx4 v[72:75], v3, s[12:15], s81 offen offset:2048 sc1
T v[56:57], v8, 28672
T v[58:59], v8, 30720
WL 8
M v[20:23], v[40:43], v[88:91], v[20:23]
T v[60:61], v9, 28672
T v[62:63], v9, 30720
WL 8
M v[24:27], v[44:47], v[88:91], v[24:27]
buffer_load_dwordx4 v[76:79], v3, s[12:15], s81 offen offset:3072 sc1
s_cmp_lg_u32 s28, 0
s_cbranch_scc1 L_np20
s_add_u32 s83, s78, 25
s_and_b32 s83, s83, 31
s_lshr_b32 s83, s83, 1
s_mov_b32 s86, 0
L_pc26:
s_lshr_b32 s84, s85, s83
s_and_b32 s84, s84, 1
s_cbranch_scc1 L_pd26
s_mov_b64 exec, 3
buffer_load_dword v31, v30, s[20:23], 0 offen sc1
s_waitcnt vmcnt(0)
s_mov_b64 exec, -1
v_readlane_b32 s84, v31, 0
v_readlane_b32 s85, v31, 1
s_and_b32 s85, s85, s84
s_sleep 1
s_add_u32 s86, s86, 1
s_cmp_lt_u32 s86, 0x400000
s_cbranch_scc1 L_pc26
L_pd26:
L_np20:
s_barrier
T v[32:33], v6, 32768
T v[34:35], v6, 34816
WL 8
M v[12:15], v[48:51], v[92:95], v[12:15]
T v[36:37], v7, 32768
T v[38:39], v7, 34816
WL 8
M v[16:19], v[52:55], v[92:95], v[16:19]
s_add_u32 s80, s78, 27
s_and_b32 s80, s80, 31
s_mul_i32 s80, s80, 114688
s_add_u32 s80, s80, s30
s_add_u32 m0, s31, 0
s_add_u32 s32, s80, 0
buffer_load_dwordx4 v2, s[8:11], s32 offen lds
T v[40:41], v8, 32768
T v[42:43], v8, 34816
WL 8
M v[20:23], v[56:59], v[92:95], v[20:23]
T v[44:45], v9, 32768
T v[46:47], v9, 34816
WL 8
M v[24:27], v[60:63], v[92:95], v[24:27]
s_add_u32 m0, s31, 1024
s_add_u32 s32, s80, 7168
buffer_load_dwordx4 v2, s[8:11], s32 offen lds
T v[48:49], v6, 36864
T v[50:51], v6, 38912
s_waitcnt vmcnt(34)
WL 8
M v[12:15], v[32:35], v[96:99], v[12:15]
T v[52:53], v7, 36864
T v[54:55], v7, 38912
WL 8
M v[16:19], v[36:39], v[96:99], v[16:19]
s_add_u32 m0, s31, 2048
s_add_u32 s32, s80, 14336
buffer_load_dwordx4 v2, s[8:11], s32 offen lds
T v[56:57], v8, 36864
T v[58:59], v8, 38912
WL 8
M v[20:23], v[40:43], v[96:99], v[20:23]
T v[60:61], v9, 36864
T v[62:63], v9, 38912
WL 8
M v[24:27], v[44:47], v[96:99], v[24:27]
s_add_u32 m0, s31, 3072
s_add_u32 s32, s80, 21504
buffer_load_dwordx4 v2, s[8:11], s32 offen lds
T v[32:33], v6, 40960
T v[34:35], v6, 43008
WL 8
M v[12:15], v[48:51], v[100:103], v[12:15]
T v[36:37], v7, 40960
T v[38:39], v7, 43008
WL 8
M v[16:19], v[52:55], v[100:103], v[16:19]
s_add_u32 s81, s78, 25
s_and_b32 s81, s81, 31
s_lshl_b32 s81, s81, 12
buffer_load_dwordx4 v[80:83], v3, s[12:15], s81 offen offset:0 sc1
T v[40:41], v8, 40960
T v[42:43], v8, 43008
WL 8
M v[20:23], v[56:59], v[100:103], v[20:23]
T v[44:45], v9, 40960
T v[46:47], v9, 43008
WL 8
M v[24:27], v[60:63], v[100:103], v[24:27]
buffer_load_dwordx4 v[84:87], v3, s[12:15], s81 offen offset:1024 sc1
T v[48:49], v6, 45056
T v[50:51], v6, 47104
WL 8
M v[12:15], v[32:35], v[104:107], v[12:15]
T v[52:53], v7, 45056
T v[54:55], v7, 47104
WL 8
M v[16:19], v[36:39], v[104:107], v[16:19]
buffer_load_dwordx4 v[88:91], v3, s[12:15], s81 offen offset:2048 sc1
T v[56:57], v8, 45056
T v[58:59], v8, 47104
WL 8
M v[20:23], v[40:43], v[104:107], v[20:23]
T v[60:61], v9, 45056
T v[62:63], v9, 47104
WL 8
M v[24:27], v[44:47], v[104:107], v[24:27]
buffer_load_dwordx4 v[92:95], v3, s[12:15], s81 offen offset:3072 sc1
s_cmp_lg_u32 s28, 0
s_cbranch_scc1 L_np21
s_add_u32 s83, s78, 26
s_and_b32 s83, s83, 31
s_lshr_b32 s83, s83, 1
s_mov_b32 s86, 0
L_pc27:
s_lshr_b32 s84, s85, s83
s_and_b32 s84, s84, 1
s_cbranch_scc1 L_pd27
s_mov_b64 exec, 3
buffer_load_dword v31, v30, s[20:23], 0 offen sc1
s_waitcnt vmcnt(0)
s_mov_b64 exec, -1
v_readlane_b32 s84, v31, 0
v_readlane_b32 s85, v31, 1
s_and_b32 s85, s85, s84
s_sleep 1
s_add_u32 s86, s86, 1
s_cmp_lt_u32 s86, 0x400000
s_cbranch_scc1 L_pc27
L_pd27:
L_np21:
s_barrier
T v[32:33], v6, 49152
T v[34:35], v6, 51200
WL 8
M v[12:15], v[48:51], v[108:111], v[12:15]
T v[36:37], v7, 49152
T v[38:39], v7, 51200
WL 8
M v[16:19], v[52:55], v[108:111], v[16:19]
s_add_u32 s80, s78, 28
s_and_b32 s80, s80, 31
s_mul_i32 s80, s80, 114688
s_add_u32 s80, s80, s30
s_add_u32 m0, s31, 16384
s_add_u32 s32, s80, 0
buffer_load_dwordx4 v2, s[8:11], s32 offen lds
T v[40:41], v8, 49152
T v[42:43], v8, 51200
WL 8
M v[20:23], v[56:59], v[108:111], v[20:23]
T v[44:45], v9, 49152
T v[46:47], v9, 51200
WL 8
M v[24:27], v[60:63], v[108:111], v[24:27]
s_add_u32 m0, s31, 17408
s_add_u32 s32, s80, 7168
buffer_load_dwordx4 v2, s[8:11], s32 offen lds
T v[48:49], v6, 53248
T v[50:51], v6, 55296
s_waitcnt vmcnt(34)
WL 8
M v[12:15], v[32:35], v[112:115], v[12:15]
T v[52:53], v7, 53248
T v[54:55], v7, 55296
WL 8
M v[16:19], v[36:39], v[112:115], v[16:19]
s_add_u32 m0, s31, 18432
s_add_u32 s32, s80, 14336
buffer_load_dwordx4 v2, s[8:11], s32 offen lds
T v[56:57], v8, 53248
T v[58:59], v8, 55296
WL 8
M v[20:23], v[40:43], v[112:115], v[20:23]
T v[60:61], v9, 53248
T v[62:63], v9, 55296
WL 8
M v[24:27], v[44:47], v[112:115], v[24:27]
s_add_u32 m0, s31, 19456
s_add_u32 s32, s80, 21504
buffer_load_dwordx4 v2, s[8:11], s32 offen lds
T v[32:33], v6, 57344
T v[34:35], v6, 59392
WL 8
M v[12:15], v[48:51], v[116:119], v[12:15]
T v[36:37], v7, 57344
T v[38:39], v7, 59392
WL 8
M v[16:19], v[52:55], v[116:119], v[16:19]
s_add_u32 s81, s78, 26
s_and_b32 s81, s81, 31
s_lshl_b32 s81, s81, 12
buffer_load_dwordx4 v[96:99], v3, s[12:15], s81 offen offset:0 sc1
T v[40:41], v8, 57344
T v[42:43], v8, 59392
WL 8
M v[20:23], v[56:59], v[116:119], v[20:23]
T v[44:45], v9, 57344
T v[46:47], v9, 59392
WL 8
M v[24:27], v[60:63], v[116:119], v[24:27]
buffer_load_dwordx4 v[100:103], v3, s[12:15], s81 offen offset:1024 sc1
T v[48:49], v6, 61440
T v[50:51], v6, 63488
WL 8
M v[12:15], v[32:35], v[120:123], v[12:15]
T v[52:53], v7, 61440
T v[54:55], v7, 63488
WL 8
M v[16:19], v[36:39], v[120:123], v[16:19]
buffer_load_dwordx4 v[104:107], v3, s[12:15], s81 offen offset:2048 sc1
T v[56:57], v8, 61440
T v[58:59], v8, 63488
WL 8
M v[20:23], v[40:43], v[120:123], v[20:23]
T v[60:61], v9, 61440
T v[62:63], v9, 63488
WL 8
M v[24:27], v[44:47], v[120:123], v[24:27]
buffer_load_dwordx4 v[108:111], v3, s[12:15], s81 offen offset:3072 sc1
s_cmp_lg_u32 s28, 0
s_cbranch_scc1 L_np22
s_add_u32 s83, s78, 27
s_and_b32 s83, s83, 31
s_lshr_b32 s83, s83, 1
s_mov_b32 s86, 0
L_pc28:
s_lshr_b32 s84, s85, s83
s_and_b32 s84, s84, 1
s_cbranch_scc1 L_pd28
s_mov_b64 exec, 3
buffer_load_dword v31, v30, s[20:23], 0 offen sc1
s_waitcnt vmcnt(0)
s_mov_b64 exec, -1
v_readlane_b32 s84, v31, 0
v_readlane_b32 s85, v31, 1
s_and_b32 s85, s85, s84
s_sleep 1
s_add_u32 s86, s86, 1
s_cmp_lt_u32 s86, 0x400000
s_cbranch_scc1 L_pc28
L_pd28:
L_np22:
s_barrier
v_add_u32 v6, 65536, v6
v_add_u32 v7, 65536, v7
v_add_u32 v8, 65536, v8
v_add_u32 v9, 65536, v9
T v[32:33], v6, 0
T v[34:35], v6, 2048
WL 8
M v[12:15], v[48:51], v[124:127], v[12:15]
T v[36:37], v7, 0
T v[38:39], v7, 2048
WL 8
M v[16:19], v[52:55], v[124:127], v[16:19]
s_add_u32 s80, s78, 29
s_and_b32 s80, s80, 31
s_mul_i32 s80, s80, 114688
s_add_u32 s80, s80, s30
s_add_u32 m0, s31, 32768
s_add_u32 s32, s80, 0
buffer_load_dwordx4 v2, s[8:11], s32 offen lds
T v[40:41], v8, 0
T v[42:43], v8, 2048
WL 8
M v[20:23], v[56:59], v[124:127], v[20:23]
T v[44:45], v9, 0
T v[46:47], v9, 2048
WL 8
M v[24:27], v[60:63], v[124:127], v[24:27]
s_add_u32 m0, s31, 33792
s_add_u32 s32, s80, 7168
buffer_load_dwordx4 v2, s[8:11], s32 offen lds
T v[48:49], v6, 4096
T v[50:51], v6, 6144
s_waitcnt vmcnt(34)
WL 8
M v[12:15], v[32:35], v[128:131], v[12:15]
T v[52:53], v7, 4096
T v[54:55], v7, 6144
WL 8
M v[16:19], v[36:39], v[128:131], v[16:19]
s_add_u32 m0, s31, 34816
s_add_u32 s32, s80, 14336
buffer_load_dwordx4 v2, s[8:11], s32 offen lds
T v[56:57], v8, 4096
T v[58:59], v8, 6144
WL 8
M v[20:23], v[40:43], v[128:131], v[20:23]
T v[60:61], v9, 4096
T v[62:63], v9, 6144
WL 8
M v[24:27], v[44:47], v[128:131], v[24:27]
s_add_u32 m0, s31, 35840
s_add_u32 s32, s80, 21504
buffer_load_dwordx4 v2, s[8:11], s32 offen lds
T v[32:33], v6, 8192
T v[34:35], v6, 10240
WL 8
M v[12:15], v[48:51], v[132:135], v[12:15]
T v[36:37], v7, 8192
T v[38:39], v7, 10240
WL 8
M v[16:19], v[52:55], v[132:135], v[16:19]
s_add_u32 s81, s78, 27
s_and_b32 s81, s81, 31
s_lshl_b32 s81, s81, 12
buffer_load_dwordx4 v[112:115], v3, s[12:15], s81 offen offset:0 sc1
T v[40:41], v8, 8192
T v[42:43], v8, 10240
WL 8
M v[20:23], v[56:59], v[132:135], v[20:23]
T v[44:45], v9, 8192
T v[46:47], v9, 10240
WL 8
M v[24:27], v[60:63], v[132:135], v[24:27]
buffer_load_dwordx4 v[116:119], v3, s[12:15], s81 offen offset:1024 sc1
T v[48:49], v6, 12288
T v[50:51], v6, 14336
WL 8
M v[12:15], v[32:35], v[136:139], v[12:15]
T v[52:53], v7, 12288
T v[54:55], v7, 14336
WL 8
M v[16:19], v[36:39], v[136:139], v[16:19]
buffer_load_dwordx4 v[120:123], v3, s[12:15], s81 offen offset:2048 sc1
T v[56:57], v8, 12288
T v[58:59], v8, 14336
WL 8
M v[20:23], v[40:43], v[136:139], v[20:23]
T v[60:61], v9, 12288
T v[62:63], v9, 14336
WL 8
M v[24:27], v[44:47], v[136:139], v[24:27]
buffer_load_dwordx4 v[124:127], v3, s[12:15], s81 offen offset:3072 sc1
s_cmp_lg_u32 s28, 0
s_cbranch_scc1 L_np23
s_add_u32 s83, s78, 28
s_and_b32 s83, s83, 31
s_lshr_b32 s83, s83, 1
s_mov_b32 s86, 0
L_pc29:
s_lshr_b32 s84, s85, s83
s_and_b32 s84, s84, 1
s_cbranch_scc1 L_pd29
s_mov_b64 exec, 3
buffer_load_dword v31, v30, s[20:23], 0 offen sc1
s_waitcnt vmcnt(0)
s_mov_b64 exec, -1
v_readlane_b32 s84, v31, 0
v_readlane_b32 s85, v31, 1
s_and_b32 s85, s85, s84
s_sleep 1
s_add_u32 s86, s86, 1
s_cmp_lt_u32 s86, 0x400000
s_cbranch_scc1 L_pc29
L_pd29:
L_np23:
s_barrier
T v[32:33], v6, 16384
T v[34:35], v6, 18432
WL 8
M v[12:15], v[48:51], v[140:143], v[12:15]
T v[36:37], v7, 16384
T v[38:39], v7, 18432
WL 8
M v[16:19], v[52:55], v[140:143], v[16:19]
s_add_u32 s80, s78, 30
s_and_b32 s80, s80, 31
s_mul_i32 s80, s80, 114688
s_add_u32 s80, s80, s30
s_add_u32 m0, s31, 49152
s_add_u32 s32, s80, 0
buffer_load_dwordx4 v2, s[8:11], s32 offen lds
T v[40:41], v8, 16384
T v[42:43], v8, 18432
WL 8
M v[20:23], v[56:59], v[140:143], v[20:23]
T v[44:45], v9, 16384
T v[46:47], v9, 18432
WL 8
M v[24:27], v[60:63], v[140:143], v[24:27]
s_add_u32 m0, s31, 50176
s_add_u32 s32, s80, 7168
buffer_load_dwordx4 v2, s[8:11], s32 offen lds
T v[48:49], v6, 20480
T v[50:51], v6, 22528
s_waitcnt vmcnt(34)
WL 8
M v[12:15], v[32:35], v[144:147], v[12:15]
T v[52:53], v7, 20480
T v[54:55], v7, 22528
WL 8
M v[16:19], v[36:39], v[144:147], v[16:19]
s_add_u32 m0, s31, 51200
s_add_u32 s32, s80, 14336
buffer_load_dwordx4 v2, s[8:11], s32 offen lds
T v[56:57], v8, 20480
T v[58:59], v8, 22528
WL 8
M v[20:23], v[40:43], v[144:147], v[20:23]
T v[60:61], v9, 20480
T v[62:63], v9, 22528
WL 8
M v[24:27], v[44:47], v[144:147], v[24:27]
s_add_u32 m0, s31, 52224
s_add_u32 s32, s80, 21504
buffer_load_dwordx4 v2, s[8:11], s32 offen lds
T v[32:33], v6, 24576
T v[34:35], v6, 26624
WL 8
M v[12:15], v[48:51], v[148:151], v[12:15]
T v[36:37], v7, 24576
T v[38:39], v7, 26624
WL 8
M v[16:19], v[52:55], v[148:151], v[16:19]
s_add_u32 s81, s78, 28
s_and_b32 s81, s81, 31
s_lshl_b32 s81, s81, 12
buffer_load_dwordx4 v[128:131], v3, s[12:15], s81 offen offset:0 sc1
T v[40:41], v8, 24576
T v[42:43], v8, 26624
WL 8
M v[20:23], v[56:59], v[148:151], v[20:23]
T v[44:45], v9, 24576
T v[46:47], v9, 26624
WL 8
M v[24:27], v[60:63], v[148:151], v[24:27]
buffer_load_dwordx4 v[132:135], v3, s[12:15], s81 offen offset:1024 sc1
T v[48:49], v6, 28672
T v[50:51], v6, 30720
WL 8
M v[12:15], v[32:35], v[152:155], v[12:15]
T v[52:53], v7, 28672
T v[54:55], v7, 30720
WL 8
M v[16:19], v[36:39], v[152:155], v[16:19]
buffer_load_dwordx4 v[136:139], v3, s[12:15], s81 offen offset:2048 sc1
T v[56:57], v8, 28672
T v[58:59], v8, 30720
WL 8
M v[20:23], v[40:43], v[152:155], v[20:23]
T v[60:61], v9, 28672
T v[62:63], v9, 30720
WL 8
M v[24:27], v[44:47], v[152:155], v[24:27]
buffer_load_dwordx4 v[140:143], v3, s[12:15], s81 offen offset:3072 sc1
s_cmp_lg_u32 s28, 0
s_cbranch_scc1 L_np24
s_add_u32 s83, s78, 29
s_and_b32 s83, s83, 31
s_lshr_b32 s83, s83, 1
s_mov_b32 s86, 0
L_pc30:
s_lshr_b32 s84, s85, s83
s_and_b32 s84, s84, 1
s_cbranch_scc1 L_pd30
s_mov_b64 exec, 3
buffer_load_dword v31, v30, s[20:23], 0 offen sc1
s_waitcnt vmcnt(0)
s_mov_b64 exec, -1
v_readlane_b32 s84, v31, 0
v_readlane_b32 s85, v31, 1
s_and_b32 s85, s85, s84
s_sleep 1
s_add_u32 s86, s86, 1
s_cmp_lt_u32 s86, 0x400000
s_cbranch_scc1 L_pc30
L_pd30:
L_np24:
s_barrier
T v[32:33], v6, 32768
T v[34:35], v6, 34816
WL 8
M v[12:15], v[48:51], v[156:159], v[12:15]
T v[36:37], v7, 32768
T v[38:39], v7, 34816
WL 8
M v[16:19], v[52:55], v[156:159], v[16:19]
s_add_u32 s80, s78, 31
s_and_b32 s80, s80, 31
s_mul_i32 s80, s80, 114688
s_add_u32 s80, s80, s30
s_add_u32 m0, s31, 65536
s_add_u32 s32, s80, 0
buffer_load_dwordx4 v2, s[8:11], s32 offen lds
T v[40:41], v8, 32768
T v[42:43], v8, 34816
WL 8
M v[20:23], v[56:59], v[156:159], v[20:23]
T v[44:45], v9, 32768
T v[46:47], v9, 34816
WL 8
M v[24:27], v[60:63], v[156:159], v[24:27]
s_add_u32 m0, s31, 66560
s_add_u32 s32, s80, 7168
buffer_load_dwordx4 v2, s[8:11], s32 offen lds
T v[48:49], v6, 36864
T v[50:51], v6, 38912
s_waitcnt vmcnt(34)
WL 8
M v[12:15], v[32:35], v[64:67], v[12:15]
T v[52:53], v7, 36864
T v[54:55], v7, 38912
WL 8
M v[16:19], v[36:39], v[64:67], v[16:19]
s_add_u32 m0, s31, 67584
s_add_u32 s32, s80, 14336
buffer_load_dwordx4 v2, s[8:11], s32 offen lds
T v[56:57], v8, 36864
T v[58:59], v8, 38912
WL 8
M v[20:23], v[40:43], v[64:67], v[20:23]
T v[60:61], v9, 36864
T v[62:63], v9, 38912
WL 8
M v[24:27], v[44:47], v[64:67], v[24:27]
s_add_u32 m0, s31, 68608
s_add_u32 s32, s80, 21504
buffer_load_dwordx4 v2, s[8:11], s32 offen lds
T v[32:33], v6, 40960
T v[34:35], v6, 43008
WL 8
M v[12:15], v[48:51], v[68:71], v[12:15]
T v[36:37], v7, 40960
T v[38:39], v7, 43008
WL 8
M v[16:19], v[52:55], v[68:71], v[16:19]
s_add_u32 s81, s78, 29
s_and_b32 s81, s81, 31
s_lshl_b32 s81, s81, 12
buffer_load_dwordx4 v[144:147], v3, s[12:15], s81 offen offset:0 sc1
T v[40:41], v8, 40960
T v[42:43], v8, 43008
WL 8
M v[20:23], v[56:59], v[68:71], v[20:23]
T v[44:45], v9, 40960
T v[46:47], v9, 43008
WL 8
M v[24:27], v[60:63], v[68:71], v[24:27]
buffer_load_dwordx4 v[148:151], v3, s[12:15], s81 offen offset:1024 sc1
T v[48:49], v6, 45056
T v[50:51], v6, 47104
WL 8
M v[12:15], v[32:35], v[72:75], v[12:15]
T v[52:53], v7, 45056
T v[54:55], v7, 47104
WL 8
M v[16:19], v[36:39], v[72:75], v[16:19]
buffer_load_dwordx4 v[152:155], v3, s[12:15], s81 offen offset:2048 sc1
T v[56:57], v8, 45056
T v[58:59], v8, 47104
WL 8
M v[20:23], v[40:43], v[72:75], v[20:23]
T v[60:61], v9, 45056
T v[62:63], v9, 47104
WL 8
M v[24:27], v[44:47], v[72:75], v[24:27]
buffer_load_dwordx4 v[156:159], v3, s[12:15], s81 offen offset:3072 sc1
s_cmp_lg_u32 s28, 0
s_cbranch_scc1 L_np25
s_add_u32 s83, s78, 30
s_and_b32 s83, s83, 31
s_lshr_b32 s83, s83, 1
s_mov_b32 s86, 0
L_pc31:
s_lshr_b32 s84, s85, s83
s_and_b32 s84, s84, 1
s_cbranch_scc1 L_pd31
s_mov_b64 exec, 3
buffer_load_dword v31, v30, s[20:23], 0 offen sc1
s_waitcnt vmcnt(0)
s_mov_b64 exec, -1
v_readlane_b32 s84, v31, 0
v_readlane_b32 s85, v31, 1
s_and_b32 s85, s85, s84
s_sleep 1
s_add_u32 s86, s86, 1
s_cmp_lt_u32 s86, 0x400000
s_cbranch_scc1 L_pc31
L_pd31:
L_np25:
s_barrier
T v[32:33], v6, 49152
T v[34:35], v6, 51200
WL 8
M v[12:15], v[48:51], v[76:79], v[12:15]
T v[36:37], v7, 49152
T v[38:39], v7, 51200
WL 8
M v[16:19], v[52:55], v[76:79], v[16:19]
T v[40:41], v8, 49152
T v[42:43], v8, 51200
WL 8
M v[20:23], v[56:59], v[76:79], v[20:23]
T v[44:45], v9, 49152
T v[46:47], v9, 51200
WL 8
M v[24:27], v[60:63], v[76:79], v[24:27]
T v[48:49], v6, 53248
T v[50:51], v6, 55296
s_waitcnt vmcnt(32)
WL 8
M v[12:15], v[32:35], v[80:83], v[12:15]
T v[52:53], v7, 53248
T v[54:55], v7, 55296
WL 8
M v[16:19], v[36:39], v[80:83], v[16:19]
s_add_u32 s81, s78, 30
s_and_b32 s81, s81, 31
s_lshl_b32 s81, s81, 12
buffer_load_dwordx4 v[64:67], v3, s[12:15], s81 offen offset:0 sc1
T v[56:57], v8, 53248
T v[58:59], v8, 55296
WL 8
M v[20:23], v[40:43], v[80:83], v[20:23]
T v[60:61], v9, 53248
T v[62:63], v9, 55296
WL 8
M v[24:27], v[44:47], v[80:83], v[24:27]
buffer_load_dwordx4 v[68:71], v3, s[12:15], s81 offen offset:1024 sc1
T v[32:33], v6, 57344
T v[34:35], v6, 59392
WL 8
M v[12:15], v[48:51], v[84:87], v[12:15]
T v[36:37], v7, 57344
T v[38:39], v7, 59392
WL 8
M v[16:19], v[52:55], v[84:87], v[16:19]
buffer_load_dwordx4 v[72:75], v3, s[12:15], s81 offen offset:2048 sc1
T v[40:41], v8, 57344
T v[42:43], v8, 59392
WL 8
M v[20:23], v[56:59], v[84:87], v[20:23]
T v[44:45], v9, 57344
T v[46:47], v9, 59392
WL 8
M v[24:27], v[60:63], v[84:87], v[24:27]
buffer_load_dwordx4 v[76:79], v3, s[12:15], s81 offen offset:3072 sc1
T v[48:49], v6, 61440
T v[50:51], v6, 63488
WL 8
M v[12:15], v[32:35], v[88:91], v[12:15]
T v[52:53], v7, 61440
T v[54:55], v7, 63488
WL 8
M v[16:19], v[36:39], v[88:91], v[16:19]
T v[56:57], v8, 61440
T v[58:59], v8, 63488
WL 8
M v[20:23], v[40:43], v[88:91], v[20:23]
T v[60:61], v9, 61440
T v[62:63], v9, 63488
WL 8
M v[24:27], v[44:47], v[88:91], v[24:27]
s_cmp_lg_u32 s28, 0
s_cbranch_scc1 L_np26
s_add_u32 s83, s78, 31
s_and_b32 s83, s83, 31
s_lshr_b32 s83, s83, 1
s_mov_b32 s86, 0
L_pc32:
s_lshr_b32 s84, s85, s83
s_and_b32 s84, s84, 1
s_cbranch_scc1 L_pd32
s_mov_b64 exec, 3
buffer_load_dword v31, v30, s[20:23], 0 offen sc1
s_waitcnt vmcnt(0)
s_mov_b64 exec, -1
v_readlane_b32 s84, v31, 0
v_readlane_b32 s85, v31, 1
s_and_b32 s85, s85, s84
s_sleep 1
s_add_u32 s86, s86, 1
s_cmp_lt_u32 s86, 0x400000
s_cbranch_scc1 L_pc32
L_pd32:
L_np26:
s_barrier
v_add_u32 v6, 65536, v6
v_add_u32 v7, 65536, v7
v_add_u32 v8, 65536, v8
v_add_u32 v9, 65536, v9
T v[32:33], v6, 0
T v[34:35], v6, 2048
WL 8
M v[12:15], v[48:51], v[92:95], v[12:15]
T v[36:37], v7, 0
T v[38:39], v7, 2048
WL 8
M v[16:19], v[52:55], v[92:95], v[16:19]
T v[40:41], v8, 0
T v[42:43], v8, 2048
WL 8
M v[20:23], v[56:59], v[92:95], v[20:23]
T v[44:45], v9, 0
T v[46:47], v9, 2048
WL 8
M v[24:27], v[60:63], v[92:95], v[24:27]
T v[48:49], v6, 4096
T v[50:51], v6, 6144
s_waitcnt vmcnt(28)
WL 8
M v[12:15], v[32:35], v[96:99], v[12:15]
T v[52:53], v7, 4096
T v[54:55], v7, 6144
WL 8
M v[16:19], v[36:39], v[96:99], v[16:19]
s_add_u32 s81, s78, 31
s_and_b32 s81, s81, 31
s_lshl_b32 s81, s81, 12
buffer_load_dwordx4 v[80:83], v3, s[12:15], s81 offen offset:0 sc1
T v[56:57], v8, 4096
T v[58:59], v8, 6144
WL 8
M v[20:23], v[40:43], v[96:99], v[20:23]
T v[60:61], v9, 4096
T v[62:63], v9, 6144
WL 8
M v[24:27], v[44:47], v[96:99], v[24:27]
buffer_load_dwordx4 v[84:87], v3, s[12:15], s81 offen offset:1024 sc1
T v[32:33], v6, 8192
T v[34:35], v6, 10240
WL 8
M v[12:15], v[48:51], v[100:103], v[12:15]
T v[36:37], v7, 8192
T v[38:39], v7, 10240
WL 8
M v[16:19], v[52:55], v[100:103], v[16:19]
buffer_load_dwordx4 v[88:91], v3, s[12:15], s81 offen offset:2048 sc1
T v[40:41], v8, 8192
T v[42:43], v8, 10240
WL 8
M v[20:23], v[56:59], v[100:103], v[20:23]
T v[44:45], v9, 8192
T v[46:47], v9, 10240
WL 8
M v[24:27], v[60:63], v[100:103], v[24:27]
buffer_load_dwordx4 v[92:95], v3, s[12:15], s81 offen offset:3072 sc1
T v[48:49], v6, 12288
T v[50:51], v6, 14336
WL 8
M v[12:15], v[32:35], v[104:107], v[12:15]
T v[52:53], v7, 12288
T v[54:55], v7, 14336
WL 8
M v[16:19], v[36:39], v[104:107], v[16:19]
T v[56:57], v8, 12288
T v[58:59], v8, 14336
WL 8
M v[20:23], v[40:43], v[104:107], v[20:23]
T v[60:61], v9, 12288
T v[62:63], v9, 14336
WL 8
M v[24:27], v[44:47], v[104:107], v[24:27]
s_barrier
v_add_u32 v6, 4294836224, v6
v_add_u32 v7, 4294836224, v7
v_add_u32 v8, 4294836224, v8
v_add_u32 v9, 4294836224, v9
T v[32:33], v6, 0
T v[34:35], v6, 2048
WL 8
M v[12:15], v[48:51], v[108:111], v[12:15]
T v[36:37], v7, 0
T v[38:39], v7, 2048
WL 8
M v[16:19], v[52:55], v[108:111], v[16:19]
T v[40:41], v8, 0
T v[42:43], v8, 2048
WL 8
M v[20:23], v[56:59], v[108:111], v[20:23]
T v[44:45], v9, 0
T v[46:47], v9, 2048
WL 8
M v[24:27], v[60:63], v[108:111], v[24:27]
T v[48:49], v6, 4096
T v[50:51], v6, 6144
s_waitcnt vmcnt(24)
WL 8
M v[12:15], v[32:35], v[112:115], v[12:15]
T v[52:53], v7, 4096
T v[54:55], v7, 6144
WL 8
M v[16:19], v[36:39], v[112:115], v[16:19]
T v[56:57], v8, 4096
T v[58:59], v8, 6144
WL 8
M v[20:23], v[40:43], v[112:115], v[20:23]
T v[60:61], v9, 4096
T v[62:63], v9, 6144
WL 8
M v[24:27], v[44:47], v[112:115], v[24:27]
T v[32:33], v6, 8192
T v[34:35], v6, 10240
WL 8
M v[12:15], v[48:51], v[116:119], v[12:15]
T v[36:37], v7, 8192
T v[38:39], v7, 10240
WL 8
M v[16:19], v[52:55], v[116:119], v[16:19]
T v[40:41], v8, 8192
T v[42:43], v8, 10240
WL 8
M v[20:23], v[56:59], v[116:119], v[20:23]
T v[44:45], v9, 8192
T v[46:47], v9, 10240
WL 8
M v[24:27], v[60:63], v[116:119], v[24:27]
T v[48:49], v6, 12288
T v[50:51], v6, 14336
WL 8
M v[12:15], v[32:35], v[120:123], v[12:15]
T v[52:53], v7, 12288
T v[54:55], v7, 14336
WL 8
M v[16:19], v[36:39], v[120:123], v[16:19]
T v[56:57], v8, 12288
T v[58:59], v8, 14336
WL 8
M v[20:23], v[40:43], v[120:123], v[20:23]
T v[60:61], v9, 12288
T v[62:63], v9, 14336
WL 8
M v[24:27], v[44:47], v[120:123], v[24:27]
s_barrier
T v[32:33], v6, 16384
T v[34:35], v6, 18432
WL 8
M v[12:15], v[48:51], v[124:127], v[12:15]
T v[36:37], v7, 16384
T v[38:39], v7, 18432
WL 8
M v[16:19], v[52:55], v[124:127], v[16:19]
T v[40:41], v8, 16384
T v[42:43], v8, 18432
WL 8
M v[20:23], v[56:59], v[124:127], v[20:23]
T v[44:45], v9, 16384
T v[46:47], v9, 18432
WL 8
M v[24:27], v[60:63], v[124:127], v[24:27]
T v[48:49], v6, 20480
T v[50:51], v6, 22528
s_waitcnt vmcnt(16)
WL 8
M v[12:15], v[32:35], v[128:131], v[12:15]
T v[52:53], v7, 20480
T v[54:55], v7, 22528
WL 8
M v[16:19], v[36:39], v[128:131], v[16:19]
T v[56:57], v8, 20480
T v[58:59], v8, 22528
WL 8
M v[20:23], v[40:43], v[128:131], v[20:23]
T v[60:61], v9, 20480
T v[62:63], v9, 22528
WL 8
M v[24:27], v[44:47], v[128:131], v[24:27]
T v[32:33], v6, 24576
T v[34:35], v6, 26624
WL 8
M v[12:15], v[48:51], v[132:135], v[12:15]
T v[36:37], v7, 24576
T v[38:39], v7, 26624
WL 8
M v[16:19], v[52:55], v[132:135], v[16:19]
T v[40:41], v8, 24576
T v[42:43], v8, 26624
WL 8
M v[20:23], v[56:59], v[132:135], v[20:23]
T v[44:45], v9, 24576
T v[46:47], v9, 26624
WL 8
M v[24:27], v[60:63], v[132:135], v[24:27]
T v[48:49], v6, 28672
T v[50:51], v6, 30720
WL 8
M v[12:15], v[32:35], v[136:139], v[12:15]
T v[52:53], v7, 28672
T v[54:55], v7, 30720
WL 8
M v[16:19], v[36:39], v[136:139], v[16:19]
T v[56:57], v8, 28672
T v[58:59], v8, 30720
WL 8
M v[20:23], v[40:43], v[136:139], v[20:23]
T v[60:61], v9, 28672
T v[62:63], v9, 30720
WL 8
M v[24:27], v[44:47], v[136:139], v[24:27]
s_barrier
T v[32:33], v6, 32768
T v[34:35], v6, 34816
WL 8
M v[12:15], v[48:51], v[140:143], v[12:15]
T v[36:37], v7, 32768
T v[38:39], v7, 34816
WL 8
M v[16:19], v[52:55], v[140:143], v[16:19]
T v[40:41], v8, 32768
T v[42:43], v8, 34816
WL 8
M v[20:23], v[56:59], v[140:143], v[20:23]
T v[44:45], v9, 32768
T v[46:47], v9, 34816
WL 8
M v[24:27], v[60:63], v[140:143], v[24:27]
T v[48:49], v6, 36864
T v[50:51], v6, 38912
s_waitcnt vmcnt(8)
WL 8
M v[12:15], v[32:35], v[144:147], v[12:15]
T v[52:53], v7, 36864
T v[54:55], v7, 38912
WL 8
M v[16:19], v[36:39], v[144:147], v[16:19]
T v[56:57], v8, 36864
T v[58:59], v8, 38912
WL 8
M v[20:23], v[40:43], v[144:147], v[20:23]
T v[60:61], v9, 36864
T v[62:63], v9, 38912
WL 8
M v[24:27], v[44:47], v[144:147], v[24:27]
T v[32:33], v6, 40960
T v[34:35], v6, 43008
WL 8
M v[12:15], v[48:51], v[148:151], v[12:15]
T v[36:37], v7, 40960
T v[38:39], v7, 43008
WL 8
M v[16:19], v[52:55], v[148:151], v[16:19]
T v[40:41], v8, 40960
T v[42:43], v8, 43008
WL 8
M v[20:23], v[56:59], v[148:151], v[20:23]
T v[44:45], v9, 40960
T v[46:47], v9, 43008
WL 8
M v[24:27], v[60:63], v[148:151], v[24:27]
T v[48:49], v6, 45056
T v[50:51], v6, 47104
WL 8
M v[12:15], v[32:35], v[152:155], v[12:15]
T v[52:53], v7, 45056
T v[54:55], v7, 47104
WL 8
M v[16:19], v[36:39], v[152:155], v[16:19]
T v[56:57], v8, 45056
T v[58:59], v8, 47104
WL 8
M v[20:23], v[40:43], v[152:155], v[20:23]
T v[60:61], v9, 45056
T v[62:63], v9, 47104
WL 8
M v[24:27], v[44:47], v[152:155], v[24:27]
s_barrier
T v[32:33], v6, 49152
T v[34:35], v6, 51200
WL 8
M v[12:15], v[48:51], v[156:159], v[12:15]
T v[36:37], v7, 49152
T v[38:39], v7, 51200
WL 8
M v[16:19], v[52:55], v[156:159], v[16:19]
T v[40:41], v8, 49152
T v[42:43], v8, 51200
WL 8
M v[20:23], v[56:59], v[156:159], v[20:23]
T v[44:45], v9, 49152
T v[46:47], v9, 51200
WL 8
M v[24:27], v[60:63], v[156:159], v[24:27]
T v[48:49], v6, 53248
T v[50:51], v6, 55296
s_waitcnt vmcnt(4)
WL 8
M v[12:15], v[32:35], v[64:67], v[12:15]
T v[52:53], v7, 53248
T v[54:55], v7, 55296
WL 8
M v[16:19], v[36:39], v[64:67], v[16:19]
T v[56:57], v8, 53248
T v[58:59], v8, 55296
WL 8
M v[20:23], v[40:43], v[64:67], v[20:23]
T v[60:61], v9, 53248
T v[62:63], v9, 55296
WL 8
M v[24:27], v[44:47], v[64:67], v[24:27]
T v[32:33], v6, 57344
T v[34:35], v6, 59392
WL 8
M v[12:15], v[48:51], v[68:71], v[12:15]
T v[36:37], v7, 57344
T v[38:39], v7, 59392
WL 8
M v[16:19], v[52:55], v[68:71], v[16:19]
T v[40:41], v8, 57344
T v[42:43], v8, 59392
WL 8
M v[20:23], v[56:59], v[68:71], v[20:23]
T v[44:45], v9, 57344
T v[46:47], v9, 59392
WL 8
M v[24:27], v[60:63], v[68:71], v[24:27]
T v[48:49], v6, 61440
T v[50:51], v6, 63488
WL 8
M v[12:15], v[32:35], v[72:75], v[12:15]
T v[52:53], v7, 61440
T v[54:55], v7, 63488
WL 8
M v[16:19], v[36:39], v[72:75], v[16:19]
T v[56:57], v8, 61440
T v[58:59], v8, 63488
WL 8
M v[20:23], v[40:43], v[72:75], v[20:23]
T v[60:61], v9, 61440
T v[62:63], v9, 63488
WL 8
M v[24:27], v[44:47], v[72:75], v[24:27]
s_barrier
v_add_u32 v6, 65536, v6
v_add_u32 v7, 65536, v7
v_add_u32 v8, 65536, v8
v_add_u32 v9, 65536, v9
T v[32:33], v6, 0
T v[34:35], v6, 2048
WL 8
M v[12:15], v[48:51], v[76:79], v[12:15]
T v[36:37], v7, 0
T v[38:39], v7, 2048
WL 8
M v[16:19], v[52:55], v[76:79], v[16:19]
T v[40:41], v8, 0
T v[42:43], v8, 2048
WL 8
M v[20:23], v[56:59], v[76:79], v[20:23]
T v[44:45], v9, 0
T v[46:47], v9, 2048
WL 8
M v[24:27], v[60:63], v[76:79], v[24:27]
T v[48:49], v6, 4096
T v[50:51], v6, 6144
s_waitcnt vmcnt(0)
WL 8
M v[12:15], v[32:35], v[80:83], v[12:15]
T v[52:53], v7, 4096
T v[54:55], v7, 6144
WL 8
M v[16:19], v[36:39], v[80:83], v[16:19]
T v[56:57], v8, 4096
T v[58:59], v8, 6144
WL 8
M v[20:23], v[40:43], v[80:83], v[20:23]
T v[60:61], v9, 4096
T v[62:63], v9, 6144
WL 8
M v[24:27], v[44:47], v[80:83], v[24:27]
T v[32:33], v6, 8192
T v[34:35], v6, 10240
WL 8
M v[12:15], v[48:51], v[84:87], v[12:15]
T v[36:37], v7, 8192
T v[38:39], v7, 10240
WL 8
M v[16:19], v[52:55], v[84:87], v[16:19]
T v[40:41], v8, 8192
T v[42:43], v8, 10240
WL 8
M v[20:23], v[56:59], v[84:87], v[20:23]
T v[44:45], v9, 8192
T v[46:47], v9, 10240
WL 8
M v[24:27], v[60:63], v[84:87], v[24:27]
T v[48:49], v6, 12288
T v[50:51], v6, 14336
WL 8
M v[12:15], v[32:35], v[88:91], v[12:15]
T v[52:53], v7, 12288
T v[54:55], v7, 14336
WL 8
M v[16:19], v[36:39], v[88:91], v[16:19]
T v[56:57], v8, 12288
T v[58:59], v8, 14336
WL 8
M v[20:23], v[40:43], v[88:91], v[20:23]
T v[60:61], v9, 12288
T v[62:63], v9, 14336
WL 8
M v[24:27], v[44:47], v[88:91], v[24:27]
WL 6
M v[12:15], v[48:51], v[92:95], v[12:15]
WL 4
M v[16:19], v[52:55], v[92:95], v[16:19]
WL 2
M v[20:23], v[56:59], v[92:95], v[20:23]
WL 0
M v[24:27], v[60:63], v[92:95], v[24:27]
s_nop 8
CV v28, v12, v13
CV v29, v14, v15
buffer_store_dwordx2 v[28:29], v4, s[16:19], s33 offen offset:0
CV v30, v16, v17
CV v31, v18, v19
buffer_store_dwordx2 v[30:31], v4, s[16:19], s33 offen offset:32
CV v28, v20, v21
CV v29, v22, v23
buffer_store_dwordx2 v[28:29], v4, s[16:19], s33 offen offset:64
CV v30, v24, v25
CV v31, v26, v27
buffer_store_dwordx2 v[30:31], v4, s[16:19], s33 offen offset:96
L_k1_exit:
s_endpgm
.section .rodata,"a"
.p2align 6
.amdhsa_kernel standalone__mha_block_cached__near_ridge_kernel
  .amdhsa_next_free_vgpr 512
  .amdhsa_next_free_sgpr 102
  .amdhsa_accum_offset 256
  .amdhsa_group_segment_fixed_size 0
  .amdhsa_kernarg_size 64
  .amdhsa_user_sgpr_count 2
  .amdhsa_user_sgpr_kernarg_segment_ptr 1
  .amdhsa_system_sgpr_workgroup_id_x 1
.end_amdhsa_kernel
```
